```python
import torch

def _softmax(x, axis=-1):
    return torch.softmax(x, dim=axis)
def _gelu(x):
    return torch.nn.functional.gelu(x, approximate="tanh")
def _silu(x):
    return torch.nn.functional.silu(x)
def _sigmoid(x):
    return torch.sigmoid(x)
def _layernorm(x, axis=-1, eps=1e-5):
    m = x.mean(dim=axis, keepdim=True)
    v = x.var(dim=axis, keepdim=True, unbiased=False)
    return (x - m) / torch.sqrt(v + eps)
def _scatter_add(tgt, idx, src, axis=0):
    return tgt.clone().index_add_(axis, idx, src)
def _segment_sum(src, seg, n):
    out = torch.zeros((n,) + src.shape[1:], dtype=src.dtype)
    return out.index_add_(0, seg, src)
def _pad(x, pw):
    flat = tuple(v for pair in reversed(pw) for v in pair)
    return torch.nn.functional.pad(x, flat)

kernel_name = 'sequential_preLN__sliding_block__dense_activation_silu__prompt'

def setup_inputs():

    _w = (lambda a: (lambda t: t.to(torch.bfloat16) if t.is_floating_point() else t)(torch.as_tensor(a)))
    def _A_setup():
        B, S, D = 1, 2048, 640
        return {
            "x": _w((lambda *s: torch.randn(*s, dtype=torch.bfloat16) * 0.05)(B, S, D)),
            "wqkv": _w((lambda *s: torch.randn(*s, dtype=torch.bfloat16) * 0.05)(D, 3 * D)),
            "wo": _w((lambda *s: torch.randn(*s, dtype=torch.bfloat16) * 0.05)(D, D)),
        }
    _A_in = _A_setup()

    def _B_setup():
        B, S, D, F = 1, 2048, 640, 1728
        return {
            "x": _w((lambda *s: torch.randn(*s, dtype=torch.bfloat16) * 0.05)(B, S, D)),
            "w1": _w((lambda *s: torch.randn(*s, dtype=torch.bfloat16) * 3.2)(D, F) * (D ** -0.5)),
            "w2": _w((lambda *s: torch.randn(*s, dtype=torch.bfloat16) * 0.4)(F, D) * (F ** -0.5)),
        }
    _B_in = _B_setup()

    return {
        "A_x": _A_in["x"],
        "A_wqkv": _A_in["wqkv"],
        "A_wo": _A_in["wo"],
        "B_x": _B_in["x"],
        "B_w1": _B_in["w1"],
        "B_w2": _B_in["w2"],
    }

def reference(A_x, A_wqkv, A_wo, B_x, B_w1, B_w2):
    def _A_ref(x, wqkv, wo):
        B, S, D = x.shape
        H = 32; Dh = D // H; W = 256
        qkv = (lambda x, *d: x.permute(*d))((x @ wqkv).reshape(B, S, 3, H, Dh), 2, 0, 3, 1, 4)
        q, k, v = qkv[0], qkv[1], qkv[2]
        scores = torch.einsum("bhqd,bhkd->bhqk", q, k) * (Dh ** -0.5)
        idx = torch.arange(S)
        mask = (idx[:, None] - idx[None, :] >= 0) & (idx[:, None] - idx[None, :] < W)
        scores = torch.where(mask[None, None], scores, -1e9)
        p = _softmax(scores, axis=-1)
        o = torch.einsum("bhqk,bhkd->bhqd", p, v)
        return (lambda x, *d: x.permute(*d))(o, 0, 2, 1, 3).reshape(B, S, D) @ wo

    def _B_ref(x, w1, w2):
        h = torch.einsum("bsd,df->bsf", x, w1)
        h = _silu(h)
        out = torch.einsum("bsf,fd->bsd", h, w2)
        return out

    x = A_x
    h = x + _A_ref(_layernorm(x, axis=-1), A_wqkv, A_wo)
    h2 = h + _B_ref(_layernorm(h, axis=-1), B_w1, B_w2)
    return h2
```

```asm
; @launch grid=(256,1,1) block=(256,1,1) lds=163840
.amdgcn_target "amdgcn-amd-amdhsa--gfx950"
.text
.globl sequential_preLN__sliding_block__dense_activation_silu__prompt_kernel
.p2align 8
.type sequential_preLN__sliding_block__dense_activation_silu__prompt_kernel,@function
sequential_preLN__sliding_block__dense_activation_silu__prompt_kernel:
  s_cmpk_ge_u32 s2, 256
  s_cbranch_scc1 Lend
  s_load_dwordx2 s[4:5], s[0:1], 0
  s_load_dwordx2 s[8:9], s[0:1], 8
  s_load_dwordx2 s[12:13], s[0:1], 64
  s_getpc_b64 s[48:49]
Lpc0:
  s_lshr_b32 s51, s2, 3
  s_lshl_b32 s50, s51, 11
  s_min_u32 s50, s50, Lcode_end-Lpc0-2048
  v_lshl_add_u32 v2, v0, 3, s50
  global_load_dword v253, v2, s[48:49]
  v_lshrrev_b32 v2, 6, v0
  v_and_b32 v1, 63, v0
  v_readfirstlane_b32 s36, v2
  s_and_b32 s48, s2, 7
  s_lshr_b32 s38, s48, 1
  s_and_b32 s50, s51, 3
  s_lshl2_add_u32 s38, s38, s50
  s_lshr_b32 s50, s50, 1
  s_lshr_b32 s39, s51, 2
  s_cmp_eq_u32 s39, 7
  s_cselect_b32 s50, s50, 0
  s_xor_b32 s50, s50, s48
  s_and_b32 s50, s50, 1
  s_lshl3_add_u32 s39, s50, s39
  s_mov_b32 s6, 2621440
  s_mov_b32 s7, 0x20000
  s_lshr_b32 s48, s2, 1
  s_xor_b32 s48, s48, s2
  s_and_b32 s48, s48, 1
  s_mul_i32 s56, s48, 5
  s_lshl_b32 s59, s36, 12
  s_lshl2_add_u32 s48, s38, s36
  s_mul_i32 s48, s48, 40960
  v_lshrrev_b32 v28, 3, v1
  v_mul_u32_u24 v28, 1280, v28
  v_lshrrev_b32 v29, 4, v1
  v_and_b32 v30, 7, v1
  v_xor_b32 v30, v30, v29
  v_lshlrev_b32 v30, 4, v30
  v_add3_u32 v4, v30, v28, s48
  v_xor_b32 v31, 64, v4
  s_cmp_ge_u32 s39, 10
  s_cselect_b32 s49, 10240, 0
  s_add_u32 s48, s49, 9216
  s_sub_u32 s49, 18432, s49
  v_add_u32 v5, s48, v31
  v_add_u32 v6, s49, v4
  v_add_u32 v7, 27648, v31
  s_cmp_eq_u32 s39, 15
  s_waitcnt lgkmcnt(0)
  s_cbranch_scc1 Lp1_idle
  s_add_u32 m0, s59, 0
  s_lshl_b32 s57, s56, 7
  buffer_load_dwordx4 v4, s[4:7], s57 offen offset:0 lds
  buffer_load_dwordx4 v5, s[4:7], s57 offen offset:1024 lds
  buffer_load_dwordx4 v6, s[4:7], s57 offen offset:2048 lds
  buffer_load_dwordx4 v7, s[4:7], s57 offen offset:3072 lds
  s_mov_b32 s10, 2457600
  s_mov_b32 s11, 0x20000
  s_mul_i32 s48, s36, 61440
  s_lshl_b32 s49, s39, 8
  s_add_u32 s48, s48, s49
  v_mul_u32_u24 v28, 3840, v29
  v_and_b32 v30, 15, v1
  v_lshlrev_b32 v31, 1, v29
  v_xor_b32 v30, v30, v31
  v_lshlrev_b32 v30, 4, v30
  v_add3_u32 v8, v30, v28, s48
  v_xor_b32 v31, 128, v8
  v_add_u32 v9, 14336, v8
  v_add_u32 v10, 28672, v31
  v_add_u32 v11, 43008, v31
  s_add_u32 m0, s59, 65536
  s_mul_i32 s58, s56, 245760
  buffer_load_dwordx4 v8, s[8:11], s58 offen offset:0 lds
  buffer_load_dwordx4 v9, s[8:11], s58 offen offset:1024 lds
  buffer_load_dwordx4 v10, s[8:11], s58 offen offset:2048 lds
  buffer_load_dwordx4 v11, s[8:11], s58 offen offset:3072 lds
  s_mov_b32 s62, s56
  s_add_u32 s56, s56, 1
  s_cmp_eq_u32 s56, 10
  s_cselect_b32 s56, 0, s56
  s_add_u32 m0, s59, 16384
  s_lshl_b32 s57, s56, 7
  buffer_load_dwordx4 v4, s[4:7], s57 offen offset:0 lds
  buffer_load_dwordx4 v5, s[4:7], s57 offen offset:1024 lds
  buffer_load_dwordx4 v6, s[4:7], s57 offen offset:2048 lds
  buffer_load_dwordx4 v7, s[4:7], s57 offen offset:3072 lds
  s_load_dwordx2 s[30:31], s[0:1], 16
  s_load_dwordx4 s[32:35], s[0:1], 32
  s_load_dwordx2 s[20:21], s[0:1], 48
  s_add_u32 s96, s12, 29130752
  s_addc_u32 s97, s13, 0
  s_load_dword s37, s[96:97], 0
  s_lshr_b32 s48, s36, 1
  s_and_b32 s49, s36, 1
  v_and_b32 v28, 15, v1
  s_lshl_b32 s50, s48, 13
  v_lshl_add_u32 v28, v28, 7, s50
  v_lshrrev_b32 v33, 4, v1
  v_bfe_u32 v30, v1, 1, 3
  v_xor_b32 v31, v30, v33
  v_lshl_add_u32 v12, v31, 4, v28
  v_xor_b32 v13, 64, v12
  v_bfe_u32 v31, v1, 2, 2
  v_lshl_add_u32 v28, v33, 3, v31
  v_lshlrev_b32 v28, 8, v28
  v_bfe_u32 v33, v1, 2, 3
  v_lshl_add_u32 v28, v33, 5, v28
  v_and_b32 v33, 3, v1
  v_lshlrev_b32 v33, 3, v33
  v_add_u32 v33, 65536, v33
  v_add_u32 v28, v28, v33
  s_lshl_b32 s50, s49, 7
  v_xor_b32 v14, s50, v28
  v_xor_b32 v15, 32, v14
  v_xor_b32 v16, 64, v14
  v_xor_b32 v17, 96, v14
  s_lshr_b32 s48, s38, 3
  s_and_b32 s49, s38, 3
  s_lshl2_add_u32 s74, s48, s49
  s_and_b32 s75, s39, 7
  s_add_u32 s48, s74, s75
  s_mul_i32 s49, s48, 52
  s_lshr_b32 s49, s49, 8
  s_mul_i32 s49, s49, 5
  s_sub_u32 s76, s48, s49
  s_add_u32 s62, s76, s62
  v_and_b32 v32, 31, v1
  v_lshrrev_b32 v29, 5, v1
  s_and_b32 s51, s76, 3
  s_lshl_b32 s51, s51, 14
  s_add_u32 s50, s51, s59
  v_add_u32 v33, s51, v33
  v_lshl_add_u32 v28, v32, 7, s50
  v_xor_b32 v30, v30, v29
  v_lshl_add_u32 v18, v30, 4, v28
  v_xor_b32 v19, 32, v18
  v_xor_b32 v20, 64, v18
  v_xor_b32 v21, 96, v18
  v_lshl_add_u32 v28, v29, 3, v31
  v_lshl_add_u32 v28, v28, 8, v33
  v_lshl_add_u32 v31, v29, 2, v31
  v_bfe_u32 v30, v1, 4, 1
  v_xor_b32 v31, v31, v30
  v_lshl_add_u32 v28, v31, 5, v28
  s_lshl_b32 s50, s36, 6
  v_xor_b32 v22, s50, v28
  v_lshlrev_b32 v2, 4, v1
  s_mov_b32 s14, 29786112
  s_mov_b32 s15, 0x20000
  s_mov_b32 s22, 2621440
  s_mov_b32 s23, 0x20000
  s_mov_b32 s44, 0
  s_mov_b32 s45, -1
  s_mov_b32 s46, 0xffff0000
  s_mov_b32 s94, 29097984
  s_waitcnt lgkmcnt(0)
  s_mov_b32 s24, s34
  s_mov_b32 s25, s35
  s_mov_b32 s27, 0x20000
  s_cmp_lt_u32 s2, 224
  s_cselect_b32 s26, 2211840, 0
  s_cselect_b32 s100, 29786112, 0
  s_and_b32 s49, s2, 3
  s_lshr_b32 s48, s2, 2
  s_mul_i32 s50, s48, 18726
  s_lshr_b32 s50, s50, 16
  s_mul_i32 s52, s50, 112
  s_lshl_b32 s51, s48, 5
  s_sub_u32 s51, s51, s52
  s_mul_i32 s50, s50, 138240
  s_mul_i32 s52, s49, 320
  s_add_u32 s52, s52, s50
  s_mul_i32 s98, s49, 112
  s_add_u32 s98, s98, s48
  s_mul_i32 s98, s98, 5120
  s_add_u32 s98, s98, 23691264
  s_lshl_b32 s99, s49, 6
  s_add_u32 s99, s99, s48
  s_lshl_b32 s99, s99, 7
  s_add_u32 s99, s99, 29261824
  v_mov_b32 v32, 2147418112
  v_add_u32 v28, 0, v0
  v_mul_u32_u24 v29, 3277, v28
  v_lshrrev_b32 v29, 16, v29
  v_mul_u32_u24 v30, 20, v29
  v_sub_u32 v28, v28, v30
  v_lshl_add_u32 v28, v28, 4, s52
  v_add_u32 v29, s51, v29
  v_subrev_u32 v30, 108, v29
  v_med3_i32 v31, v30, 0, 4
  v_cmp_gt_u32 vcc, 4, v30
  v_sub_u32 v29, v29, v31
  v_mul_u32_u24 v29, 1280, v29
  v_add_u32 v28, v28, v29
  v_cndmask_b32 v52, v28, v32, vcc
  v_add_u32 v28, 256, v0
  v_mul_u32_u24 v29, 3277, v28
  v_lshrrev_b32 v29, 16, v29
  v_mul_u32_u24 v30, 20, v29
  v_sub_u32 v28, v28, v30
  v_lshl_add_u32 v28, v28, 4, s52
  v_add_u32 v29, s51, v29
  v_subrev_u32 v30, 108, v29
  v_med3_i32 v31, v30, 0, 4
  v_cmp_gt_u32 vcc, 4, v30
  v_sub_u32 v29, v29, v31
  v_mul_u32_u24 v29, 1280, v29
  v_add_u32 v28, v28, v29
  v_cndmask_b32 v53, v28, v32, vcc
  v_add_u32 v28, 512, v0
  v_mul_u32_u24 v29, 3277, v28
  v_lshrrev_b32 v29, 16, v29
  v_mul_u32_u24 v30, 20, v29
  v_sub_u32 v28, v28, v30
  v_lshl_add_u32 v28, v28, 4, s52
  v_add_u32 v29, s51, v29
  v_subrev_u32 v30, 108, v29
  v_med3_i32 v31, v30, 0, 4
  v_cmp_gt_u32 vcc, 4, v30
  v_sub_u32 v29, v29, v31
  v_mul_u32_u24 v29, 1280, v29
  v_add_u32 v28, v28, v29
  v_cndmask_b32 v54, v28, v32, vcc
  v_cmp_gt_u32 vcc, 128, v0
  v_lshrrev_b32 v28, 4, v1
  v_bfe_u32 v29, v1, 2, 2
  v_cndmask_b32 v54, v32, v54, vcc
  v_cndmask_b32 v243, v32, v2, vcc
  v_cmp_gt_u32 vcc, 32, v0
  v_lshl_add_u32 v30, v1, 2, s99
  v_lshl_add_u32 v28, v28, 3, v29
  v_cndmask_b32 v244, v32, v30, vcc
  v_mul_u32_u24 v28, 320, v28
  v_and_b32 v29, 3, v1
  s_add_u32 s48, s36, 0
  s_cmp_ge_u32 s48, 5
  s_cselect_b32 s49, 1, 0
  s_mul_i32 s53, s49, 5
  s_sub_u32 s48, s48, s53
  s_mul_i32 s53, s49, 280
  s_add_u32 s53, s53, s48
  s_lshl_b32 s53, s53, 10
  s_add_u32 s82, s98, s53
  s_mul_i32 s49, s49, 160
  s_and_b32 s53, s48, 1
  s_lshl3_add_u32 s49, s53, s49
  s_and_b32 s53, s48, 6
  s_lshl_b32 s53, s53, 5
  s_add_u32 s49, s49, s53
  s_add_u32 s49, s49, 131072
  s_cmp_eq_u32 s48, 4
  s_cselect_b32 s54, 3, 4
  v_lshlrev_b32 v30, s54, v29
  v_add3_u32 v240, v30, v28, s49
  s_add_u32 s48, s36, 4
  s_cmp_ge_u32 s48, 5
  s_cselect_b32 s49, 1, 0
  s_mul_i32 s53, s49, 5
  s_sub_u32 s48, s48, s53
  s_mul_i32 s53, s49, 280
  s_add_u32 s53, s53, s48
  s_lshl_b32 s53, s53, 10
  s_add_u32 s83, s98, s53
  s_mul_i32 s49, s49, 160
  s_and_b32 s53, s48, 1
  s_lshl3_add_u32 s49, s53, s49
  s_and_b32 s53, s48, 6
  s_lshl_b32 s53, s53, 5
  s_add_u32 s49, s49, s53
  s_add_u32 s49, s49, 131072
  s_cmp_eq_u32 s48, 4
  s_cselect_b32 s54, 3, 4
  v_lshlrev_b32 v30, s54, v29
  v_add3_u32 v241, v30, v28, s49
  s_add_u32 s48, s36, 8
  s_cmp_ge_u32 s48, 5
  s_cselect_b32 s49, 1, 0
  s_mul_i32 s53, s49, 5
  s_sub_u32 s48, s48, s53
  s_mul_i32 s53, s49, 280
  s_add_u32 s53, s53, s48
  s_lshl_b32 s53, s53, 10
  s_add_u32 s84, s98, s53
  s_mul_i32 s49, s49, 160
  s_cmp_ge_u32 s39, 10
  s_cbranch_scc1 Lp1_v
  s_add_u32 m0, s59, 81920
  s_mul_i32 s58, s56, 245760
  buffer_load_dwordx4 v8, s[8:11], s58 offen offset:0 lds
  buffer_load_dwordx4 v9, s[8:11], s58 offen offset:1024 lds
  buffer_load_dwordx4 v10, s[8:11], s58 offen offset:2048 lds
  buffer_load_dwordx4 v11, s[8:11], s58 offen offset:3072 lds
  s_waitcnt vmcnt(8)
  s_barrier
  ds_read_b128 v[128:131], v12 offset:0
  ds_read_b64_tr_b16 v[144:145], v14 offset:0
  ds_read_b64_tr_b16 v[146:147], v14 offset:1024
  ds_read_b64_tr_b16 v[148:149], v15 offset:0
  ds_read_b64_tr_b16 v[150:151], v15 offset:1024
  ds_read_b128 v[132:135], v12 offset:2048
  ds_read_b64_tr_b16 v[152:153], v16 offset:0
  ds_read_b64_tr_b16 v[154:155], v16 offset:1024
  ds_read_b128 v[136:139], v12 offset:4096
  ds_read_b64_tr_b16 v[156:157], v17 offset:0
  ds_read_b64_tr_b16 v[158:159], v17 offset:1024
  ds_read_b128 v[140:143], v12 offset:6144
  s_add_u32 s56, s56, 1
  s_cmp_eq_u32 s56, 10
  s_cselect_b32 s56, 0, s56
  s_add_u32 m0, s59, 32768
  s_lshl_b32 s57, s56, 7
  buffer_load_dwordx4 v4, s[4:7], s57 offen offset:0 lds
  buffer_load_dwordx4 v5, s[4:7], s57 offen offset:1024 lds
  buffer_load_dwordx4 v6, s[4:7], s57 offen offset:2048 lds
  buffer_load_dwordx4 v7, s[4:7], s57 offen offset:3072 lds
  s_waitcnt lgkmcnt(9)
  v_mfma_f32_16x16x32_bf16 v[64:67], v[144:147], v[128:131], 0
  ds_read_b128 v[160:163], v13 offset:0
  s_cmp_lg_u32 s76, 0
  s_cbranch_scc1 Lsc_8
  ds_read_b128 v[192:195], v18
  ds_read_b64_tr_b16 v[208:209], v22 offset:0
  ds_read_b64_tr_b16 v[210:211], v22 offset:1024
  ds_read_b128 v[196:199], v19
  ds_read_b64_tr_b16 v[212:213], v22 offset:4096
  ds_read_b64_tr_b16 v[214:215], v22 offset:5120
  ds_read_b128 v[200:203], v20
  ds_read_b64_tr_b16 v[216:217], v22 offset:8192
  ds_read_b64_tr_b16 v[218:219], v22 offset:9216
  ds_read_b128 v[204:207], v21
  ds_read_b64_tr_b16 v[220:221], v22 offset:12288
  ds_read_b64_tr_b16 v[222:223], v22 offset:13312
Lsc_8:
  s_waitcnt lgkmcnt(8)
  v_mfma_f32_16x16x32_bf16 v[68:71], v[148:151], v[128:131], 0
  ds_read_b64_tr_b16 v[176:177], v14 offset:8192
  s_add_u32 s37, s37, 1564122216
  s_and_b32 s53, s48, 1
  s_lshl3_add_u32 s49, s53, s49
  s_add_u32 m0, s59, 98304
  s_mul_i32 s58, s56, 245760
  s_waitcnt lgkmcnt(8)
  v_mfma_f32_16x16x32_bf16 v[84:87], v[148:151], v[132:135], 0
  buffer_load_dwordx4 v8, s[8:11], s58 offen offset:0 lds
  ds_read_b64_tr_b16 v[178:179], v14 offset:9216
  s_and_b32 s53, s48, 6
  s_lshl_b32 s53, s53, 5
  v_mfma_f32_16x16x32_bf16 v[80:83], v[144:147], v[132:135], 0
  ds_read_b64_tr_b16 v[180:181], v15 offset:8192
  s_add_u32 s49, s49, s53
  s_add_u32 s49, s49, 131072
  s_cmp_eq_u32 s48, 4
  s_cselect_b32 s54, 3, 4
  s_waitcnt lgkmcnt(8)
  v_mfma_f32_16x16x32_bf16 v[88:91], v[152:155], v[132:135], 0
  ds_read_b64_tr_b16 v[182:183], v15 offset:9216
  v_lshlrev_b32 v30, s54, v29
  v_add3_u32 v242, v30, v28, s49
  v_mfma_f32_16x16x32_bf16 v[72:75], v[152:155], v[128:131], 0
  ds_read_b128 v[164:167], v13 offset:2048
  s_mov_b32 s16, s32
  s_mov_b32 s17, s33
  s_mov_b32 s19, 0x20000
  s_waitcnt lgkmcnt(9)
  v_mfma_f32_16x16x32_bf16 v[104:107], v[152:155], v[136:139], 0
  buffer_load_dwordx4 v9, s[8:11], s58 offen offset:1024 lds
  ds_read_b64_tr_b16 v[184:185], v16 offset:8192
  s_cmp_lt_u32 s2, 192
  s_cselect_b32 s18, 2211840, 0
  s_cselect_b32 s79, 29786112, 0
  s_cselect_b64 vcc, s[44:45], 0
  s_and_b32 s48, s2, 15
  v_mfma_f32_16x16x32_bf16 v[100:103], v[148:151], v[136:139], 0
  ds_read_b64_tr_b16 v[186:187], v16 offset:9216
  s_bfe_u32 s49, s2, 0x20004
  s_mul_i32 s49, s49, 5
  s_lshr_b32 s51, s2, 6
  v_mfma_f32_16x16x32_bf16 v[96:99], v[144:147], v[136:139], 0
  ds_read_b128 v[168:171], v13 offset:4096
  s_add_u32 s49, s49, s51
  s_add_u32 s49, s49, 2
  s_waitcnt lgkmcnt(10)
  v_mfma_f32_16x16x32_bf16 v[108:111], v[156:159], v[136:139], 0
  ds_read_b64_tr_b16 v[188:189], v17 offset:8192
  s_mul_i32 s80, s48, 20
  s_add_u32 s80, s80, s49
  s_mul_i32 s80, s80, 7
  v_mfma_f32_16x16x32_bf16 v[92:95], v[156:159], v[132:135], 0
  buffer_load_dwordx4 v10, s[8:11], s58 offen offset:2048 lds
  ds_read_b64_tr_b16 v[190:191], v17 offset:9216
  s_add_u32 s80, s80, s36
  s_lshl_b32 s80, s80, 10
  v_mfma_f32_16x16x32_bf16 v[76:79], v[156:159], v[128:131], 0
  ds_read_b128 v[172:175], v13 offset:6144
  s_add_u32 s80, s80, 21397504
  s_lshl_b32 s51, s48, 5
  s_add_u32 s51, s51, s49
  s_waitcnt lgkmcnt(12)
  v_mfma_f32_16x16x32_bf16 v[124:127], v[156:159], v[140:143], 0
  s_lshl_b32 s51, s51, 7
  s_add_u32 s51, s51, 29163392
  v_mfma_f32_16x16x32_bf16 v[120:123], v[152:155], v[140:143], 0
  s_cmp_eq_u32 s36, 0
  s_cselect_b64 vcc, vcc, 0
  v_lshl_add_u32 v28, v1, 2, s51
  v_cndmask_b32 v244, v244, v28, vcc
  v_mfma_f32_16x16x32_bf16 v[116:119], v[148:151], v[140:143], 0
  buffer_load_dwordx4 v11, s[8:11], s58 offen offset:3072 lds
  s_mul_i32 s50, s48, 216
  s_and_b32 s50, s50, -16
  v_mfma_f32_16x16x32_bf16 v[112:115], v[144:147], v[140:143], 0
  s_waitcnt lgkmcnt(0)
  v_mfma_f32_16x16x32_bf16 v[64:67], v[176:179], v[160:163], v[64:67]
  s_waitcnt vmcnt(8)
  s_barrier
  ds_read_b128 v[128:131], v12 offset:16384
  v_mfma_f32_16x16x32_bf16 v[68:71], v[180:183], v[160:163], v[68:71]
  ds_read_b64_tr_b16 v[144:145], v14 offset:16384
  s_mul_i32 s51, s49, 110592
  s_add_u32 s50, s50, s51
  v_add_u32 v28, 0, v0
  s_add_u32 s56, s56, 1
  s_cmp_eq_u32 s56, 10
  s_cselect_b32 s56, 0, s56
  s_add_u32 m0, s59, 49152
  s_lshl_b32 s57, s56, 7
  v_mfma_f32_16x16x32_bf16 v[84:87], v[180:183], v[164:167], v[84:87]
  buffer_load_dwordx4 v4, s[4:7], s57 offen offset:0 lds
  ds_read_b64_tr_b16 v[146:147], v14 offset:17408
  v_mul_u32_u24 v29, 4682, v28
  v_lshrrev_b32 v29, 16, v29
  v_mfma_f32_16x16x32_bf16 v[80:83], v[176:179], v[164:167], v[80:83]
  ds_read_b64_tr_b16 v[148:149], v15 offset:16384
  v_mul_u32_u24 v29, 3232, v29
  v_lshl_add_u32 v28, v28, 4, s50
  v_add_u32 v55, v28, v29
  v_mfma_f32_16x16x32_bf16 v[88:91], v[184:187], v[164:167], v[88:91]
  ds_read_b64_tr_b16 v[150:151], v15 offset:17408
  v_add_u32 v28, 256, v0
  v_mul_u32_u24 v29, 4682, v28
  v_mfma_f32_16x16x32_bf16 v[72:75], v[184:187], v[160:163], v[72:75]
  ds_read_b128 v[132:135], v12 offset:18432
  v_lshrrev_b32 v29, 16, v29
  v_mul_u32_u24 v29, 3232, v29
  v_lshl_add_u32 v28, v28, 4, s50
  v_mfma_f32_16x16x32_bf16 v[104:107], v[184:187], v[168:171], v[104:107]
  buffer_load_dwordx4 v5, s[4:7], s57 offen offset:1024 lds
  ds_read_b64_tr_b16 v[152:153], v16 offset:16384
  v_add_u32 v56, v28, v29
  v_cmp_gt_u32 vcc, 192, v0
  v_mfma_f32_16x16x32_bf16 v[100:103], v[180:183], v[168:171], v[100:103]
  ds_read_b64_tr_b16 v[154:155], v16 offset:17408
  v_add_u32 v28, 4096, v2
  v_lshrrev_b32 v30, 4, v1
  v_mfma_f32_16x16x32_bf16 v[96:99], v[176:179], v[168:171], v[96:99]
  ds_read_b128 v[136:139], v12 offset:20480
  v_cndmask_b32 v56, v32, v56, vcc
  v_cndmask_b32 v248, v32, v28, vcc
  v_bfe_u32 v29, v1, 2, 2
  v_mfma_f32_16x16x32_bf16 v[108:111], v[188:191], v[168:171], v[108:111]
  ds_read_b64_tr_b16 v[156:157], v17 offset:16384
  v_lshl_add_u32 v28, v30, 3, v29
  v_mul_u32_u24 v28, 224, v28
  v_mfma_f32_16x16x32_bf16 v[92:95], v[188:191], v[164:167], v[92:95]
  buffer_load_dwordx4 v6, s[4:7], s57 offen offset:2048 lds
  ds_read_b64_tr_b16 v[158:159], v17 offset:17408
  v_and_b32 v29, 3, v1
  s_and_b32 s51, s48, 1
  s_and_b32 s50, s36, 1
  v_mfma_f32_16x16x32_bf16 v[76:79], v[188:191], v[160:163], v[76:79]
  ds_read_b128 v[140:143], v12 offset:22528
  s_add_u32 s51, s51, s50
  s_and_b32 s50, s36, 2
  v_mfma_f32_16x16x32_bf16 v[124:127], v[188:191], v[172:175], v[124:127]
  s_lshl_b32 s50, s50, 5
  s_lshl3_add_u32 s51, s51, s50
  s_add_u32 s51, s51, 143360
  v_mfma_f32_16x16x32_bf16 v[120:123], v[184:187], v[172:175], v[120:123]
  v_add_u32 v28, s51, v28
  v_lshl_add_u32 v246, v29, 4, v28
  v_mfma_f32_16x16x32_bf16 v[116:119], v[180:183], v[172:175], v[116:119]
  buffer_load_dwordx4 v7, s[4:7], s57 offen offset:3072 lds
  s_cmp_eq_u32 s36, 2
  s_cselect_b32 s51, 3, 4
  s_cselect_b32 s28, 12, 16
  v_lshl_add_u32 v247, v29, s51, v28
  v_mfma_f32_16x16x32_bf16 v[112:115], v[176:179], v[172:175], v[112:115]
  s_waitcnt lgkmcnt(6)
  v_mfma_f32_16x16x32_bf16 v[64:67], v[144:147], v[128:131], v[64:67]
  ds_read_b128 v[160:163], v13 offset:16384
  s_cmp_lg_u32 s76, 1
  s_cbranch_scc1 Lsc_9
  ds_read_b128 v[192:195], v18
  ds_read_b64_tr_b16 v[208:209], v22 offset:0
  ds_read_b64_tr_b16 v[210:211], v22 offset:1024
  ds_read_b128 v[196:199], v19
  ds_read_b64_tr_b16 v[212:213], v22 offset:4096
  ds_read_b64_tr_b16 v[214:215], v22 offset:5120
  ds_read_b128 v[200:203], v20
  ds_read_b64_tr_b16 v[216:217], v22 offset:8192
  ds_read_b64_tr_b16 v[218:219], v22 offset:9216
  ds_read_b128 v[204:207], v21
  ds_read_b64_tr_b16 v[220:221], v22 offset:12288
  ds_read_b64_tr_b16 v[222:223], v22 offset:13312
Lsc_9:
  v_mfma_f32_16x16x32_bf16 v[68:71], v[148:151], v[128:131], v[68:71]
  ds_read_b64_tr_b16 v[176:177], v14 offset:24576
  v_and_b32 v32, 31, v1
  v_lshrrev_b32 v29, 5, v1
  s_add_u32 m0, s59, 114688
  s_mul_i32 s58, s56, 245760
  v_mfma_f32_16x16x32_bf16 v[84:87], v[148:151], v[132:135], v[84:87]
  buffer_load_dwordx4 v8, s[8:11], s58 offen offset:0 lds
  ds_read_b64_tr_b16 v[178:179], v14 offset:25600
  s_mov_b32 s77, 0x3f803f80
  v_mfma_f32_16x16x32_bf16 v[80:83], v[144:147], v[132:135], v[80:83]
  ds_read_b64_tr_b16 v[180:181], v15 offset:24576
  v_mov_b32 v31, 2147418112
  s_lshl2_add_u32 s50, s38, s36
  s_waitcnt lgkmcnt(4)
  v_mfma_f32_16x16x32_bf16 v[88:91], v[152:155], v[132:135], v[88:91]
  buffer_load_dwordx4 v9, s[8:11], s58 offen offset:1024 lds
  ds_read_b64_tr_b16 v[182:183], v15 offset:25600
  s_mul_i32 s50, s50, 5120
  v_mfma_f32_16x16x32_bf16 v[72:75], v[152:155], v[128:131], v[72:75]
  ds_read_b128 v[164:167], v13 offset:18432
  s_add_u32 s50, s50, 28606464
  v_mfma_f32_16x16x32_bf16 v[104:107], v[152:155], v[136:139], v[104:107]
  buffer_load_dwordx4 v10, s[8:11], s58 offen offset:2048 lds
  ds_read_b64_tr_b16 v[184:185], v16 offset:24576
  v_lshl_add_u32 v28, v32, 4, s50
  v_mul_u32_u24 v30, 2560, v29
  v_mfma_f32_16x16x32_bf16 v[100:103], v[148:151], v[136:139], v[100:103]
  ds_read_b64_tr_b16 v[186:187], v16 offset:25600
  v_add_u32 v46, v28, v30
  v_mfma_f32_16x16x32_bf16 v[96:99], v[144:147], v[136:139], v[96:99]
  buffer_load_dwordx4 v11, s[8:11], s58 offen offset:3072 lds
  ds_read_b128 v[168:171], v13 offset:20480
  s_lshl_b32 s50, s62, 9
  v_mfma_f32_16x16x32_bf16 v[108:111], v[156:159], v[136:139], v[108:111]
  ds_read_b64_tr_b16 v[188:189], v17 offset:24576
  v_add_u32 v28, s50, v28
  s_cmp_ge_u32 s39, 10
  s_cselect_b32 s50, 48, 0
  s_lshl_b32 s60, s36, 10
  s_add_u32 m0, s60, 131072
  v_mfma_f32_16x16x32_bf16 v[92:95], v[156:159], v[132:135], v[92:95]
  buffer_load_dwordx4 v52, s[24:27], 0 offen  lds
  ds_read_b64_tr_b16 v[190:191], v17 offset:25600
  v_lshrrev_b32 v30, 1, v1
  v_mfma_f32_16x16x32_bf16 v[76:79], v[156:159], v[128:131], v[76:79]
  ds_read_b128 v[172:175], v13 offset:22528
  v_xor_b32 v30, v30, v1
  s_add_u32 m0, s60, 135168
  v_mfma_f32_16x16x32_bf16 v[124:127], v[156:159], v[140:143], v[124:127]
  buffer_load_dwordx4 v53, s[24:27], 0 offen  lds
  v_and_b32 v30, 8, v30
  v_mul_u32_u24 v30, s50, v30
  v_mfma_f32_16x16x32_bf16 v[120:123], v[152:155], v[140:143], v[120:123]
  v_xor_b32 v28, v28, v30
  s_add_u32 m0, s60, 139264
  v_mfma_f32_16x16x32_bf16 v[116:119], v[148:151], v[140:143], v[116:119]
  buffer_load_dwordx4 v54, s[24:27], 0 offen  lds
  s_cmp_lt_u32 s75, 5
  s_cselect_b64 s[50:51], s[44:45], -1
  v_mfma_f32_16x16x32_bf16 v[112:115], v[144:147], v[140:143], v[112:115]
  s_waitcnt lgkmcnt(0)
  v_mfma_f32_16x16x32_bf16 v[64:67], v[176:179], v[160:163], v[64:67]
  s_waitcnt vmcnt(11)
  s_barrier
  ds_read_b128 v[128:131], v12 offset:32768
  v_mfma_f32_16x16x32_bf16 v[68:71], v[180:183], v[160:163], v[68:71]
  ds_read_b64_tr_b16 v[144:145], v14 offset:32768
  v_cndmask_b32 v44, v28, v31, s[50:51]
  s_lshl2_add_u32 s50, s39, s36
  s_add_u32 s56, s56, 1
  s_cmp_eq_u32 s56, 10
  s_cselect_b32 s56, 0, s56
  s_add_u32 m0, s59, 0
  s_lshl_b32 s57, s56, 7
  v_mfma_f32_16x16x32_bf16 v[84:87], v[180:183], v[164:167], v[84:87]
  buffer_load_dwordx4 v4, s[4:7], s57 offen offset:0 lds
  ds_read_b64_tr_b16 v[146:147], v14 offset:33792
  s_mul_i32 s50, s50, 2560
  v_mfma_f32_16x16x32_bf16 v[80:83], v[176:179], v[164:167], v[80:83]
  ds_read_b64_tr_b16 v[148:149], v15 offset:32768
  s_add_u32 s50, s50, 28934144
  v_lshl_add_u32 v28, v32, 3, s50
  v_mfma_f32_16x16x32_bf16 v[88:91], v[184:187], v[164:167], v[88:91]
  buffer_load_dwordx4 v5, s[4:7], s57 offen offset:1024 lds
  ds_read_b64_tr_b16 v[150:151], v15 offset:33792
  v_mul_u32_u24 v30, 1280, v29
  v_mfma_f32_16x16x32_bf16 v[72:75], v[184:187], v[160:163], v[72:75]
  ds_read_b128 v[132:135], v12 offset:34816
  v_add_u32 v47, v28, v30
  v_mfma_f32_16x16x32_bf16 v[104:107], v[184:187], v[168:171], v[104:107]
  buffer_load_dwordx4 v6, s[4:7], s57 offen offset:2048 lds
  ds_read_b64_tr_b16 v[152:153], v16 offset:32768
  s_lshl_b32 s50, s62, 8
  v_add_u32 v28, s50, v28
  v_mfma_f32_16x16x32_bf16 v[100:103], v[180:183], v[168:171], v[100:103]
  ds_read_b64_tr_b16 v[154:155], v16 offset:33792
  s_cmp_lt_u32 s74, 5
  s_cselect_b64 s[50:51], s[44:45], -1
  v_mfma_f32_16x16x32_bf16 v[96:99], v[176:179], v[168:171], v[96:99]
  ds_read_b128 v[136:139], v12 offset:36864
  v_cndmask_b32 v45, v28, v31, s[50:51]
  v_mfma_f32_16x16x32_bf16 v[108:111], v[188:191], v[168:171], v[108:111]
  buffer_load_dwordx4 v7, s[4:7], s57 offen offset:3072 lds
  ds_read_b64_tr_b16 v[156:157], v17 offset:32768
  s_lshl_b32 s50, s36, 7
  s_add_u32 s50, s50, 153600
  v_mfma_f32_16x16x32_bf16 v[92:95], v[188:191], v[164:167], v[92:95]
  ds_read_b64_tr_b16 v[158:159], v17 offset:33792
  v_lshl_add_u32 v50, v32, 2, s50
  s_add_u32 m0, s60, 143360
  v_mfma_f32_16x16x32_bf16 v[76:79], v[188:191], v[160:163], v[76:79]
  buffer_load_dwordx4 v55, s[16:19], 0 offen  lds
  ds_read_b128 v[140:143], v12 offset:38912
  s_and_b32 s48, s2, 7
  v_mfma_f32_16x16x32_bf16 v[124:127], v[188:191], v[172:175], v[124:127]
  s_lshr_b32 s49, s2, 3
  s_lshr_b32 s40, s49, 3
  s_add_u32 m0, s60, 147456
  v_mfma_f32_16x16x32_bf16 v[120:123], v[184:187], v[172:175], v[120:123]
  buffer_load_dwordx4 v56, s[16:19], 0 offen  lds
  s_lshl2_add_u32 s40, s48, s40
  v_mfma_f32_16x16x32_bf16 v[116:119], v[180:183], v[172:175], v[116:119]
  s_and_b32 s41, s49, 7
  v_mfma_f32_16x16x32_bf16 v[112:115], v[176:179], v[172:175], v[112:115]
  s_waitcnt lgkmcnt(6)
  v_mfma_f32_16x16x32_bf16 v[64:67], v[144:147], v[128:131], v[64:67]
  ds_read_b128 v[160:163], v13 offset:32768
  s_cmp_lg_u32 s76, 2
  s_cbranch_scc1 Lsc_10
  ds_read_b128 v[192:195], v18
  ds_read_b64_tr_b16 v[208:209], v22 offset:0
  ds_read_b64_tr_b16 v[210:211], v22 offset:1024
  ds_read_b128 v[196:199], v19
  ds_read_b64_tr_b16 v[212:213], v22 offset:4096
  ds_read_b64_tr_b16 v[214:215], v22 offset:5120
  ds_read_b128 v[200:203], v20
  ds_read_b64_tr_b16 v[216:217], v22 offset:8192
  ds_read_b64_tr_b16 v[218:219], v22 offset:9216
  ds_read_b128 v[204:207], v21
  ds_read_b64_tr_b16 v[220:221], v22 offset:12288
  ds_read_b64_tr_b16 v[222:223], v22 offset:13312
Lsc_10:
  v_mfma_f32_16x16x32_bf16 v[68:71], v[148:151], v[128:131], v[68:71]
  ds_read_b64_tr_b16 v[176:177], v14 offset:40960
  s_lshr_b32 s42, s40, 1
  s_and_b32 s85, s2, 1
  s_add_u32 m0, s59, 65536
  s_mul_i32 s58, s56, 245760
  v_mfma_f32_16x16x32_bf16 v[84:87], v[148:151], v[132:135], v[84:87]
  buffer_load_dwordx4 v8, s[8:11], s58 offen offset:0 lds
  ds_read_b64_tr_b16 v[178:179], v14 offset:41984
  s_lshl3_add_u32 s43, s85, s41
  v_mfma_f32_16x16x32_bf16 v[80:83], v[144:147], v[132:135], v[80:83]
  ds_read_b64_tr_b16 v[180:181], v15 offset:40960
  s_andn2_b32 s3, s40, 4
  s_and_b32 s48, s36, 2
  s_waitcnt lgkmcnt(4)
  v_mfma_f32_16x16x32_bf16 v[88:91], v[152:155], v[132:135], v[88:91]
  ds_read_b64_tr_b16 v[182:183], v15 offset:41984
  s_lshl1_add_u32 s3, s48, s3
  v_mfma_f32_16x16x32_bf16 v[72:75], v[152:155], v[128:131], v[72:75]
  ds_read_b128 v[164:167], v13 offset:34816
  s_and_b32 s48, s36, 1
  v_mfma_f32_16x16x32_bf16 v[104:107], v[152:155], v[136:139], v[104:107]
  buffer_load_dwordx4 v9, s[8:11], s58 offen offset:1024 lds
  ds_read_b64_tr_b16 v[184:185], v16 offset:40960
  s_lshl1_add_u32 s3, s3, s48
  s_lshl2_add_u32 s47, s41, s36
  v_mfma_f32_16x16x32_bf16 v[100:103], v[148:151], v[136:139], v[100:103]
  ds_read_b64_tr_b16 v[186:187], v16 offset:41984
  s_and_b32 s93, s41, 0
  v_mfma_f32_16x16x32_bf16 v[96:99], v[144:147], v[136:139], v[96:99]
  ds_read_b128 v[168:171], v13 offset:36864
  s_xor_b32 s93, s93, s36
  v_mfma_f32_16x16x32_bf16 v[108:111], v[156:159], v[136:139], v[108:111]
  ds_read_b64_tr_b16 v[188:189], v17 offset:40960
  s_getreg_b32 s87, hwreg(HW_REG_XCC_ID, 0, 4)
  s_mul_i32 s90, s47, 25600
  v_mfma_f32_16x16x32_bf16 v[92:95], v[156:159], v[132:135], v[92:95]
  buffer_load_dwordx4 v10, s[8:11], s58 offen offset:2048 lds
  ds_read_b64_tr_b16 v[190:191], v17 offset:41984
  s_add_u32 s90, s90, 20582400
  v_mfma_f32_16x16x32_bf16 v[76:79], v[156:159], v[128:131], v[76:79]
  ds_read_b128 v[172:175], v13 offset:38912
  s_lshl2_add_u32 s91, s43, s36
  v_mfma_f32_16x16x32_bf16 v[124:127], v[156:159], v[140:143], v[124:127]
  s_mul_i32 s91, s91, 35840
  s_add_u32 s91, s91, 21397504
  v_mfma_f32_16x16x32_bf16 v[120:123], v[152:155], v[140:143], v[120:123]
  s_mul_i32 s95, s36, 35840
  v_mfma_f32_16x16x32_bf16 v[116:119], v[148:151], v[140:143], v[116:119]
  buffer_load_dwordx4 v11, s[8:11], s58 offen offset:3072 lds
  s_lshl2_add_u32 s85, s85, s36
  v_mfma_f32_16x16x32_bf16 v[112:115], v[144:147], v[140:143], v[112:115]
  s_waitcnt lgkmcnt(0)
  v_mfma_f32_16x16x32_bf16 v[64:67], v[176:179], v[160:163], v[64:67]
  s_waitcnt vmcnt(13)
  s_barrier
  ds_read_b128 v[128:131], v12 offset:49152
  v_mfma_f32_16x16x32_bf16 v[68:71], v[180:183], v[160:163], v[68:71]
  ds_read_b64_tr_b16 v[144:145], v14 offset:49152
  s_lshl3_add_u32 s92, s41, s85
  s_mul_i32 s92, s92, 35840
  s_add_u32 s56, s56, 1
  s_cmp_eq_u32 s56, 10
  s_cselect_b32 s56, 0, s56
  s_add_u32 m0, s59, 16384
  s_lshl_b32 s57, s56, 7
  v_mfma_f32_16x16x32_bf16 v[84:87], v[180:183], v[164:167], v[84:87]
  buffer_load_dwordx4 v4, s[4:7], s57 offen offset:0 lds
  ds_read_b64_tr_b16 v[146:147], v14 offset:50176
  s_add_u32 s92, s92, 23695360
  v_mfma_f32_16x16x32_bf16 v[80:83], v[176:179], v[164:167], v[80:83]
  ds_read_b64_tr_b16 v[148:149], v15 offset:49152
  s_mul_i32 s48, s36, 640
  v_mfma_f32_16x16x32_bf16 v[88:91], v[184:187], v[164:167], v[88:91]
  ds_read_b64_tr_b16 v[150:151], v15 offset:50176
  s_lshl_b32 s49, s41, 12
  s_add_u32 s48, s48, s49
  v_mfma_f32_16x16x32_bf16 v[72:75], v[184:187], v[160:163], v[72:75]
  ds_read_b128 v[132:135], v12 offset:51200
  s_add_u32 s48, s48, 262144
  v_mfma_f32_16x16x32_bf16 v[104:107], v[184:187], v[168:171], v[104:107]
  buffer_load_dwordx4 v5, s[4:7], s57 offen offset:1024 lds
  ds_read_b64_tr_b16 v[152:153], v16 offset:49152
  v_min_u32 v59, 4, v1
  v_mfma_f32_16x16x32_bf16 v[100:103], v[180:183], v[168:171], v[100:103]
  ds_read_b64_tr_b16 v[154:155], v16 offset:50176
  v_lshl_add_u32 v59, v59, 7, s48
  v_mfma_f32_16x16x32_bf16 v[96:99], v[176:179], v[168:171], v[96:99]
  ds_read_b128 v[136:139], v12 offset:53248
  s_lshl3_add_u32 s48, s40, s41
  s_lshl_b32 s48, s48, 7
  v_mfma_f32_16x16x32_bf16 v[108:111], v[188:191], v[168:171], v[108:111]
  ds_read_b64_tr_b16 v[156:157], v17 offset:49152
  s_add_u32 s48, s48, 29229056
  v_mfma_f32_16x16x32_bf16 v[92:95], v[188:191], v[164:167], v[92:95]
  buffer_load_dwordx4 v6, s[4:7], s57 offen offset:2048 lds
  ds_read_b64_tr_b16 v[158:159], v17 offset:50176
  s_add_u32 s49, s37, s87
  v_mfma_f32_16x16x32_bf16 v[76:79], v[188:191], v[160:163], v[76:79]
  ds_read_b128 v[140:143], v12 offset:55296
  v_mov_b32 v61, s49
  v_lshrrev_b32 v62, 5, v0
  v_mfma_f32_16x16x32_bf16 v[124:127], v[188:191], v[172:175], v[124:127]
  v_lshlrev_b32 v62, 27, v62
  v_mfma_f32_16x16x32_bf16 v[120:123], v[184:187], v[172:175], v[120:123]
  v_lshl_add_u32 v62, v0, 2, v62
  v_mfma_f32_16x16x32_bf16 v[116:119], v[180:183], v[172:175], v[116:119]
  buffer_load_dwordx4 v7, s[4:7], s57 offen offset:3072 lds
  buffer_store_dword v61, v62, s[12:15], s48 offen sc1
  v_mfma_f32_16x16x32_bf16 v[112:115], v[176:179], v[172:175], v[112:115]
  s_waitcnt lgkmcnt(6)
  v_mfma_f32_16x16x32_bf16 v[64:67], v[144:147], v[128:131], v[64:67]
  ds_read_b128 v[160:163], v13 offset:49152
  s_cmp_lg_u32 s76, 3
  s_cbranch_scc1 Lsc_11
  ds_read_b128 v[192:195], v18
  ds_read_b64_tr_b16 v[208:209], v22 offset:0
  ds_read_b64_tr_b16 v[210:211], v22 offset:1024
  ds_read_b128 v[196:199], v19
  ds_read_b64_tr_b16 v[212:213], v22 offset:4096
  ds_read_b64_tr_b16 v[214:215], v22 offset:5120
  ds_read_b128 v[200:203], v20
  ds_read_b64_tr_b16 v[216:217], v22 offset:8192
  ds_read_b64_tr_b16 v[218:219], v22 offset:9216
  ds_read_b128 v[204:207], v21
  ds_read_b64_tr_b16 v[220:221], v22 offset:12288
  ds_read_b64_tr_b16 v[222:223], v22 offset:13312
Lsc_11:
  v_mfma_f32_16x16x32_bf16 v[68:71], v[148:151], v[128:131], v[68:71]
  ds_read_b64_tr_b16 v[176:177], v14 offset:57344
  s_lshr_b32 s48, s36, 1
  s_add_u32 m0, s59, 81920
  s_mul_i32 s58, s56, 245760
  v_mfma_f32_16x16x32_bf16 v[84:87], v[148:151], v[132:135], v[84:87]
  buffer_load_dwordx4 v8, s[8:11], s58 offen offset:0 lds
  ds_read_b64_tr_b16 v[178:179], v14 offset:58368
  v_mfma_f32_16x16x32_bf16 v[80:83], v[144:147], v[132:135], v[80:83]
  ds_read_b64_tr_b16 v[180:181], v15 offset:57344
  s_waitcnt lgkmcnt(4)
  v_mfma_f32_16x16x32_bf16 v[88:91], v[152:155], v[132:135], v[88:91]
  ds_read_b64_tr_b16 v[182:183], v15 offset:58368
  v_mfma_f32_16x16x32_bf16 v[72:75], v[152:155], v[128:131], v[72:75]
  ds_read_b128 v[164:167], v13 offset:51200
  s_and_b32 s49, s36, 1
  v_mfma_f32_16x16x32_bf16 v[104:107], v[152:155], v[136:139], v[104:107]
  buffer_load_dwordx4 v9, s[8:11], s58 offen offset:1024 lds
  ds_read_b64_tr_b16 v[184:185], v16 offset:57344
  v_mfma_f32_16x16x32_bf16 v[100:103], v[148:151], v[136:139], v[100:103]
  ds_read_b64_tr_b16 v[186:187], v16 offset:58368
  v_mfma_f32_16x16x32_bf16 v[96:99], v[144:147], v[136:139], v[96:99]
  ds_read_b128 v[168:171], v13 offset:53248
  v_mfma_f32_16x16x32_bf16 v[108:111], v[156:159], v[136:139], v[108:111]
  ds_read_b64_tr_b16 v[188:189], v17 offset:57344
  v_mfma_f32_16x16x32_bf16 v[92:95], v[156:159], v[132:135], v[92:95]
  buffer_load_dwordx4 v10, s[8:11], s58 offen offset:2048 lds
  ds_read_b64_tr_b16 v[190:191], v17 offset:58368
  s_lshl1_add_u32 s50, s38, s48
  v_mfma_f32_16x16x32_bf16 v[76:79], v[156:159], v[128:131], v[76:79]
  ds_read_b128 v[172:175], v13 offset:55296
  v_mfma_f32_16x16x32_bf16 v[124:127], v[156:159], v[140:143], v[124:127]
  v_mfma_f32_16x16x32_bf16 v[120:123], v[152:155], v[140:143], v[120:123]
  v_mfma_f32_16x16x32_bf16 v[116:119], v[148:151], v[140:143], v[116:119]
  buffer_load_dwordx4 v11, s[8:11], s58 offen offset:3072 lds
  v_mfma_f32_16x16x32_bf16 v[112:115], v[144:147], v[140:143], v[112:115]
  s_waitcnt lgkmcnt(0)
  v_mfma_f32_16x16x32_bf16 v[64:67], v[176:179], v[160:163], v[64:67]
  s_waitcnt vmcnt(9)
  s_barrier
  ds_read_b128 v[128:131], v12 offset:0
  v_mfma_f32_16x16x32_bf16 v[68:71], v[180:183], v[160:163], v[68:71]
  ds_read_b64_tr_b16 v[144:145], v14 offset:0
  s_lshl1_add_u32 s51, s39, s49
  s_add_u32 s56, s56, 1
  s_cmp_eq_u32 s56, 10
  s_cselect_b32 s56, 0, s56
  s_add_u32 m0, s59, 32768
  s_lshl_b32 s57, s56, 7
  v_mfma_f32_16x16x32_bf16 v[84:87], v[180:183], v[164:167], v[84:87]
  buffer_load_dwordx4 v4, s[4:7], s57 offen offset:0 lds
  ds_read_b64_tr_b16 v[146:147], v14 offset:1024
  v_mfma_f32_16x16x32_bf16 v[80:83], v[176:179], v[164:167], v[80:83]
  ds_read_b64_tr_b16 v[148:149], v15 offset:0
  v_mfma_f32_16x16x32_bf16 v[88:91], v[184:187], v[164:167], v[88:91]
  ds_read_b64_tr_b16 v[150:151], v15 offset:1024
  v_mfma_f32_16x16x32_bf16 v[72:75], v[184:187], v[160:163], v[72:75]
  ds_read_b128 v[132:135], v12 offset:2048
  s_lshl_b32 s48, s48, 8
  v_mfma_f32_16x16x32_bf16 v[104:107], v[184:187], v[168:171], v[104:107]
  buffer_load_dwordx4 v5, s[4:7], s57 offen offset:1024 lds
  ds_read_b64_tr_b16 v[152:153], v16 offset:0
  v_mfma_f32_16x16x32_bf16 v[100:103], v[180:183], v[168:171], v[100:103]
  ds_read_b64_tr_b16 v[154:155], v16 offset:1024
  v_mfma_f32_16x16x32_bf16 v[96:99], v[176:179], v[168:171], v[96:99]
  ds_read_b128 v[136:139], v12 offset:4096
  v_mfma_f32_16x16x32_bf16 v[108:111], v[188:191], v[168:171], v[108:111]
  ds_read_b64_tr_b16 v[156:157], v17 offset:0
  v_mfma_f32_16x16x32_bf16 v[92:95], v[188:191], v[164:167], v[92:95]
  buffer_load_dwordx4 v6, s[4:7], s57 offen offset:2048 lds
  ds_read_b64_tr_b16 v[158:159], v17 offset:1024
  s_add_u32 s48, s48, 153600
  v_mfma_f32_16x16x32_bf16 v[76:79], v[188:191], v[160:163], v[76:79]
  ds_read_b128 v[140:143], v12 offset:6144
  v_mfma_f32_16x16x32_bf16 v[124:127], v[188:191], v[172:175], v[124:127]
  v_mfma_f32_16x16x32_bf16 v[120:123], v[184:187], v[172:175], v[120:123]
  v_mfma_f32_16x16x32_bf16 v[116:119], v[180:183], v[172:175], v[116:119]
  buffer_load_dwordx4 v7, s[4:7], s57 offen offset:3072 lds
  v_mfma_f32_16x16x32_bf16 v[112:115], v[176:179], v[172:175], v[112:115]
  s_waitcnt lgkmcnt(6)
  v_mfma_f32_16x16x32_bf16 v[64:67], v[144:147], v[128:131], v[64:67]
  ds_read_b128 v[160:163], v13 offset:0
  s_cmp_lg_u32 s76, 4
  s_cbranch_scc1 Lsc_12
  ds_read_b128 v[192:195], v18
  ds_read_b64_tr_b16 v[208:209], v22 offset:0
  ds_read_b64_tr_b16 v[210:211], v22 offset:1024
  ds_read_b128 v[196:199], v19
  ds_read_b64_tr_b16 v[212:213], v22 offset:4096
  ds_read_b64_tr_b16 v[214:215], v22 offset:5120
  ds_read_b128 v[200:203], v20
  ds_read_b64_tr_b16 v[216:217], v22 offset:8192
  ds_read_b64_tr_b16 v[218:219], v22 offset:9216
  ds_read_b128 v[204:207], v21
  ds_read_b64_tr_b16 v[220:221], v22 offset:12288
  ds_read_b64_tr_b16 v[222:223], v22 offset:13312
Lsc_12:
  v_mfma_f32_16x16x32_bf16 v[68:71], v[148:151], v[128:131], v[68:71]
  ds_read_b64_tr_b16 v[176:177], v14 offset:8192
  s_lshl_b32 s49, s49, 8
  s_add_u32 m0, s59, 98304
  s_mul_i32 s58, s56, 245760
  v_mfma_f32_16x16x32_bf16 v[84:87], v[148:151], v[132:135], v[84:87]
  buffer_load_dwordx4 v8, s[8:11], s58 offen offset:0 lds
  ds_read_b64_tr_b16 v[178:179], v14 offset:9216
  ds_read_b64_tr_b16 v[24:25], v240 offset:0
  v_mfma_f32_16x16x32_bf16 v[80:83], v[144:147], v[132:135], v[80:83]
  ds_read_b64_tr_b16 v[180:181], v15 offset:8192
  ds_read_b64_tr_b16 v[26:27], v240 offset:1280
  s_waitcnt lgkmcnt(6)
  v_mfma_f32_16x16x32_bf16 v[88:91], v[152:155], v[132:135], v[88:91]
  ds_read_b64_tr_b16 v[182:183], v15 offset:9216
  ds_read_b64_tr_b16 v[224:225], v241 offset:0
  v_mfma_f32_16x16x32_bf16 v[72:75], v[152:155], v[128:131], v[72:75]
  ds_read_b128 v[164:167], v13 offset:2048
  ds_read_b64_tr_b16 v[226:227], v241 offset:1280
  v_mfma_f32_16x16x32_bf16 v[104:107], v[152:155], v[136:139], v[104:107]
  buffer_load_dwordx4 v9, s[8:11], s58 offen offset:1024 lds
  ds_read_b64_tr_b16 v[184:185], v16 offset:8192
  s_add_u32 s49, s49, 154624
  v_mfma_f32_16x16x32_bf16 v[100:103], v[148:151], v[136:139], v[100:103]
  ds_read_b64_tr_b16 v[186:187], v16 offset:9216
  ds_read_b64_tr_b16 v[228:229], v242 offset:0
  v_mfma_f32_16x16x32_bf16 v[96:99], v[144:147], v[136:139], v[96:99]
  ds_read_b128 v[168:171], v13 offset:4096
  ds_read_b64_tr_b16 v[230:231], v242 offset:1280
  s_waitcnt lgkmcnt(12)
  v_dot2_f32_bf16 v36, v192, s77, 0
  v_dot2_f32_bf16 v38, v192, v192, 0
  v_dot2_f32_bf16 v40, v208, s77, 0
  v_dot2_f32_bf16 v36, v193, s77, v36
  v_dot2_f32_bf16 v38, v193, v193, v38
  v_dot2_f32_bf16 v40, v209, s77, v40
  v_dot2_f32_bf16 v36, v194, s77, v36
  v_dot2_f32_bf16 v38, v194, v194, v38
  v_dot2_f32_bf16 v40, v210, s77, v40
  v_dot2_f32_bf16 v36, v195, s77, v36
  v_dot2_f32_bf16 v38, v195, v195, v38
  v_dot2_f32_bf16 v40, v211, s77, v40
  v_dot2_f32_bf16 v36, v196, s77, v36
  v_dot2_f32_bf16 v38, v196, v196, v38
  v_dot2_f32_bf16 v40, v212, s77, v40
  v_dot2_f32_bf16 v36, v197, s77, v36
  v_dot2_f32_bf16 v38, v197, v197, v38
  v_dot2_f32_bf16 v40, v213, s77, v40
  v_dot2_f32_bf16 v36, v198, s77, v36
  v_dot2_f32_bf16 v38, v198, v198, v38
  v_dot2_f32_bf16 v40, v214, s77, v40
  v_dot2_f32_bf16 v36, v199, s77, v36
  v_dot2_f32_bf16 v38, v199, v199, v38
  v_dot2_f32_bf16 v40, v215, s77, v40
  v_dot2_f32_bf16 v36, v200, s77, v36
  v_dot2_f32_bf16 v38, v200, v200, v38
  v_dot2_f32_bf16 v40, v216, s77, v40
  v_dot2_f32_bf16 v36, v201, s77, v36
  v_dot2_f32_bf16 v38, v201, v201, v38
  v_dot2_f32_bf16 v40, v217, s77, v40
  v_dot2_f32_bf16 v36, v202, s77, v36
  v_dot2_f32_bf16 v38, v202, v202, v38
  v_dot2_f32_bf16 v40, v218, s77, v40
  v_dot2_f32_bf16 v36, v203, s77, v36
  v_dot2_f32_bf16 v38, v203, v203, v38
  v_dot2_f32_bf16 v40, v219, s77, v40
  v_dot2_f32_bf16 v36, v204, s77, v36
  v_dot2_f32_bf16 v38, v204, v204, v38
  v_dot2_f32_bf16 v40, v220, s77, v40
  v_dot2_f32_bf16 v36, v205, s77, v36
  v_dot2_f32_bf16 v38, v205, v205, v38
  v_dot2_f32_bf16 v40, v221, s77, v40
  v_dot2_f32_bf16 v36, v206, s77, v36
  v_dot2_f32_bf16 v38, v206, v206, v38
  v_dot2_f32_bf16 v40, v222, s77, v40
  v_dot2_f32_bf16 v36, v207, s77, v36
  v_dot2_f32_bf16 v38, v207, v207, v38
  v_dot2_f32_bf16 v40, v223, s77, v40
  v_mfma_f32_16x16x32_bf16 v[108:111], v[156:159], v[136:139], v[108:111]
  ds_read_b64_tr_b16 v[188:189], v17 offset:8192
  ds_read_b64_tr_b16 v[232:233], v246 offset:0
  v_mfma_f32_16x16x32_bf16 v[92:95], v[156:159], v[132:135], v[92:95]
  buffer_load_dwordx4 v10, s[8:11], s58 offen offset:2048 lds
  ds_read_b64_tr_b16 v[190:191], v17 offset:9216
  v_lshrrev_b32 v32, 4, v1
  v_mfma_f32_16x16x32_bf16 v[76:79], v[156:159], v[128:131], v[76:79]
  ds_read_b128 v[172:175], v13 offset:6144
  ds_read_b64_tr_b16 v[234:235], v246 offset:896
  v_mov_b32 v37, v36
  v_mov_b32 v39, v38
  v_mov_b32 v41, v40
  v_mfma_f32_16x16x32_bf16 v[124:127], v[156:159], v[140:143], v[124:127]
  ds_read_b64_tr_b16 v[236:237], v247 offset:128
  v_permlane32_swap_b32 v36, v37
  v_permlane32_swap_b32 v38, v39
  v_permlane32_swap_b32 v40, v41
  v_mfma_f32_16x16x32_bf16 v[120:123], v[152:155], v[140:143], v[120:123]
  ds_read_b64_tr_b16 v[238:239], v247 offset:1024
  v_add_f32 v36, v36, v37
  v_add_f32 v38, v38, v39
  v_add_f32 v40, v40, v41
  v_mfma_f32_16x16x32_bf16 v[116:119], v[148:151], v[140:143], v[116:119]
  buffer_load_dwordx4 v11, s[8:11], s58 offen offset:3072 lds
  v_mov_b32 v37, s37
  v_mov_b32 v39, s37
  v_mov_b32 v41, s37
  v_mfma_f32_16x16x32_bf16 v[112:115], v[144:147], v[140:143], v[112:115]
  buffer_store_dwordx4 v[36:39], v44, s[12:15], 0 offen sc1
  buffer_store_dwordx2 v[40:41], v45, s[12:15], 0 offen sc1
  s_waitcnt lgkmcnt(3)
  v_mfma_f32_16x16x32_bf16 v[64:67], v[176:179], v[160:163], v[64:67]
  s_waitcnt vmcnt(10)
  s_barrier
  ds_read_b128 v[128:131], v12 offset:16384
  v_mfma_f32_16x16x32_bf16 v[68:71], v[180:183], v[160:163], v[68:71]
  ds_read_b64_tr_b16 v[144:145], v14 offset:16384
  v_and_b32 v246, 15, v1
  s_add_u32 s56, s56, 1
  s_cmp_eq_u32 s56, 10
  s_cselect_b32 s56, 0, s56
  s_add_u32 m0, s59, 49152
  s_lshl_b32 s57, s56, 7
  v_mfma_f32_16x16x32_bf16 v[84:87], v[180:183], v[164:167], v[84:87]
  buffer_load_dwordx4 v4, s[4:7], s57 offen offset:0 lds
  ds_read_b64_tr_b16 v[146:147], v14 offset:17408
  v_cmp_gt_u32 vcc, s28, v246
  v_mfma_f32_16x16x32_bf16 v[80:83], v[176:179], v[164:167], v[80:83]
  ds_read_b64_tr_b16 v[148:149], v15 offset:16384
  s_mov_b64 s[24:25], s[12:13]
  s_mov_b32 s26, s100
  v_mfma_f32_16x16x32_bf16 v[88:91], v[184:187], v[164:167], v[88:91]
  buffer_store_dwordx4 v[24:27], v2, s[24:27], s82 offen sc1
  ds_read_b64_tr_b16 v[150:151], v15 offset:17408
  s_waitcnt lgkmcnt(6)
  v_cndmask_b32 v236, 0, v236, vcc
  v_mfma_f32_16x16x32_bf16 v[72:75], v[184:187], v[160:163], v[72:75]
  ds_read_b128 v[132:135], v12 offset:18432
  v_cndmask_b32 v237, 0, v237, vcc
  v_mfma_f32_16x16x32_bf16 v[104:107], v[184:187], v[168:171], v[104:107]
  ds_read_b64_tr_b16 v[152:153], v16 offset:16384
  v_mfma_f32_16x16x32_bf16 v[100:103], v[180:183], v[168:171], v[100:103]
  buffer_load_dwordx4 v5, s[4:7], s57 offen offset:1024 lds
  ds_read_b64_tr_b16 v[154:155], v16 offset:17408
  s_waitcnt lgkmcnt(8)
  v_cndmask_b32 v238, 0, v238, vcc
  v_mfma_f32_16x16x32_bf16 v[96:99], v[176:179], v[168:171], v[96:99]
  ds_read_b128 v[136:139], v12 offset:20480
  v_cndmask_b32 v239, 0, v239, vcc
  v_mfma_f32_16x16x32_bf16 v[108:111], v[188:191], v[168:171], v[108:111]
  ds_read_b64_tr_b16 v[156:157], v17 offset:16384
  v_mfma_f32_16x16x32_bf16 v[92:95], v[188:191], v[164:167], v[92:95]
  buffer_load_dwordx4 v6, s[4:7], s57 offen offset:2048 lds
  ds_read_b64_tr_b16 v[158:159], v17 offset:17408
  v_and_b32 v33, 15, v1
  v_mfma_f32_16x16x32_bf16 v[76:79], v[188:191], v[160:163], v[76:79]
  ds_read_b128 v[140:143], v12 offset:22528
  v_lshl_add_u32 v28, v33, 2, s48
  v_mfma_f32_16x16x32_bf16 v[124:127], v[188:191], v[172:175], v[124:127]
  v_mfma_f32_16x16x32_bf16 v[120:123], v[184:187], v[172:175], v[120:123]
  buffer_load_dwordx4 v7, s[4:7], s57 offen offset:3072 lds
  v_lshl_add_u32 v29, v32, 4, s49
  v_mfma_f32_16x16x32_bf16 v[116:119], v[180:183], v[172:175], v[116:119]
  v_mfma_f32_16x16x32_bf16 v[112:115], v[176:179], v[172:175], v[112:115]
  s_waitcnt lgkmcnt(6)
  v_mfma_f32_16x16x32_bf16 v[64:67], v[144:147], v[128:131], v[64:67]
  ds_read_b128 v[160:163], v13 offset:16384
  v_mfma_f32_16x16x32_bf16 v[68:71], v[148:151], v[128:131], v[68:71]
  ds_read_b64_tr_b16 v[176:177], v14 offset:24576
  v_mul_u32_u24 v32, 256, v32
  s_add_u32 m0, s59, 114688
  s_mul_i32 s58, s56, 245760
  v_mfma_f32_16x16x32_bf16 v[84:87], v[148:151], v[132:135], v[84:87]
  buffer_load_dwordx4 v8, s[8:11], s58 offen offset:0 lds
  ds_read_b64_tr_b16 v[178:179], v14 offset:25600
  v_mfma_f32_16x16x32_bf16 v[80:83], v[144:147], v[132:135], v[80:83]
  ds_read_b64_tr_b16 v[180:181], v15 offset:24576
  s_waitcnt lgkmcnt(4)
  v_mfma_f32_16x16x32_bf16 v[88:91], v[152:155], v[132:135], v[88:91]
  buffer_store_dwordx4 v[224:227], v2, s[24:27], s83 offen sc1
  ds_read_b64_tr_b16 v[182:183], v15 offset:25600
  v_mfma_f32_16x16x32_bf16 v[72:75], v[152:155], v[128:131], v[72:75]
  ds_read_b128 v[164:167], v13 offset:18432
  v_add_u32 v32, v2, v32
  v_mfma_f32_16x16x32_bf16 v[104:107], v[152:155], v[136:139], v[104:107]
  ds_read_b64_tr_b16 v[184:185], v16 offset:24576
  v_mfma_f32_16x16x32_bf16 v[100:103], v[148:151], v[136:139], v[100:103]
  buffer_load_dwordx4 v9, s[8:11], s58 offen offset:1024 lds
  ds_read_b64_tr_b16 v[186:187], v16 offset:25600
  v_mfma_f32_16x16x32_bf16 v[96:99], v[144:147], v[136:139], v[96:99]
  ds_read_b128 v[168:171], v13 offset:20480
  v_mfma_f32_16x16x32_bf16 v[108:111], v[156:159], v[136:139], v[108:111]
  ds_read_b64_tr_b16 v[188:189], v17 offset:24576
  v_mfma_f32_16x16x32_bf16 v[92:95], v[156:159], v[132:135], v[92:95]
  buffer_load_dwordx4 v10, s[8:11], s58 offen offset:2048 lds
  ds_read_b64_tr_b16 v[190:191], v17 offset:25600
  s_lshl4_add_u32 s61, s38, s39
  v_mfma_f32_16x16x32_bf16 v[76:79], v[156:159], v[128:131], v[76:79]
  ds_read_b128 v[172:175], v13 offset:22528
  v_mfma_f32_16x16x32_bf16 v[124:127], v[156:159], v[140:143], v[124:127]
  v_mfma_f32_16x16x32_bf16 v[120:123], v[152:155], v[140:143], v[120:123]
  buffer_load_dwordx4 v11, s[8:11], s58 offen offset:3072 lds
  v_mfma_f32_16x16x32_bf16 v[116:119], v[148:151], v[140:143], v[116:119]
  v_mfma_f32_16x16x32_bf16 v[112:115], v[144:147], v[140:143], v[112:115]
  s_waitcnt lgkmcnt(0)
  v_mfma_f32_16x16x32_bf16 v[64:67], v[176:179], v[160:163], v[64:67]
  s_waitcnt vmcnt(12)
  s_barrier
  ds_read_b128 v[128:131], v12 offset:32768
  v_mfma_f32_16x16x32_bf16 v[68:71], v[180:183], v[160:163], v[68:71]
  ds_read_b64_tr_b16 v[144:145], v14 offset:32768
  s_lshl_b32 s61, s61, 7
  s_add_u32 s56, s56, 1
  s_cmp_eq_u32 s56, 10
  s_cselect_b32 s56, 0, s56
  s_add_u32 m0, s59, 0
  s_lshl_b32 s57, s56, 7
  v_mfma_f32_16x16x32_bf16 v[84:87], v[180:183], v[164:167], v[84:87]
  buffer_load_dwordx4 v4, s[4:7], s57 offen offset:0 lds
  ds_read_b64_tr_b16 v[146:147], v14 offset:33792
  v_mfma_f32_16x16x32_bf16 v[80:83], v[176:179], v[164:167], v[80:83]
  ds_read_b64_tr_b16 v[148:149], v15 offset:32768
  v_mfma_f32_16x16x32_bf16 v[88:91], v[184:187], v[164:167], v[88:91]
  buffer_store_dwordx4 v[228:231], v243, s[24:27], s84 offen sc1
  ds_read_b64_tr_b16 v[150:151], v15 offset:33792
  v_mfma_f32_16x16x32_bf16 v[72:75], v[184:187], v[160:163], v[72:75]
  ds_read_b128 v[132:135], v12 offset:34816
  s_add_u32 s61, s61, 29327360
  v_mfma_f32_16x16x32_bf16 v[104:107], v[184:187], v[168:171], v[104:107]
  ds_read_b64_tr_b16 v[152:153], v16 offset:32768
  v_mfma_f32_16x16x32_bf16 v[100:103], v[180:183], v[168:171], v[100:103]
  buffer_load_dwordx4 v5, s[4:7], s57 offen offset:1024 lds
  ds_read_b64_tr_b16 v[154:155], v16 offset:33792
  v_mfma_f32_16x16x32_bf16 v[96:99], v[176:179], v[168:171], v[96:99]
  ds_read_b128 v[136:139], v12 offset:36864
  v_mfma_f32_16x16x32_bf16 v[108:111], v[188:191], v[168:171], v[108:111]
  ds_read_b64_tr_b16 v[156:157], v17 offset:32768
  v_mfma_f32_16x16x32_bf16 v[92:95], v[188:191], v[164:167], v[92:95]
  buffer_load_dwordx4 v6, s[4:7], s57 offen offset:2048 lds
  ds_read_b64_tr_b16 v[158:159], v17 offset:33792
  s_mul_i32 s52, s50, 163840
  v_mfma_f32_16x16x32_bf16 v[76:79], v[188:191], v[160:163], v[76:79]
  ds_read_b128 v[140:143], v12 offset:38912
  v_mfma_f32_16x16x32_bf16 v[124:127], v[188:191], v[172:175], v[124:127]
  v_mfma_f32_16x16x32_bf16 v[120:123], v[184:187], v[172:175], v[120:123]
  buffer_load_dwordx4 v7, s[4:7], s57 offen offset:3072 lds
  v_mfma_f32_16x16x32_bf16 v[116:119], v[180:183], v[172:175], v[116:119]
  v_mfma_f32_16x16x32_bf16 v[112:115], v[176:179], v[172:175], v[112:115]
  s_waitcnt lgkmcnt(6)
  v_mfma_f32_16x16x32_bf16 v[64:67], v[144:147], v[128:131], v[64:67]
  ds_read_b128 v[160:163], v13 offset:32768
  v_mfma_f32_16x16x32_bf16 v[68:71], v[148:151], v[128:131], v[68:71]
  ds_read_b64_tr_b16 v[176:177], v14 offset:40960
  s_lshl_b32 s53, s51, 13
  s_add_u32 m0, s59, 65536
  s_mul_i32 s58, s56, 245760
  v_mfma_f32_16x16x32_bf16 v[84:87], v[148:151], v[132:135], v[84:87]
  buffer_load_dwordx4 v8, s[8:11], s58 offen offset:0 lds
  ds_read_b64_tr_b16 v[178:179], v14 offset:41984
  v_mfma_f32_16x16x32_bf16 v[80:83], v[144:147], v[132:135], v[80:83]
  ds_read_b64_tr_b16 v[180:181], v15 offset:40960
  s_mov_b64 s[16:17], s[12:13]
  s_mov_b32 s18, s79
  s_waitcnt lgkmcnt(4)
  v_mfma_f32_16x16x32_bf16 v[88:91], v[152:155], v[132:135], v[88:91]
  buffer_store_dwordx4 v[232:235], v2, s[16:19], s80 offen sc1
  ds_read_b64_tr_b16 v[182:183], v15 offset:41984
  v_mfma_f32_16x16x32_bf16 v[72:75], v[152:155], v[128:131], v[72:75]
  ds_read_b128 v[164:167], v13 offset:34816
  s_add_u32 s52, s52, s53
  v_mfma_f32_16x16x32_bf16 v[104:107], v[152:155], v[136:139], v[104:107]
  ds_read_b64_tr_b16 v[184:185], v16 offset:40960
  v_mfma_f32_16x16x32_bf16 v[100:103], v[148:151], v[136:139], v[100:103]
  buffer_load_dwordx4 v9, s[8:11], s58 offen offset:1024 lds
  ds_read_b64_tr_b16 v[186:187], v16 offset:41984
  v_mfma_f32_16x16x32_bf16 v[96:99], v[144:147], v[136:139], v[96:99]
  ds_read_b128 v[168:171], v13 offset:36864
  v_mfma_f32_16x16x32_bf16 v[108:111], v[156:159], v[136:139], v[108:111]
  ds_read_b64_tr_b16 v[188:189], v17 offset:40960
  v_mfma_f32_16x16x32_bf16 v[92:95], v[156:159], v[132:135], v[92:95]
  buffer_load_dwordx4 v10, s[8:11], s58 offen offset:2048 lds
  ds_read_b64_tr_b16 v[190:191], v17 offset:41984
  s_add_u32 s53, s52, 4096
  v_mfma_f32_16x16x32_bf16 v[76:79], v[156:159], v[128:131], v[76:79]
  ds_read_b128 v[172:175], v13 offset:38912
  v_mfma_f32_16x16x32_bf16 v[124:127], v[156:159], v[140:143], v[124:127]
  v_mfma_f32_16x16x32_bf16 v[120:123], v[152:155], v[140:143], v[120:123]
  buffer_load_dwordx4 v11, s[8:11], s58 offen offset:3072 lds
  v_mfma_f32_16x16x32_bf16 v[116:119], v[148:151], v[140:143], v[116:119]
  v_mfma_f32_16x16x32_bf16 v[112:115], v[144:147], v[140:143], v[112:115]
  s_waitcnt lgkmcnt(0)
  v_mfma_f32_16x16x32_bf16 v[64:67], v[176:179], v[160:163], v[64:67]
  s_waitcnt vmcnt(10)
  s_barrier
  ds_read_b128 v[128:131], v12 offset:49152
  v_mfma_f32_16x16x32_bf16 v[68:71], v[180:183], v[160:163], v[68:71]
  ds_read_b64_tr_b16 v[144:145], v14 offset:49152
  s_cmp_lt_u32 s39, 5
  s_cselect_b32 s55, 0x3ea52b5c, 1.0
  s_add_u32 s56, s56, 1
  s_cmp_eq_u32 s56, 10
  s_cselect_b32 s56, 0, s56
  s_add_u32 m0, s59, 16384
  s_lshl_b32 s57, s56, 7
  v_mfma_f32_16x16x32_bf16 v[84:87], v[180:183], v[164:167], v[84:87]
  buffer_load_dwordx4 v4, s[4:7], s57 offen offset:0 lds
  ds_read_b64_tr_b16 v[146:147], v14 offset:50176
  v_mfma_f32_16x16x32_bf16 v[80:83], v[176:179], v[164:167], v[80:83]
  ds_read_b64_tr_b16 v[148:149], v15 offset:49152
  v_mfma_f32_16x16x32_bf16 v[88:91], v[184:187], v[164:167], v[88:91]
  buffer_store_dwordx4 v[236:239], v248, s[16:19], s80 offen sc1
  ds_read_b64_tr_b16 v[150:151], v15 offset:50176
  v_mfma_f32_16x16x32_bf16 v[72:75], v[184:187], v[160:163], v[72:75]
  ds_read_b128 v[132:135], v12 offset:51200
  v_mfma_f32_16x16x32_bf16 v[104:107], v[184:187], v[168:171], v[104:107]
  ds_read_b64_tr_b16 v[152:153], v16 offset:49152
  v_mfma_f32_16x16x32_bf16 v[100:103], v[180:183], v[168:171], v[100:103]
  buffer_load_dwordx4 v5, s[4:7], s57 offen offset:1024 lds
  ds_read_b64_tr_b16 v[154:155], v16 offset:50176
  v_mfma_f32_16x16x32_bf16 v[96:99], v[176:179], v[168:171], v[96:99]
  ds_read_b128 v[136:139], v12 offset:53248
  v_mfma_f32_16x16x32_bf16 v[108:111], v[188:191], v[168:171], v[108:111]
  ds_read_b64_tr_b16 v[156:157], v17 offset:49152
  v_mfma_f32_16x16x32_bf16 v[92:95], v[188:191], v[164:167], v[92:95]
  buffer_load_dwordx4 v6, s[4:7], s57 offen offset:2048 lds
  ds_read_b64_tr_b16 v[158:159], v17 offset:50176
  v_mfma_f32_16x16x32_bf16 v[76:79], v[188:191], v[160:163], v[76:79]
  ds_read_b128 v[140:143], v12 offset:55296
  v_mfma_f32_16x16x32_bf16 v[124:127], v[188:191], v[172:175], v[124:127]
  v_mfma_f32_16x16x32_bf16 v[120:123], v[184:187], v[172:175], v[120:123]
  buffer_load_dwordx4 v7, s[4:7], s57 offen offset:3072 lds
  v_mfma_f32_16x16x32_bf16 v[116:119], v[180:183], v[172:175], v[116:119]
  v_mfma_f32_16x16x32_bf16 v[112:115], v[176:179], v[172:175], v[112:115]
  s_waitcnt lgkmcnt(6)
  v_mfma_f32_16x16x32_bf16 v[64:67], v[144:147], v[128:131], v[64:67]
  ds_read_b128 v[160:163], v13 offset:49152
  v_mfma_f32_16x16x32_bf16 v[68:71], v[148:151], v[128:131], v[68:71]
  ds_read_b64_tr_b16 v[176:177], v14 offset:57344
  s_add_u32 m0, s59, 81920
  s_mul_i32 s58, s56, 245760
  v_mfma_f32_16x16x32_bf16 v[84:87], v[148:151], v[132:135], v[84:87]
  buffer_load_dwordx4 v8, s[8:11], s58 offen offset:0 lds
  ds_read_b64_tr_b16 v[178:179], v14 offset:58368
  v_mfma_f32_16x16x32_bf16 v[80:83], v[144:147], v[132:135], v[80:83]
  ds_read_b64_tr_b16 v[180:181], v15 offset:57344
  s_waitcnt lgkmcnt(4)
  v_mfma_f32_16x16x32_bf16 v[88:91], v[152:155], v[132:135], v[88:91]
  buffer_load_dword v60, v59, s[12:15], s94 offen sc1
  ds_read_b64_tr_b16 v[182:183], v15 offset:58368
  v_mfma_f32_16x16x32_bf16 v[72:75], v[152:155], v[128:131], v[72:75]
  ds_read_b128 v[164:167], v13 offset:51200
  v_mfma_f32_16x16x32_bf16 v[104:107], v[152:155], v[136:139], v[104:107]
  ds_read_b64_tr_b16 v[184:185], v16 offset:57344
  v_mfma_f32_16x16x32_bf16 v[100:103], v[148:151], v[136:139], v[100:103]
  buffer_load_dwordx4 v9, s[8:11], s58 offen offset:1024 lds
  ds_read_b64_tr_b16 v[186:187], v16 offset:58368
  v_mfma_f32_16x16x32_bf16 v[96:99], v[144:147], v[136:139], v[96:99]
  ds_read_b128 v[168:171], v13 offset:53248
  v_mfma_f32_16x16x32_bf16 v[108:111], v[156:159], v[136:139], v[108:111]
  ds_read_b64_tr_b16 v[188:189], v17 offset:57344
  v_mfma_f32_16x16x32_bf16 v[92:95], v[156:159], v[132:135], v[92:95]
  buffer_load_dwordx4 v10, s[8:11], s58 offen offset:2048 lds
  ds_read_b64_tr_b16 v[190:191], v17 offset:58368
  v_mfma_f32_16x16x32_bf16 v[76:79], v[156:159], v[128:131], v[76:79]
  ds_read_b128 v[172:175], v13 offset:55296
  v_mfma_f32_16x16x32_bf16 v[124:127], v[156:159], v[140:143], v[124:127]
  v_mfma_f32_16x16x32_bf16 v[120:123], v[152:155], v[140:143], v[120:123]
  buffer_load_dwordx4 v11, s[8:11], s58 offen offset:3072 lds
  v_mfma_f32_16x16x32_bf16 v[116:119], v[148:151], v[140:143], v[116:119]
  v_mfma_f32_16x16x32_bf16 v[112:115], v[144:147], v[140:143], v[112:115]
  s_waitcnt lgkmcnt(0)
  v_mfma_f32_16x16x32_bf16 v[64:67], v[176:179], v[160:163], v[64:67]
  s_waitcnt vmcnt(10)
  s_barrier
  ds_read_b128 v[128:131], v12 offset:0
  v_mfma_f32_16x16x32_bf16 v[68:71], v[180:183], v[160:163], v[68:71]
  ds_read_b64_tr_b16 v[144:145], v14 offset:0
  v_mfma_f32_16x16x32_bf16 v[84:87], v[180:183], v[164:167], v[84:87]
  buffer_load_dwordx4 v[192:195], v46, s[12:15], 0 offen offset:0 sc1
  ds_read_b64_tr_b16 v[146:147], v14 offset:1024
  v_mfma_f32_16x16x32_bf16 v[80:83], v[176:179], v[164:167], v[80:83]
  ds_read_b64_tr_b16 v[148:149], v15 offset:0
  v_mfma_f32_16x16x32_bf16 v[88:91], v[184:187], v[164:167], v[88:91]
  buffer_load_dwordx4 v[196:199], v46, s[12:15], 0 offen offset:512 sc1
  ds_read_b64_tr_b16 v[150:151], v15 offset:1024
  v_mfma_f32_16x16x32_bf16 v[72:75], v[184:187], v[160:163], v[72:75]
  ds_read_b128 v[132:135], v12 offset:2048
  v_mfma_f32_16x16x32_bf16 v[104:107], v[184:187], v[168:171], v[104:107]
  ds_read_b64_tr_b16 v[152:153], v16 offset:0
  v_mfma_f32_16x16x32_bf16 v[100:103], v[180:183], v[168:171], v[100:103]
  buffer_load_dwordx4 v[200:203], v46, s[12:15], 0 offen offset:1024 sc1
  ds_read_b64_tr_b16 v[154:155], v16 offset:1024
  v_mfma_f32_16x16x32_bf16 v[96:99], v[176:179], v[168:171], v[96:99]
  ds_read_b128 v[136:139], v12 offset:4096
  v_mfma_f32_16x16x32_bf16 v[108:111], v[188:191], v[168:171], v[108:111]
  ds_read_b64_tr_b16 v[156:157], v17 offset:0
  v_mfma_f32_16x16x32_bf16 v[92:95], v[188:191], v[164:167], v[92:95]
  buffer_load_dwordx4 v[204:207], v46, s[12:15], 0 offen offset:1536 sc1
  ds_read_b64_tr_b16 v[158:159], v17 offset:1024
  v_mfma_f32_16x16x32_bf16 v[76:79], v[188:191], v[160:163], v[76:79]
  ds_read_b128 v[140:143], v12 offset:6144
  v_mfma_f32_16x16x32_bf16 v[124:127], v[188:191], v[172:175], v[124:127]
  v_mfma_f32_16x16x32_bf16 v[120:123], v[184:187], v[172:175], v[120:123]
  buffer_load_dwordx4 v[208:211], v46, s[12:15], 0 offen offset:2048 sc1
  v_mfma_f32_16x16x32_bf16 v[116:119], v[180:183], v[172:175], v[116:119]
  v_mfma_f32_16x16x32_bf16 v[112:115], v[176:179], v[172:175], v[112:115]
  s_waitcnt lgkmcnt(6)
  v_mfma_f32_16x16x32_bf16 v[64:67], v[144:147], v[128:131], v[64:67]
  ds_read_b128 v[160:163], v13 offset:0
  v_mfma_f32_16x16x32_bf16 v[68:71], v[148:151], v[128:131], v[68:71]
  ds_read_b64_tr_b16 v[176:177], v14 offset:8192
  s_waitcnt vmcnt(8)
  v_cmp_ne_u32 vcc, s37, v60
  s_nop 3
  s_cbranch_vccnz Lfs_1
Lfb_2:
  v_mfma_f32_16x16x32_bf16 v[84:87], v[148:151], v[132:135], v[84:87]
  buffer_load_dwordx2 v[212:213], v47, s[12:15], 0 offen offset:0 sc1
  ds_read_b64_tr_b16 v[178:179], v14 offset:9216
  v_mfma_f32_16x16x32_bf16 v[80:83], v[144:147], v[132:135], v[80:83]
  ds_read_b64_tr_b16 v[180:181], v15 offset:8192
  s_waitcnt lgkmcnt(4)
  v_mfma_f32_16x16x32_bf16 v[88:91], v[152:155], v[132:135], v[88:91]
  buffer_load_dwordx2 v[214:215], v47, s[12:15], 0 offen offset:256 sc1
  ds_read_b64_tr_b16 v[182:183], v15 offset:9216
  v_mfma_f32_16x16x32_bf16 v[72:75], v[152:155], v[128:131], v[72:75]
  ds_read_b128 v[164:167], v13 offset:2048
  v_mfma_f32_16x16x32_bf16 v[104:107], v[152:155], v[136:139], v[104:107]
  ds_read_b64_tr_b16 v[184:185], v16 offset:8192
  v_mfma_f32_16x16x32_bf16 v[100:103], v[148:151], v[136:139], v[100:103]
  buffer_load_dwordx2 v[216:217], v47, s[12:15], 0 offen offset:512 sc1
  ds_read_b64_tr_b16 v[186:187], v16 offset:9216
  v_mfma_f32_16x16x32_bf16 v[96:99], v[144:147], v[136:139], v[96:99]
  ds_read_b128 v[168:171], v13 offset:4096
  v_mfma_f32_16x16x32_bf16 v[108:111], v[156:159], v[136:139], v[108:111]
  ds_read_b64_tr_b16 v[188:189], v17 offset:8192
  v_mfma_f32_16x16x32_bf16 v[92:95], v[156:159], v[132:135], v[92:95]
  buffer_load_dwordx2 v[218:219], v47, s[12:15], 0 offen offset:768 sc1
  ds_read_b64_tr_b16 v[190:191], v17 offset:9216
  v_mfma_f32_16x16x32_bf16 v[76:79], v[156:159], v[128:131], v[76:79]
  ds_read_b128 v[172:175], v13 offset:6144
  v_mfma_f32_16x16x32_bf16 v[124:127], v[156:159], v[140:143], v[124:127]
  v_mfma_f32_16x16x32_bf16 v[120:123], v[152:155], v[140:143], v[120:123]
  buffer_load_dwordx2 v[220:221], v47, s[12:15], 0 offen offset:1024 sc1
  v_mfma_f32_16x16x32_bf16 v[116:119], v[148:151], v[140:143], v[116:119]
  v_mfma_f32_16x16x32_bf16 v[112:115], v[144:147], v[140:143], v[112:115]
  s_waitcnt lgkmcnt(0)
  v_mfma_f32_16x16x32_bf16 v[64:67], v[176:179], v[160:163], v[64:67]
  s_waitcnt vmcnt(10)
  s_barrier
  ds_read_b128 v[128:131], v12 offset:16384
  v_mfma_f32_16x16x32_bf16 v[68:71], v[180:183], v[160:163], v[68:71]
  ds_read_b64_tr_b16 v[144:145], v14 offset:16384
  v_add_u32 v250, s90, v2
  v_mfma_f32_16x16x32_bf16 v[84:87], v[180:183], v[164:167], v[84:87]
  global_load_dwordx4 a[156:159], v250, s[12:13] offset:-4096 sc1
  ds_read_b64_tr_b16 v[146:147], v14 offset:17408
  v_mfma_f32_16x16x32_bf16 v[80:83], v[176:179], v[164:167], v[80:83]
  ds_read_b64_tr_b16 v[148:149], v15 offset:16384
  v_mfma_f32_16x16x32_bf16 v[88:91], v[184:187], v[164:167], v[88:91]
  global_load_dwordx4 a[160:163], v250, s[12:13] offset:-3072 sc1
  ds_read_b64_tr_b16 v[150:151], v15 offset:17408
  v_mfma_f32_16x16x32_bf16 v[72:75], v[184:187], v[160:163], v[72:75]
  ds_read_b128 v[132:135], v12 offset:18432
  v_mfma_f32_16x16x32_bf16 v[104:107], v[184:187], v[168:171], v[104:107]
  global_load_dwordx4 a[164:167], v250, s[12:13] offset:-2048 sc1
  ds_read_b64_tr_b16 v[152:153], v16 offset:16384
  v_mfma_f32_16x16x32_bf16 v[100:103], v[180:183], v[168:171], v[100:103]
  ds_read_b64_tr_b16 v[154:155], v16 offset:17408
  v_mfma_f32_16x16x32_bf16 v[96:99], v[176:179], v[168:171], v[96:99]
  global_load_dwordx4 a[168:171], v250, s[12:13] offset:-1024 sc1
  ds_read_b128 v[136:139], v12 offset:20480
  v_mfma_f32_16x16x32_bf16 v[108:111], v[188:191], v[168:171], v[108:111]
  ds_read_b64_tr_b16 v[156:157], v17 offset:16384
  v_mfma_f32_16x16x32_bf16 v[92:95], v[188:191], v[164:167], v[92:95]
  global_load_dwordx4 a[172:175], v250, s[12:13] offset:0 sc1
  ds_read_b64_tr_b16 v[158:159], v17 offset:17408
  v_mfma_f32_16x16x32_bf16 v[76:79], v[188:191], v[160:163], v[76:79]
  ds_read_b128 v[140:143], v12 offset:22528
  v_mfma_f32_16x16x32_bf16 v[124:127], v[188:191], v[172:175], v[124:127]
  global_load_dwordx4 a[176:179], v250, s[12:13] offset:1024 sc1
  v_mfma_f32_16x16x32_bf16 v[120:123], v[184:187], v[172:175], v[120:123]
  v_mfma_f32_16x16x32_bf16 v[116:119], v[180:183], v[172:175], v[116:119]
  global_load_dwordx4 a[180:183], v250, s[12:13] offset:2048 sc1
  v_mfma_f32_16x16x32_bf16 v[112:115], v[176:179], v[172:175], v[112:115]
  s_waitcnt lgkmcnt(6)
  v_mfma_f32_16x16x32_bf16 v[64:67], v[144:147], v[128:131], v[64:67]
  ds_read_b128 v[160:163], v13 offset:16384
  v_mfma_f32_16x16x32_bf16 v[68:71], v[148:151], v[128:131], v[68:71]
  ds_read_b64_tr_b16 v[176:177], v14 offset:24576
  s_waitcnt vmcnt(7)
  v_xor_b32 v51, s37, v221
  v_bitop3_b32 v51, v193, s37, v51 bitop3:0xbe
  v_bitop3_b32 v51, v195, s37, v51 bitop3:0xbe
  v_mfma_f32_16x16x32_bf16 v[84:87], v[148:151], v[132:135], v[84:87]
  global_load_dwordx4 a[184:187], v250, s[12:13] offset:3072 sc1
  ds_read_b64_tr_b16 v[178:179], v14 offset:25600
  v_bitop3_b32 v51, v197, s37, v51 bitop3:0xbe
  v_bitop3_b32 v51, v199, s37, v51 bitop3:0xbe
  v_mfma_f32_16x16x32_bf16 v[80:83], v[144:147], v[132:135], v[80:83]
  ds_read_b64_tr_b16 v[180:181], v15 offset:24576
  v_bitop3_b32 v51, v201, s37, v51 bitop3:0xbe
  v_bitop3_b32 v51, v203, s37, v51 bitop3:0xbe
  v_add_u32 v250, 8192, v250
  s_waitcnt lgkmcnt(4)
  v_mfma_f32_16x16x32_bf16 v[88:91], v[152:155], v[132:135], v[88:91]
  global_load_dwordx4 a[188:191], v250, s[12:13] offset:-4096 sc1
  ds_read_b64_tr_b16 v[182:183], v15 offset:25600
  v_bitop3_b32 v51, v205, s37, v51 bitop3:0xbe
  v_bitop3_b32 v51, v207, s37, v51 bitop3:0xbe
  v_mfma_f32_16x16x32_bf16 v[72:75], v[152:155], v[128:131], v[72:75]
  ds_read_b128 v[164:167], v13 offset:18432
  v_bitop3_b32 v51, v209, s37, v51 bitop3:0xbe
  v_bitop3_b32 v51, v211, s37, v51 bitop3:0xbe
  v_bitop3_b32 v51, v213, s37, v51 bitop3:0xbe
  v_mfma_f32_16x16x32_bf16 v[104:107], v[152:155], v[136:139], v[104:107]
  global_load_dwordx4 a[192:195], v250, s[12:13] offset:-3072 sc1
  ds_read_b64_tr_b16 v[184:185], v16 offset:24576
  v_bitop3_b32 v51, v215, s37, v51 bitop3:0xbe
  v_bitop3_b32 v51, v217, s37, v51 bitop3:0xbe
  v_mfma_f32_16x16x32_bf16 v[100:103], v[148:151], v[136:139], v[100:103]
  ds_read_b64_tr_b16 v[186:187], v16 offset:25600
  v_bitop3_b32 v51, v219, s37, v51 bitop3:0xbe
  v_cmp_ne_u32 vcc, 0, v51
  v_mfma_f32_16x16x32_bf16 v[96:99], v[144:147], v[136:139], v[96:99]
  global_load_dwordx4 a[196:199], v250, s[12:13] offset:-2048 sc1
  ds_read_b128 v[168:171], v13 offset:20480
  s_nop 3
  s_cbranch_vccnz Lss_5
Lsb_6:
  v_add_f32 v4, v192, v196
  v_mfma_f32_16x16x32_bf16 v[108:111], v[156:159], v[136:139], v[108:111]
  ds_read_b64_tr_b16 v[188:189], v17 offset:24576
  v_add_f32 v5, v194, v198
  v_add_f32 v8, v212, v214
  v_mfma_f32_16x16x32_bf16 v[92:95], v[156:159], v[132:135], v[92:95]
  global_load_dwordx4 a[200:203], v250, s[12:13] offset:-1024 sc1
  ds_read_b64_tr_b16 v[190:191], v17 offset:25600
  v_add_f32 v4, v4, v200
  v_add_f32 v5, v5, v202
  v_add_f32 v8, v8, v216
  v_mfma_f32_16x16x32_bf16 v[76:79], v[156:159], v[128:131], v[76:79]
  ds_read_b128 v[172:175], v13 offset:22528
  v_add_f32 v4, v4, v204
  v_add_f32 v5, v5, v206
  v_mfma_f32_16x16x32_bf16 v[124:127], v[156:159], v[140:143], v[124:127]
  global_load_dwordx4 a[204:207], v250, s[12:13] offset:0 sc1
  v_add_f32 v8, v8, v218
  v_add_f32 v4, v4, v208
  v_mfma_f32_16x16x32_bf16 v[120:123], v[152:155], v[140:143], v[120:123]
  v_add_f32 v5, v5, v210
  v_add_f32 v8, v8, v220
  v_mfma_f32_16x16x32_bf16 v[116:119], v[148:151], v[140:143], v[116:119]
  global_load_dwordx4 a[208:211], v250, s[12:13] offset:1024 sc1
  v_mov_b32 v6, v4
  v_mov_b32 v7, v5
  v_mfma_f32_16x16x32_bf16 v[112:115], v[144:147], v[140:143], v[112:115]
  s_waitcnt lgkmcnt(0)
  v_mfma_f32_16x16x32_bf16 v[64:67], v[176:179], v[160:163], v[64:67]
  v_mov_b32 v9, v8
  v_permlane32_swap_b32 v4, v6
  v_permlane32_swap_b32 v5, v7
  v_mfma_f32_16x16x32_bf16 v[68:71], v[180:183], v[160:163], v[68:71]
  v_permlane32_swap_b32 v8, v9
  v_add_f32 v4, v4, v6
  v_add_f32 v5, v5, v7
  v_mfma_f32_16x16x32_bf16 v[84:87], v[180:183], v[164:167], v[84:87]
  global_load_dwordx4 a[212:215], v250, s[12:13] offset:2048 sc1
  v_mul_f32 v4, 0xbacccccd, v4
  v_mul_f32 v5, 0x3acccccd, v5
  v_add_f32 v8, v8, v9
  v_mfma_f32_16x16x32_bf16 v[80:83], v[176:179], v[164:167], v[80:83]
  v_fma_f32 v5, -v4, v4, v5
  ds_write_b32 v50, v4
  v_max_f32 v5, 0, v5
  v_mfma_f32_16x16x32_bf16 v[88:91], v[184:187], v[164:167], v[88:91]
  global_load_dwordx4 a[216:219], v250, s[12:13] offset:3072 sc1
  v_add_f32 v5, 0x3727c5ac, v5
  v_rsq_f32 v5, v5
  ds_write_b32 v50, v8 offset:1024
  v_mfma_f32_16x16x32_bf16 v[72:75], v[184:187], v[160:163], v[72:75]
  v_mul_f32 v5, s55, v5
  ds_write_b32 v50, v5 offset:512
  v_add_u32 v250, 8192, v250
  v_mfma_f32_16x16x32_bf16 v[104:107], v[184:187], v[168:171], v[104:107]
  global_load_dwordx4 a[220:223], v250, s[12:13] offset:-4096 sc1
  v_mfma_f32_16x16x32_bf16 v[100:103], v[180:183], v[168:171], v[100:103]
  s_waitcnt lgkmcnt(0)
  s_barrier
  v_mfma_f32_16x16x32_bf16 v[96:99], v[176:179], v[168:171], v[96:99]
  global_load_dwordx4 a[224:227], v250, s[12:13] offset:-3072 sc1
  ds_read2_b32 v[36:37], v28 offset0:0 offset1:128
  ds_read2_b32 v[38:39], v28 offset0:16 offset1:144
  v_mfma_f32_16x16x32_bf16 v[108:111], v[188:191], v[168:171], v[108:111]
  ds_read2_b32 v[40:41], v28 offset0:32 offset1:160
  v_mfma_f32_16x16x32_bf16 v[92:95], v[188:191], v[164:167], v[92:95]
  global_load_dwordx4 a[228:231], v250, s[12:13] offset:-2048 sc1
  ds_read2_b32 v[42:43], v28 offset0:48 offset1:176
  ds_read_b128 v[208:211], v29 offset:0
  v_mfma_f32_16x16x32_bf16 v[76:79], v[188:191], v[160:163], v[76:79]
  ds_read_b128 v[212:215], v29 offset:64
  v_mfma_f32_16x16x32_bf16 v[124:127], v[188:191], v[172:175], v[124:127]
  global_load_dwordx4 a[232:235], v250, s[12:13] offset:-1024 sc1
  ds_read_b128 v[216:219], v29 offset:128
  ds_read_b128 v[220:223], v29 offset:192
  v_mfma_f32_16x16x32_bf16 v[120:123], v[184:187], v[172:175], v[120:123]
  v_mfma_f32_16x16x32_bf16 v[116:119], v[180:183], v[172:175], v[116:119]
  global_load_dwordx4 a[236:239], v250, s[12:13] offset:0 sc1
  v_mfma_f32_16x16x32_bf16 v[112:115], v[176:179], v[172:175], v[112:115]
  s_waitcnt lgkmcnt(3)
  v_pk_fma_f32 v[64:65], v[208:209], v[36:37], v[64:65] op_sel_hi:[1,0,1]
  v_pk_fma_f32 v[66:67], v[210:211], v[36:37], v[66:67] op_sel_hi:[1,0,1]
  v_pk_fma_f32 v[96:97], v[208:209], v[40:41], v[96:97] op_sel_hi:[1,0,1]
  v_pk_fma_f32 v[98:99], v[210:211], v[40:41], v[98:99] op_sel_hi:[1,0,1]
  v_pk_mul_f32 v[64:65], v[64:65], v[36:37] op_sel:[0,1] op_sel_hi:[1,1]
  v_pk_mul_f32 v[66:67], v[66:67], v[36:37] op_sel:[0,1] op_sel_hi:[1,1]
  v_pk_mul_f32 v[96:97], v[96:97], v[40:41] op_sel:[0,1] op_sel_hi:[1,1]
  v_pk_mul_f32 v[98:99], v[98:99], v[40:41] op_sel:[0,1] op_sel_hi:[1,1]
  v_cvt_pk_bf16_f32 v128, v64, v65
  v_cvt_pk_bf16_f32 v129, v66, v67
  v_cvt_pk_bf16_f32 v130, v96, v97
  v_cvt_pk_bf16_f32 v131, v98, v99
  buffer_store_dwordx4 v[128:131], v32, s[12:15], s52 offen offset:0 sc1
  v_pk_fma_f32 v[80:81], v[208:209], v[38:39], v[80:81] op_sel_hi:[1,0,1]
  v_pk_fma_f32 v[82:83], v[210:211], v[38:39], v[82:83] op_sel_hi:[1,0,1]
  v_pk_fma_f32 v[112:113], v[208:209], v[42:43], v[112:113] op_sel_hi:[1,0,1]
  v_pk_fma_f32 v[114:115], v[210:211], v[42:43], v[114:115] op_sel_hi:[1,0,1]
  v_pk_mul_f32 v[80:81], v[80:81], v[38:39] op_sel:[0,1] op_sel_hi:[1,1]
  v_pk_mul_f32 v[82:83], v[82:83], v[38:39] op_sel:[0,1] op_sel_hi:[1,1]
  v_pk_mul_f32 v[112:113], v[112:113], v[42:43] op_sel:[0,1] op_sel_hi:[1,1]
  v_pk_mul_f32 v[114:115], v[114:115], v[42:43] op_sel:[0,1] op_sel_hi:[1,1]
  v_cvt_pk_bf16_f32 v132, v80, v81
  v_cvt_pk_bf16_f32 v133, v82, v83
  v_cvt_pk_bf16_f32 v134, v112, v113
  v_cvt_pk_bf16_f32 v135, v114, v115
  buffer_store_dwordx4 v[132:135], v32, s[12:15], s52 offen offset:256 sc1
  s_waitcnt lgkmcnt(2)
  v_pk_fma_f32 v[68:69], v[212:213], v[36:37], v[68:69] op_sel_hi:[1,0,1]
  v_pk_fma_f32 v[70:71], v[214:215], v[36:37], v[70:71] op_sel_hi:[1,0,1]
  v_pk_fma_f32 v[100:101], v[212:213], v[40:41], v[100:101] op_sel_hi:[1,0,1]
  v_pk_fma_f32 v[102:103], v[214:215], v[40:41], v[102:103] op_sel_hi:[1,0,1]
  v_pk_mul_f32 v[68:69], v[68:69], v[36:37] op_sel:[0,1] op_sel_hi:[1,1]
  v_pk_mul_f32 v[70:71], v[70:71], v[36:37] op_sel:[0,1] op_sel_hi:[1,1]
  v_pk_mul_f32 v[100:101], v[100:101], v[40:41] op_sel:[0,1] op_sel_hi:[1,1]
  v_pk_mul_f32 v[102:103], v[102:103], v[40:41] op_sel:[0,1] op_sel_hi:[1,1]
  v_cvt_pk_bf16_f32 v136, v68, v69
  v_cvt_pk_bf16_f32 v137, v70, v71
  v_cvt_pk_bf16_f32 v138, v100, v101
  v_cvt_pk_bf16_f32 v139, v102, v103
  buffer_store_dwordx4 v[136:139], v32, s[12:15], s52 offen offset:2048 sc1
  v_pk_fma_f32 v[84:85], v[212:213], v[38:39], v[84:85] op_sel_hi:[1,0,1]
  v_pk_fma_f32 v[86:87], v[214:215], v[38:39], v[86:87] op_sel_hi:[1,0,1]
  v_pk_fma_f32 v[116:117], v[212:213], v[42:43], v[116:117] op_sel_hi:[1,0,1]
  v_pk_fma_f32 v[118:119], v[214:215], v[42:43], v[118:119] op_sel_hi:[1,0,1]
  v_pk_mul_f32 v[84:85], v[84:85], v[38:39] op_sel:[0,1] op_sel_hi:[1,1]
  v_pk_mul_f32 v[86:87], v[86:87], v[38:39] op_sel:[0,1] op_sel_hi:[1,1]
  v_pk_mul_f32 v[116:117], v[116:117], v[42:43] op_sel:[0,1] op_sel_hi:[1,1]
  v_pk_mul_f32 v[118:119], v[118:119], v[42:43] op_sel:[0,1] op_sel_hi:[1,1]
  v_cvt_pk_bf16_f32 v140, v84, v85
  v_cvt_pk_bf16_f32 v141, v86, v87
  v_cvt_pk_bf16_f32 v142, v116, v117
  v_cvt_pk_bf16_f32 v143, v118, v119
  buffer_store_dwordx4 v[140:143], v32, s[12:15], s52 offen offset:2304 sc1
  s_waitcnt lgkmcnt(1)
  v_pk_fma_f32 v[72:73], v[216:217], v[36:37], v[72:73] op_sel_hi:[1,0,1]
  v_pk_fma_f32 v[74:75], v[218:219], v[36:37], v[74:75] op_sel_hi:[1,0,1]
  v_pk_fma_f32 v[104:105], v[216:217], v[40:41], v[104:105] op_sel_hi:[1,0,1]
  v_pk_fma_f32 v[106:107], v[218:219], v[40:41], v[106:107] op_sel_hi:[1,0,1]
  v_pk_mul_f32 v[72:73], v[72:73], v[36:37] op_sel:[0,1] op_sel_hi:[1,1]
  v_pk_mul_f32 v[74:75], v[74:75], v[36:37] op_sel:[0,1] op_sel_hi:[1,1]
  v_pk_mul_f32 v[104:105], v[104:105], v[40:41] op_sel:[0,1] op_sel_hi:[1,1]
  v_pk_mul_f32 v[106:107], v[106:107], v[40:41] op_sel:[0,1] op_sel_hi:[1,1]
  v_cvt_pk_bf16_f32 v144, v72, v73
  v_cvt_pk_bf16_f32 v145, v74, v75
  v_cvt_pk_bf16_f32 v146, v104, v105
  v_cvt_pk_bf16_f32 v147, v106, v107
  buffer_store_dwordx4 v[144:147], v32, s[12:15], s53 offen offset:0 sc1
  v_pk_fma_f32 v[88:89], v[216:217], v[38:39], v[88:89] op_sel_hi:[1,0,1]
  v_pk_fma_f32 v[90:91], v[218:219], v[38:39], v[90:91] op_sel_hi:[1,0,1]
  v_pk_fma_f32 v[120:121], v[216:217], v[42:43], v[120:121] op_sel_hi:[1,0,1]
  v_pk_fma_f32 v[122:123], v[218:219], v[42:43], v[122:123] op_sel_hi:[1,0,1]
  v_pk_mul_f32 v[88:89], v[88:89], v[38:39] op_sel:[0,1] op_sel_hi:[1,1]
  v_pk_mul_f32 v[90:91], v[90:91], v[38:39] op_sel:[0,1] op_sel_hi:[1,1]
  v_pk_mul_f32 v[120:121], v[120:121], v[42:43] op_sel:[0,1] op_sel_hi:[1,1]
  v_pk_mul_f32 v[122:123], v[122:123], v[42:43] op_sel:[0,1] op_sel_hi:[1,1]
  v_cvt_pk_bf16_f32 v148, v88, v89
  v_cvt_pk_bf16_f32 v149, v90, v91
  v_cvt_pk_bf16_f32 v150, v120, v121
  v_cvt_pk_bf16_f32 v151, v122, v123
  buffer_store_dwordx4 v[148:151], v32, s[12:15], s53 offen offset:256 sc1
  s_waitcnt lgkmcnt(0)
  v_pk_fma_f32 v[76:77], v[220:221], v[36:37], v[76:77] op_sel_hi:[1,0,1]
  v_pk_fma_f32 v[78:79], v[222:223], v[36:37], v[78:79] op_sel_hi:[1,0,1]
  v_pk_fma_f32 v[108:109], v[220:221], v[40:41], v[108:109] op_sel_hi:[1,0,1]
  v_pk_fma_f32 v[110:111], v[222:223], v[40:41], v[110:111] op_sel_hi:[1,0,1]
  v_pk_mul_f32 v[76:77], v[76:77], v[36:37] op_sel:[0,1] op_sel_hi:[1,1]
  v_pk_mul_f32 v[78:79], v[78:79], v[36:37] op_sel:[0,1] op_sel_hi:[1,1]
  v_pk_mul_f32 v[108:109], v[108:109], v[40:41] op_sel:[0,1] op_sel_hi:[1,1]
  v_pk_mul_f32 v[110:111], v[110:111], v[40:41] op_sel:[0,1] op_sel_hi:[1,1]
  v_cvt_pk_bf16_f32 v152, v76, v77
  v_cvt_pk_bf16_f32 v153, v78, v79
  v_cvt_pk_bf16_f32 v154, v108, v109
  v_cvt_pk_bf16_f32 v155, v110, v111
  buffer_store_dwordx4 v[152:155], v32, s[12:15], s53 offen offset:2048 sc1
  v_pk_fma_f32 v[92:93], v[220:221], v[38:39], v[92:93] op_sel_hi:[1,0,1]
  v_pk_fma_f32 v[94:95], v[222:223], v[38:39], v[94:95] op_sel_hi:[1,0,1]
  v_pk_fma_f32 v[124:125], v[220:221], v[42:43], v[124:125] op_sel_hi:[1,0,1]
  v_pk_fma_f32 v[126:127], v[222:223], v[42:43], v[126:127] op_sel_hi:[1,0,1]
  v_pk_mul_f32 v[92:93], v[92:93], v[38:39] op_sel:[0,1] op_sel_hi:[1,1]
  v_pk_mul_f32 v[94:95], v[94:95], v[38:39] op_sel:[0,1] op_sel_hi:[1,1]
  v_pk_mul_f32 v[124:125], v[124:125], v[42:43] op_sel:[0,1] op_sel_hi:[1,1]
  v_pk_mul_f32 v[126:127], v[126:127], v[42:43] op_sel:[0,1] op_sel_hi:[1,1]
  v_cvt_pk_bf16_f32 v156, v92, v93
  v_cvt_pk_bf16_f32 v157, v94, v95
  v_cvt_pk_bf16_f32 v158, v124, v125
  v_cvt_pk_bf16_f32 v159, v126, v127
  buffer_store_dwordx4 v[156:159], v32, s[12:15], s53 offen offset:2304 sc1
  s_nop 0
  s_branch Lp1_done
Lp1_v:
  s_add_u32 m0, s59, 81920
  s_mul_i32 s58, s56, 245760
  buffer_load_dwordx4 v8, s[8:11], s58 offen offset:0 lds
  buffer_load_dwordx4 v9, s[8:11], s58 offen offset:1024 lds
  buffer_load_dwordx4 v10, s[8:11], s58 offen offset:2048 lds
  buffer_load_dwordx4 v11, s[8:11], s58 offen offset:3072 lds
  s_waitcnt vmcnt(8)
  s_barrier
  ds_read_b128 v[128:131], v12 offset:0
  ds_read_b64_tr_b16 v[144:145], v14 offset:0
  ds_read_b64_tr_b16 v[146:147], v14 offset:1024
  ds_read_b64_tr_b16 v[148:149], v15 offset:0
  ds_read_b64_tr_b16 v[150:151], v15 offset:1024
  ds_read_b128 v[132:135], v12 offset:2048
  ds_read_b64_tr_b16 v[152:153], v16 offset:0
  ds_read_b64_tr_b16 v[154:155], v16 offset:1024
  ds_read_b128 v[136:139], v12 offset:4096
  ds_read_b64_tr_b16 v[156:157], v17 offset:0
  ds_read_b64_tr_b16 v[158:159], v17 offset:1024
  ds_read_b128 v[140:143], v12 offset:6144
  s_add_u32 s56, s56, 1
  s_cmp_eq_u32 s56, 10
  s_cselect_b32 s56, 0, s56
  s_add_u32 m0, s59, 32768
  s_lshl_b32 s57, s56, 7
  buffer_load_dwordx4 v4, s[4:7], s57 offen offset:0 lds
  buffer_load_dwordx4 v5, s[4:7], s57 offen offset:1024 lds
  buffer_load_dwordx4 v6, s[4:7], s57 offen offset:2048 lds
  buffer_load_dwordx4 v7, s[4:7], s57 offen offset:3072 lds
  s_waitcnt lgkmcnt(9)
  v_mfma_f32_16x16x32_bf16 v[64:67], v[128:131], v[144:147], 0
  ds_read_b128 v[160:163], v13 offset:0
  s_cmp_lg_u32 s76, 0
  s_cbranch_scc1 Lsc_20
  ds_read_b128 v[192:195], v18
  ds_read_b64_tr_b16 v[208:209], v22 offset:0
  ds_read_b64_tr_b16 v[210:211], v22 offset:1024
  ds_read_b128 v[196:199], v19
  ds_read_b64_tr_b16 v[212:213], v22 offset:4096
  ds_read_b64_tr_b16 v[214:215], v22 offset:5120
  ds_read_b128 v[200:203], v20
  ds_read_b64_tr_b16 v[216:217], v22 offset:8192
  ds_read_b64_tr_b16 v[218:219], v22 offset:9216
  ds_read_b128 v[204:207], v21
  ds_read_b64_tr_b16 v[220:221], v22 offset:12288
  ds_read_b64_tr_b16 v[222:223], v22 offset:13312
Lsc_20:
  s_waitcnt lgkmcnt(8)
  v_mfma_f32_16x16x32_bf16 v[68:71], v[128:131], v[148:151], 0
  ds_read_b64_tr_b16 v[176:177], v14 offset:8192
  s_add_u32 s37, s37, 1564122216
  s_and_b32 s53, s48, 1
  s_lshl3_add_u32 s49, s53, s49
  s_add_u32 m0, s59, 98304
  s_mul_i32 s58, s56, 245760
  s_waitcnt lgkmcnt(8)
  v_mfma_f32_16x16x32_bf16 v[84:87], v[132:135], v[148:151], 0
  buffer_load_dwordx4 v8, s[8:11], s58 offen offset:0 lds
  ds_read_b64_tr_b16 v[178:179], v14 offset:9216
  s_and_b32 s53, s48, 6
  s_lshl_b32 s53, s53, 5
  v_mfma_f32_16x16x32_bf16 v[80:83], v[132:135], v[144:147], 0
  ds_read_b64_tr_b16 v[180:181], v15 offset:8192
  s_add_u32 s49, s49, s53
  s_add_u32 s49, s49, 131072
  s_cmp_eq_u32 s48, 4
  s_cselect_b32 s54, 3, 4
  s_waitcnt lgkmcnt(8)
  v_mfma_f32_16x16x32_bf16 v[88:91], v[132:135], v[152:155], 0
  ds_read_b64_tr_b16 v[182:183], v15 offset:9216
  v_lshlrev_b32 v30, s54, v29
  v_add3_u32 v242, v30, v28, s49
  v_mfma_f32_16x16x32_bf16 v[72:75], v[128:131], v[152:155], 0
  ds_read_b128 v[164:167], v13 offset:2048
  s_mov_b32 s16, s32
  s_mov_b32 s17, s33
  s_mov_b32 s19, 0x20000
  s_waitcnt lgkmcnt(9)
  v_mfma_f32_16x16x32_bf16 v[104:107], v[136:139], v[152:155], 0
  buffer_load_dwordx4 v9, s[8:11], s58 offen offset:1024 lds
  ds_read_b64_tr_b16 v[184:185], v16 offset:8192
  s_cmp_lt_u32 s2, 192
  s_cselect_b32 s18, 2211840, 0
  s_cselect_b32 s79, 29786112, 0
  s_cselect_b64 vcc, s[44:45], 0
  s_and_b32 s48, s2, 15
  v_mfma_f32_16x16x32_bf16 v[100:103], v[136:139], v[148:151], 0
  ds_read_b64_tr_b16 v[186:187], v16 offset:9216
  s_bfe_u32 s49, s2, 0x20004
  s_mul_i32 s49, s49, 5
  s_lshr_b32 s51, s2, 6
  v_mfma_f32_16x16x32_bf16 v[96:99], v[136:139], v[144:147], 0
  ds_read_b128 v[168:171], v13 offset:4096
  s_add_u32 s49, s49, s51
  s_add_u32 s49, s49, 2
  s_waitcnt lgkmcnt(10)
  v_mfma_f32_16x16x32_bf16 v[108:111], v[136:139], v[156:159], 0
  ds_read_b64_tr_b16 v[188:189], v17 offset:8192
  s_mul_i32 s80, s48, 20
  s_add_u32 s80, s80, s49
  s_mul_i32 s80, s80, 7
  v_mfma_f32_16x16x32_bf16 v[92:95], v[132:135], v[156:159], 0
  buffer_load_dwordx4 v10, s[8:11], s58 offen offset:2048 lds
  ds_read_b64_tr_b16 v[190:191], v17 offset:9216
  s_add_u32 s80, s80, s36
  s_lshl_b32 s80, s80, 10
  v_mfma_f32_16x16x32_bf16 v[76:79], v[128:131], v[156:159], 0
  ds_read_b128 v[172:175], v13 offset:6144
  s_add_u32 s80, s80, 21397504
  s_lshl_b32 s51, s48, 5
  s_add_u32 s51, s51, s49
  s_waitcnt lgkmcnt(12)
  v_mfma_f32_16x16x32_bf16 v[124:127], v[140:143], v[156:159], 0
  s_lshl_b32 s51, s51, 7
  s_add_u32 s51, s51, 29163392
  v_mfma_f32_16x16x32_bf16 v[120:123], v[140:143], v[152:155], 0
  s_cmp_eq_u32 s36, 0
  s_cselect_b64 vcc, vcc, 0
  v_lshl_add_u32 v28, v1, 2, s51
  v_cndmask_b32 v244, v244, v28, vcc
  v_mfma_f32_16x16x32_bf16 v[116:119], v[140:143], v[148:151], 0
  buffer_load_dwordx4 v11, s[8:11], s58 offen offset:3072 lds
  s_mul_i32 s50, s48, 216
  s_and_b32 s50, s50, -16
  v_mfma_f32_16x16x32_bf16 v[112:115], v[140:143], v[144:147], 0
  s_waitcnt lgkmcnt(0)
  v_mfma_f32_16x16x32_bf16 v[64:67], v[160:163], v[176:179], v[64:67]
  s_waitcnt vmcnt(8)
  s_barrier
  ds_read_b128 v[128:131], v12 offset:16384
  v_mfma_f32_16x16x32_bf16 v[68:71], v[160:163], v[180:183], v[68:71]
  ds_read_b64_tr_b16 v[144:145], v14 offset:16384
  s_mul_i32 s51, s49, 110592
  s_add_u32 s50, s50, s51
  v_add_u32 v28, 0, v0
  s_add_u32 s56, s56, 1
  s_cmp_eq_u32 s56, 10
  s_cselect_b32 s56, 0, s56
  s_add_u32 m0, s59, 49152
  s_lshl_b32 s57, s56, 7
  v_mfma_f32_16x16x32_bf16 v[84:87], v[164:167], v[180:183], v[84:87]
  buffer_load_dwordx4 v4, s[4:7], s57 offen offset:0 lds
  ds_read_b64_tr_b16 v[146:147], v14 offset:17408
  v_mul_u32_u24 v29, 4682, v28
  v_lshrrev_b32 v29, 16, v29
  v_mfma_f32_16x16x32_bf16 v[80:83], v[164:167], v[176:179], v[80:83]
  ds_read_b64_tr_b16 v[148:149], v15 offset:16384
  v_mul_u32_u24 v29, 3232, v29
  v_lshl_add_u32 v28, v28, 4, s50
  v_add_u32 v55, v28, v29
  v_mfma_f32_16x16x32_bf16 v[88:91], v[164:167], v[184:187], v[88:91]
  ds_read_b64_tr_b16 v[150:151], v15 offset:17408
  v_add_u32 v28, 256, v0
  v_mul_u32_u24 v29, 4682, v28
  v_mfma_f32_16x16x32_bf16 v[72:75], v[160:163], v[184:187], v[72:75]
  ds_read_b128 v[132:135], v12 offset:18432
  v_lshrrev_b32 v29, 16, v29
  v_mul_u32_u24 v29, 3232, v29
  v_lshl_add_u32 v28, v28, 4, s50
  v_mfma_f32_16x16x32_bf16 v[104:107], v[168:171], v[184:187], v[104:107]
  buffer_load_dwordx4 v5, s[4:7], s57 offen offset:1024 lds
  ds_read_b64_tr_b16 v[152:153], v16 offset:16384
  v_add_u32 v56, v28, v29
  v_cmp_gt_u32 vcc, 192, v0
  v_mfma_f32_16x16x32_bf16 v[100:103], v[168:171], v[180:183], v[100:103]
  ds_read_b64_tr_b16 v[154:155], v16 offset:17408
  v_add_u32 v28, 4096, v2
  v_lshrrev_b32 v30, 4, v1
  v_mfma_f32_16x16x32_bf16 v[96:99], v[168:171], v[176:179], v[96:99]
  ds_read_b128 v[136:139], v12 offset:20480
  v_cndmask_b32 v56, v32, v56, vcc
  v_cndmask_b32 v248, v32, v28, vcc
  v_bfe_u32 v29, v1, 2, 2
  v_mfma_f32_16x16x32_bf16 v[108:111], v[168:171], v[188:191], v[108:111]
  ds_read_b64_tr_b16 v[156:157], v17 offset:16384
  v_lshl_add_u32 v28, v30, 3, v29
  v_mul_u32_u24 v28, 224, v28
  v_mfma_f32_16x16x32_bf16 v[92:95], v[164:167], v[188:191], v[92:95]
  buffer_load_dwordx4 v6, s[4:7], s57 offen offset:2048 lds
  ds_read_b64_tr_b16 v[158:159], v17 offset:17408
  v_and_b32 v29, 3, v1
  s_and_b32 s51, s48, 1
  s_and_b32 s50, s36, 1
  v_mfma_f32_16x16x32_bf16 v[76:79], v[160:163], v[188:191], v[76:79]
  ds_read_b128 v[140:143], v12 offset:22528
  s_add_u32 s51, s51, s50
  s_and_b32 s50, s36, 2
  v_mfma_f32_16x16x32_bf16 v[124:127], v[172:175], v[188:191], v[124:127]
  s_lshl_b32 s50, s50, 5
  s_lshl3_add_u32 s51, s51, s50
  s_add_u32 s51, s51, 143360
  v_mfma_f32_16x16x32_bf16 v[120:123], v[172:175], v[184:187], v[120:123]
  v_add_u32 v28, s51, v28
  v_lshl_add_u32 v246, v29, 4, v28
  v_mfma_f32_16x16x32_bf16 v[116:119], v[172:175], v[180:183], v[116:119]
  buffer_load_dwordx4 v7, s[4:7], s57 offen offset:3072 lds
  s_cmp_eq_u32 s36, 2
  s_cselect_b32 s51, 3, 4
  s_cselect_b32 s28, 12, 16
  v_lshl_add_u32 v247, v29, s51, v28
  v_mfma_f32_16x16x32_bf16 v[112:115], v[172:175], v[176:179], v[112:115]
  s_waitcnt lgkmcnt(6)
  v_mfma_f32_16x16x32_bf16 v[64:67], v[128:131], v[144:147], v[64:67]
  ds_read_b128 v[160:163], v13 offset:16384
  s_cmp_lg_u32 s76, 1
  s_cbranch_scc1 Lsc_21
  ds_read_b128 v[192:195], v18
  ds_read_b64_tr_b16 v[208:209], v22 offset:0
  ds_read_b64_tr_b16 v[210:211], v22 offset:1024
  ds_read_b128 v[196:199], v19
  ds_read_b64_tr_b16 v[212:213], v22 offset:4096
  ds_read_b64_tr_b16 v[214:215], v22 offset:5120
  ds_read_b128 v[200:203], v20
  ds_read_b64_tr_b16 v[216:217], v22 offset:8192
  ds_read_b64_tr_b16 v[218:219], v22 offset:9216
  ds_read_b128 v[204:207], v21
  ds_read_b64_tr_b16 v[220:221], v22 offset:12288
  ds_read_b64_tr_b16 v[222:223], v22 offset:13312
Lsc_21:
  v_mfma_f32_16x16x32_bf16 v[68:71], v[128:131], v[148:151], v[68:71]
  ds_read_b64_tr_b16 v[176:177], v14 offset:24576
  v_and_b32 v32, 31, v1
  v_lshrrev_b32 v29, 5, v1
  s_add_u32 m0, s59, 114688
  s_mul_i32 s58, s56, 245760
  v_mfma_f32_16x16x32_bf16 v[84:87], v[132:135], v[148:151], v[84:87]
  buffer_load_dwordx4 v8, s[8:11], s58 offen offset:0 lds
  ds_read_b64_tr_b16 v[178:179], v14 offset:25600
  s_mov_b32 s77, 0x3f803f80
  v_mfma_f32_16x16x32_bf16 v[80:83], v[132:135], v[144:147], v[80:83]
  ds_read_b64_tr_b16 v[180:181], v15 offset:24576
  v_mov_b32 v31, 2147418112
  s_lshl2_add_u32 s50, s38, s36
  s_waitcnt lgkmcnt(4)
  v_mfma_f32_16x16x32_bf16 v[88:91], v[132:135], v[152:155], v[88:91]
  buffer_load_dwordx4 v9, s[8:11], s58 offen offset:1024 lds
  ds_read_b64_tr_b16 v[182:183], v15 offset:25600
  s_mul_i32 s50, s50, 5120
  v_mfma_f32_16x16x32_bf16 v[72:75], v[128:131], v[152:155], v[72:75]
  ds_read_b128 v[164:167], v13 offset:18432
  s_add_u32 s50, s50, 28606464
  v_mfma_f32_16x16x32_bf16 v[104:107], v[136:139], v[152:155], v[104:107]
  buffer_load_dwordx4 v10, s[8:11], s58 offen offset:2048 lds
  ds_read_b64_tr_b16 v[184:185], v16 offset:24576
  v_lshl_add_u32 v28, v32, 4, s50
  v_mul_u32_u24 v30, 2560, v29
  v_mfma_f32_16x16x32_bf16 v[100:103], v[136:139], v[148:151], v[100:103]
  ds_read_b64_tr_b16 v[186:187], v16 offset:25600
  v_add_u32 v46, v28, v30
  v_mfma_f32_16x16x32_bf16 v[96:99], v[136:139], v[144:147], v[96:99]
  buffer_load_dwordx4 v11, s[8:11], s58 offen offset:3072 lds
  ds_read_b128 v[168:171], v13 offset:20480
  s_lshl_b32 s50, s62, 9
  v_mfma_f32_16x16x32_bf16 v[108:111], v[136:139], v[156:159], v[108:111]
  ds_read_b64_tr_b16 v[188:189], v17 offset:24576
  v_add_u32 v28, s50, v28
  s_cmp_ge_u32 s39, 10
  s_cselect_b32 s50, 48, 0
  s_lshl_b32 s60, s36, 10
  s_add_u32 m0, s60, 131072
  v_mfma_f32_16x16x32_bf16 v[92:95], v[132:135], v[156:159], v[92:95]
  buffer_load_dwordx4 v52, s[24:27], 0 offen  lds
  ds_read_b64_tr_b16 v[190:191], v17 offset:25600
  v_lshrrev_b32 v30, 1, v1
  v_mfma_f32_16x16x32_bf16 v[76:79], v[128:131], v[156:159], v[76:79]
  ds_read_b128 v[172:175], v13 offset:22528
  v_xor_b32 v30, v30, v1
  s_add_u32 m0, s60, 135168
  v_mfma_f32_16x16x32_bf16 v[124:127], v[140:143], v[156:159], v[124:127]
  buffer_load_dwordx4 v53, s[24:27], 0 offen  lds
  v_and_b32 v30, 8, v30
  v_mul_u32_u24 v30, s50, v30
  v_mfma_f32_16x16x32_bf16 v[120:123], v[140:143], v[152:155], v[120:123]
  v_xor_b32 v28, v28, v30
  s_add_u32 m0, s60, 139264
  v_mfma_f32_16x16x32_bf16 v[116:119], v[140:143], v[148:151], v[116:119]
  buffer_load_dwordx4 v54, s[24:27], 0 offen  lds
  s_cmp_lt_u32 s75, 5
  s_cselect_b64 s[50:51], s[44:45], -1
  v_mfma_f32_16x16x32_bf16 v[112:115], v[140:143], v[144:147], v[112:115]
  s_waitcnt lgkmcnt(0)
  v_mfma_f32_16x16x32_bf16 v[64:67], v[160:163], v[176:179], v[64:67]
  s_waitcnt vmcnt(11)
  s_barrier
  ds_read_b128 v[128:131], v12 offset:32768
  v_mfma_f32_16x16x32_bf16 v[68:71], v[160:163], v[180:183], v[68:71]
  ds_read_b64_tr_b16 v[144:145], v14 offset:32768
  v_cndmask_b32 v44, v28, v31, s[50:51]
  s_lshl2_add_u32 s50, s39, s36
  s_add_u32 s56, s56, 1
  s_cmp_eq_u32 s56, 10
  s_cselect_b32 s56, 0, s56
  s_add_u32 m0, s59, 0
  s_lshl_b32 s57, s56, 7
  v_mfma_f32_16x16x32_bf16 v[84:87], v[164:167], v[180:183], v[84:87]
  buffer_load_dwordx4 v4, s[4:7], s57 offen offset:0 lds
  ds_read_b64_tr_b16 v[146:147], v14 offset:33792
  s_mul_i32 s50, s50, 2560
  v_mfma_f32_16x16x32_bf16 v[80:83], v[164:167], v[176:179], v[80:83]
  ds_read_b64_tr_b16 v[148:149], v15 offset:32768
  s_add_u32 s50, s50, 28934144
  v_lshl_add_u32 v28, v32, 3, s50
  v_mfma_f32_16x16x32_bf16 v[88:91], v[164:167], v[184:187], v[88:91]
  buffer_load_dwordx4 v5, s[4:7], s57 offen offset:1024 lds
  ds_read_b64_tr_b16 v[150:151], v15 offset:33792
  v_mul_u32_u24 v30, 1280, v29
  v_mfma_f32_16x16x32_bf16 v[72:75], v[160:163], v[184:187], v[72:75]
  ds_read_b128 v[132:135], v12 offset:34816
  v_add_u32 v47, v28, v30
  v_mfma_f32_16x16x32_bf16 v[104:107], v[168:171], v[184:187], v[104:107]
  buffer_load_dwordx4 v6, s[4:7], s57 offen offset:2048 lds
  ds_read_b64_tr_b16 v[152:153], v16 offset:32768
  s_lshl_b32 s50, s62, 8
  v_add_u32 v28, s50, v28
  v_mfma_f32_16x16x32_bf16 v[100:103], v[168:171], v[180:183], v[100:103]
  ds_read_b64_tr_b16 v[154:155], v16 offset:33792
  s_cmp_lt_u32 s74, 5
  s_cselect_b64 s[50:51], s[44:45], -1
  v_mfma_f32_16x16x32_bf16 v[96:99], v[168:171], v[176:179], v[96:99]
  ds_read_b128 v[136:139], v12 offset:36864
  v_cndmask_b32 v45, v28, v31, s[50:51]
  v_mfma_f32_16x16x32_bf16 v[108:111], v[168:171], v[188:191], v[108:111]
  buffer_load_dwordx4 v7, s[4:7], s57 offen offset:3072 lds
  ds_read_b64_tr_b16 v[156:157], v17 offset:32768
  s_lshl_b32 s50, s36, 7
  s_add_u32 s50, s50, 153600
  v_mfma_f32_16x16x32_bf16 v[92:95], v[164:167], v[188:191], v[92:95]
  ds_read_b64_tr_b16 v[158:159], v17 offset:33792
  v_lshl_add_u32 v50, v32, 2, s50
  s_add_u32 m0, s60, 143360
  v_mfma_f32_16x16x32_bf16 v[76:79], v[160:163], v[188:191], v[76:79]
  buffer_load_dwordx4 v55, s[16:19], 0 offen  lds
  ds_read_b128 v[140:143], v12 offset:38912
  s_and_b32 s48, s2, 7
  v_mfma_f32_16x16x32_bf16 v[124:127], v[172:175], v[188:191], v[124:127]
  s_lshr_b32 s49, s2, 3
  s_lshr_b32 s40, s49, 3
  s_add_u32 m0, s60, 147456
  v_mfma_f32_16x16x32_bf16 v[120:123], v[172:175], v[184:187], v[120:123]
  buffer_load_dwordx4 v56, s[16:19], 0 offen  lds
  s_lshl2_add_u32 s40, s48, s40
  v_mfma_f32_16x16x32_bf16 v[116:119], v[172:175], v[180:183], v[116:119]
  s_and_b32 s41, s49, 7
  v_mfma_f32_16x16x32_bf16 v[112:115], v[172:175], v[176:179], v[112:115]
  s_waitcnt lgkmcnt(6)
  v_mfma_f32_16x16x32_bf16 v[64:67], v[128:131], v[144:147], v[64:67]
  ds_read_b128 v[160:163], v13 offset:32768
  s_cmp_lg_u32 s76, 2
  s_cbranch_scc1 Lsc_22
  ds_read_b128 v[192:195], v18
  ds_read_b64_tr_b16 v[208:209], v22 offset:0
  ds_read_b64_tr_b16 v[210:211], v22 offset:1024
  ds_read_b128 v[196:199], v19
  ds_read_b64_tr_b16 v[212:213], v22 offset:4096
  ds_read_b64_tr_b16 v[214:215], v22 offset:5120
  ds_read_b128 v[200:203], v20
  ds_read_b64_tr_b16 v[216:217], v22 offset:8192
  ds_read_b64_tr_b16 v[218:219], v22 offset:9216
  ds_read_b128 v[204:207], v21
  ds_read_b64_tr_b16 v[220:221], v22 offset:12288
  ds_read_b64_tr_b16 v[222:223], v22 offset:13312
Lsc_22:
  v_mfma_f32_16x16x32_bf16 v[68:71], v[128:131], v[148:151], v[68:71]
  ds_read_b64_tr_b16 v[176:177], v14 offset:40960
  s_lshr_b32 s42, s40, 1
  s_and_b32 s85, s2, 1
  s_add_u32 m0, s59, 65536
  s_mul_i32 s58, s56, 245760
  v_mfma_f32_16x16x32_bf16 v[84:87], v[132:135], v[148:151], v[84:87]
  buffer_load_dwordx4 v8, s[8:11], s58 offen offset:0 lds
  ds_read_b64_tr_b16 v[178:179], v14 offset:41984
  s_lshl3_add_u32 s43, s85, s41
  v_mfma_f32_16x16x32_bf16 v[80:83], v[132:135], v[144:147], v[80:83]
  ds_read_b64_tr_b16 v[180:181], v15 offset:40960
  s_andn2_b32 s3, s40, 4
  s_and_b32 s48, s36, 2
  s_waitcnt lgkmcnt(4)
  v_mfma_f32_16x16x32_bf16 v[88:91], v[132:135], v[152:155], v[88:91]
  ds_read_b64_tr_b16 v[182:183], v15 offset:41984
  s_lshl1_add_u32 s3, s48, s3
  v_mfma_f32_16x16x32_bf16 v[72:75], v[128:131], v[152:155], v[72:75]
  ds_read_b128 v[164:167], v13 offset:34816
  s_and_b32 s48, s36, 1
  v_mfma_f32_16x16x32_bf16 v[104:107], v[136:139], v[152:155], v[104:107]
  buffer_load_dwordx4 v9, s[8:11], s58 offen offset:1024 lds
  ds_read_b64_tr_b16 v[184:185], v16 offset:40960
  s_lshl1_add_u32 s3, s3, s48
  s_lshl2_add_u32 s47, s41, s36
  v_mfma_f32_16x16x32_bf16 v[100:103], v[136:139], v[148:151], v[100:103]
  ds_read_b64_tr_b16 v[186:187], v16 offset:41984
  s_and_b32 s93, s41, 0
  v_mfma_f32_16x16x32_bf16 v[96:99], v[136:139], v[144:147], v[96:99]
  ds_read_b128 v[168:171], v13 offset:36864
  s_xor_b32 s93, s93, s36
  v_mfma_f32_16x16x32_bf16 v[108:111], v[136:139], v[156:159], v[108:111]
  ds_read_b64_tr_b16 v[188:189], v17 offset:40960
  s_getreg_b32 s87, hwreg(HW_REG_XCC_ID, 0, 4)
  s_mul_i32 s90, s47, 25600
  v_mfma_f32_16x16x32_bf16 v[92:95], v[132:135], v[156:159], v[92:95]
  buffer_load_dwordx4 v10, s[8:11], s58 offen offset:2048 lds
  ds_read_b64_tr_b16 v[190:191], v17 offset:41984
  s_add_u32 s90, s90, 20582400
  v_mfma_f32_16x16x32_bf16 v[76:79], v[128:131], v[156:159], v[76:79]
  ds_read_b128 v[172:175], v13 offset:38912
  s_lshl2_add_u32 s91, s43, s36
  v_mfma_f32_16x16x32_bf16 v[124:127], v[140:143], v[156:159], v[124:127]
  s_mul_i32 s91, s91, 35840
  s_add_u32 s91, s91, 21397504
  v_mfma_f32_16x16x32_bf16 v[120:123], v[140:143], v[152:155], v[120:123]
  s_mul_i32 s95, s36, 35840
  v_mfma_f32_16x16x32_bf16 v[116:119], v[140:143], v[148:151], v[116:119]
  buffer_load_dwordx4 v11, s[8:11], s58 offen offset:3072 lds
  s_lshl2_add_u32 s85, s85, s36
  v_mfma_f32_16x16x32_bf16 v[112:115], v[140:143], v[144:147], v[112:115]
  s_waitcnt lgkmcnt(0)
  v_mfma_f32_16x16x32_bf16 v[64:67], v[160:163], v[176:179], v[64:67]
  s_waitcnt vmcnt(13)
  s_barrier
  ds_read_b128 v[128:131], v12 offset:49152
  v_mfma_f32_16x16x32_bf16 v[68:71], v[160:163], v[180:183], v[68:71]
  ds_read_b64_tr_b16 v[144:145], v14 offset:49152
  s_lshl3_add_u32 s92, s41, s85
  s_mul_i32 s92, s92, 35840
  s_add_u32 s56, s56, 1
  s_cmp_eq_u32 s56, 10
  s_cselect_b32 s56, 0, s56
  s_add_u32 m0, s59, 16384
  s_lshl_b32 s57, s56, 7
  v_mfma_f32_16x16x32_bf16 v[84:87], v[164:167], v[180:183], v[84:87]
  buffer_load_dwordx4 v4, s[4:7], s57 offen offset:0 lds
  ds_read_b64_tr_b16 v[146:147], v14 offset:50176
  s_add_u32 s92, s92, 23695360
  v_mfma_f32_16x16x32_bf16 v[80:83], v[164:167], v[176:179], v[80:83]
  ds_read_b64_tr_b16 v[148:149], v15 offset:49152
  s_mul_i32 s48, s36, 640
  v_mfma_f32_16x16x32_bf16 v[88:91], v[164:167], v[184:187], v[88:91]
  ds_read_b64_tr_b16 v[150:151], v15 offset:50176
  s_lshl_b32 s49, s41, 12
  s_add_u32 s48, s48, s49
  v_mfma_f32_16x16x32_bf16 v[72:75], v[160:163], v[184:187], v[72:75]
  ds_read_b128 v[132:135], v12 offset:51200
  s_add_u32 s48, s48, 262144
  v_mfma_f32_16x16x32_bf16 v[104:107], v[168:171], v[184:187], v[104:107]
  buffer_load_dwordx4 v5, s[4:7], s57 offen offset:1024 lds
  ds_read_b64_tr_b16 v[152:153], v16 offset:49152
  v_min_u32 v59, 4, v1
  v_mfma_f32_16x16x32_bf16 v[100:103], v[168:171], v[180:183], v[100:103]
  ds_read_b64_tr_b16 v[154:155], v16 offset:50176
  v_lshl_add_u32 v59, v59, 7, s48
  v_mfma_f32_16x16x32_bf16 v[96:99], v[168:171], v[176:179], v[96:99]
  ds_read_b128 v[136:139], v12 offset:53248
  s_lshl3_add_u32 s48, s40, s41
  s_lshl_b32 s48, s48, 7
  v_mfma_f32_16x16x32_bf16 v[108:111], v[168:171], v[188:191], v[108:111]
  ds_read_b64_tr_b16 v[156:157], v17 offset:49152
  s_add_u32 s48, s48, 29229056
  v_mfma_f32_16x16x32_bf16 v[92:95], v[164:167], v[188:191], v[92:95]
  buffer_load_dwordx4 v6, s[4:7], s57 offen offset:2048 lds
  ds_read_b64_tr_b16 v[158:159], v17 offset:50176
  s_add_u32 s49, s37, s87
  v_mfma_f32_16x16x32_bf16 v[76:79], v[160:163], v[188:191], v[76:79]
  ds_read_b128 v[140:143], v12 offset:55296
  v_mov_b32 v61, s49
  v_lshrrev_b32 v62, 5, v0
  v_mfma_f32_16x16x32_bf16 v[124:127], v[172:175], v[188:191], v[124:127]
  v_lshlrev_b32 v62, 27, v62
  v_mfma_f32_16x16x32_bf16 v[120:123], v[172:175], v[184:187], v[120:123]
  v_lshl_add_u32 v62, v0, 2, v62
  v_mfma_f32_16x16x32_bf16 v[116:119], v[172:175], v[180:183], v[116:119]
  buffer_load_dwordx4 v7, s[4:7], s57 offen offset:3072 lds
  buffer_store_dword v61, v62, s[12:15], s48 offen sc1
  v_mfma_f32_16x16x32_bf16 v[112:115], v[172:175], v[176:179], v[112:115]
  s_waitcnt lgkmcnt(6)
  v_mfma_f32_16x16x32_bf16 v[64:67], v[128:131], v[144:147], v[64:67]
  ds_read_b128 v[160:163], v13 offset:49152
  s_cmp_lg_u32 s76, 3
  s_cbranch_scc1 Lsc_23
  ds_read_b128 v[192:195], v18
  ds_read_b64_tr_b16 v[208:209], v22 offset:0
  ds_read_b64_tr_b16 v[210:211], v22 offset:1024
  ds_read_b128 v[196:199], v19
  ds_read_b64_tr_b16 v[212:213], v22 offset:4096
  ds_read_b64_tr_b16 v[214:215], v22 offset:5120
  ds_read_b128 v[200:203], v20
  ds_read_b64_tr_b16 v[216:217], v22 offset:8192
  ds_read_b64_tr_b16 v[218:219], v22 offset:9216
  ds_read_b128 v[204:207], v21
  ds_read_b64_tr_b16 v[220:221], v22 offset:12288
  ds_read_b64_tr_b16 v[222:223], v22 offset:13312
Lsc_23:
  v_mfma_f32_16x16x32_bf16 v[68:71], v[128:131], v[148:151], v[68:71]
  ds_read_b64_tr_b16 v[176:177], v14 offset:57344
  s_lshr_b32 s48, s36, 1
  s_add_u32 m0, s59, 81920
  s_mul_i32 s58, s56, 245760
  v_mfma_f32_16x16x32_bf16 v[84:87], v[132:135], v[148:151], v[84:87]
  buffer_load_dwordx4 v8, s[8:11], s58 offen offset:0 lds
  ds_read_b64_tr_b16 v[178:179], v14 offset:58368
  v_mfma_f32_16x16x32_bf16 v[80:83], v[132:135], v[144:147], v[80:83]
  ds_read_b64_tr_b16 v[180:181], v15 offset:57344
  s_waitcnt lgkmcnt(4)
  v_mfma_f32_16x16x32_bf16 v[88:91], v[132:135], v[152:155], v[88:91]
  ds_read_b64_tr_b16 v[182:183], v15 offset:58368
  v_mfma_f32_16x16x32_bf16 v[72:75], v[128:131], v[152:155], v[72:75]
  ds_read_b128 v[164:167], v13 offset:51200
  s_and_b32 s49, s36, 1
  v_mfma_f32_16x16x32_bf16 v[104:107], v[136:139], v[152:155], v[104:107]
  buffer_load_dwordx4 v9, s[8:11], s58 offen offset:1024 lds
  ds_read_b64_tr_b16 v[184:185], v16 offset:57344
  v_mfma_f32_16x16x32_bf16 v[100:103], v[136:139], v[148:151], v[100:103]
  ds_read_b64_tr_b16 v[186:187], v16 offset:58368
  v_mfma_f32_16x16x32_bf16 v[96:99], v[136:139], v[144:147], v[96:99]
  ds_read_b128 v[168:171], v13 offset:53248
  v_mfma_f32_16x16x32_bf16 v[108:111], v[136:139], v[156:159], v[108:111]
  ds_read_b64_tr_b16 v[188:189], v17 offset:57344
  v_mfma_f32_16x16x32_bf16 v[92:95], v[132:135], v[156:159], v[92:95]
  buffer_load_dwordx4 v10, s[8:11], s58 offen offset:2048 lds
  ds_read_b64_tr_b16 v[190:191], v17 offset:58368
  s_lshl1_add_u32 s50, s38, s48
  v_mfma_f32_16x16x32_bf16 v[76:79], v[128:131], v[156:159], v[76:79]
  ds_read_b128 v[172:175], v13 offset:55296
  v_mfma_f32_16x16x32_bf16 v[124:127], v[140:143], v[156:159], v[124:127]
  v_mfma_f32_16x16x32_bf16 v[120:123], v[140:143], v[152:155], v[120:123]
  v_mfma_f32_16x16x32_bf16 v[116:119], v[140:143], v[148:151], v[116:119]
  buffer_load_dwordx4 v11, s[8:11], s58 offen offset:3072 lds
  v_mfma_f32_16x16x32_bf16 v[112:115], v[140:143], v[144:147], v[112:115]
  s_waitcnt lgkmcnt(0)
  v_mfma_f32_16x16x32_bf16 v[64:67], v[160:163], v[176:179], v[64:67]
  s_waitcnt vmcnt(9)
  s_barrier
  ds_read_b128 v[128:131], v12 offset:0
  v_mfma_f32_16x16x32_bf16 v[68:71], v[160:163], v[180:183], v[68:71]
  ds_read_b64_tr_b16 v[144:145], v14 offset:0
  s_lshl1_add_u32 s51, s39, s49
  s_add_u32 s56, s56, 1
  s_cmp_eq_u32 s56, 10
  s_cselect_b32 s56, 0, s56
  s_add_u32 m0, s59, 32768
  s_lshl_b32 s57, s56, 7
  v_mfma_f32_16x16x32_bf16 v[84:87], v[164:167], v[180:183], v[84:87]
  buffer_load_dwordx4 v4, s[4:7], s57 offen offset:0 lds
  ds_read_b64_tr_b16 v[146:147], v14 offset:1024
  v_mfma_f32_16x16x32_bf16 v[80:83], v[164:167], v[176:179], v[80:83]
  ds_read_b64_tr_b16 v[148:149], v15 offset:0
  v_mfma_f32_16x16x32_bf16 v[88:91], v[164:167], v[184:187], v[88:91]
  ds_read_b64_tr_b16 v[150:151], v15 offset:1024
  v_mfma_f32_16x16x32_bf16 v[72:75], v[160:163], v[184:187], v[72:75]
  ds_read_b128 v[132:135], v12 offset:2048
  s_lshl_b32 s48, s48, 8
  v_mfma_f32_16x16x32_bf16 v[104:107], v[168:171], v[184:187], v[104:107]
  buffer_load_dwordx4 v5, s[4:7], s57 offen offset:1024 lds
  ds_read_b64_tr_b16 v[152:153], v16 offset:0
  v_mfma_f32_16x16x32_bf16 v[100:103], v[168:171], v[180:183], v[100:103]
  ds_read_b64_tr_b16 v[154:155], v16 offset:1024
  v_mfma_f32_16x16x32_bf16 v[96:99], v[168:171], v[176:179], v[96:99]
  ds_read_b128 v[136:139], v12 offset:4096
  v_mfma_f32_16x16x32_bf16 v[108:111], v[168:171], v[188:191], v[108:111]
  ds_read_b64_tr_b16 v[156:157], v17 offset:0
  v_mfma_f32_16x16x32_bf16 v[92:95], v[164:167], v[188:191], v[92:95]
  buffer_load_dwordx4 v6, s[4:7], s57 offen offset:2048 lds
  ds_read_b64_tr_b16 v[158:159], v17 offset:1024
  s_add_u32 s48, s48, 153600
  v_mfma_f32_16x16x32_bf16 v[76:79], v[160:163], v[188:191], v[76:79]
  ds_read_b128 v[140:143], v12 offset:6144
  v_mfma_f32_16x16x32_bf16 v[124:127], v[172:175], v[188:191], v[124:127]
  v_mfma_f32_16x16x32_bf16 v[120:123], v[172:175], v[184:187], v[120:123]
  v_mfma_f32_16x16x32_bf16 v[116:119], v[172:175], v[180:183], v[116:119]
  buffer_load_dwordx4 v7, s[4:7], s57 offen offset:3072 lds
  v_mfma_f32_16x16x32_bf16 v[112:115], v[172:175], v[176:179], v[112:115]
  s_waitcnt lgkmcnt(6)
  v_mfma_f32_16x16x32_bf16 v[64:67], v[128:131], v[144:147], v[64:67]
  ds_read_b128 v[160:163], v13 offset:0
  s_cmp_lg_u32 s76, 4
  s_cbranch_scc1 Lsc_24
  ds_read_b128 v[192:195], v18
  ds_read_b64_tr_b16 v[208:209], v22 offset:0
  ds_read_b64_tr_b16 v[210:211], v22 offset:1024
  ds_read_b128 v[196:199], v19
  ds_read_b64_tr_b16 v[212:213], v22 offset:4096
  ds_read_b64_tr_b16 v[214:215], v22 offset:5120
  ds_read_b128 v[200:203], v20
  ds_read_b64_tr_b16 v[216:217], v22 offset:8192
  ds_read_b64_tr_b16 v[218:219], v22 offset:9216
  ds_read_b128 v[204:207], v21
  ds_read_b64_tr_b16 v[220:221], v22 offset:12288
  ds_read_b64_tr_b16 v[222:223], v22 offset:13312
Lsc_24:
  v_mfma_f32_16x16x32_bf16 v[68:71], v[128:131], v[148:151], v[68:71]
  ds_read_b64_tr_b16 v[176:177], v14 offset:8192
  s_lshl_b32 s49, s49, 8
  s_add_u32 m0, s59, 98304
  s_mul_i32 s58, s56, 245760
  v_mfma_f32_16x16x32_bf16 v[84:87], v[132:135], v[148:151], v[84:87]
  buffer_load_dwordx4 v8, s[8:11], s58 offen offset:0 lds
  ds_read_b64_tr_b16 v[178:179], v14 offset:9216
  ds_read_b64_tr_b16 v[24:25], v240 offset:0
  v_mfma_f32_16x16x32_bf16 v[80:83], v[132:135], v[144:147], v[80:83]
  ds_read_b64_tr_b16 v[180:181], v15 offset:8192
  ds_read_b64_tr_b16 v[26:27], v240 offset:1280
  s_waitcnt lgkmcnt(6)
  v_mfma_f32_16x16x32_bf16 v[88:91], v[132:135], v[152:155], v[88:91]
  ds_read_b64_tr_b16 v[182:183], v15 offset:9216
  ds_read_b64_tr_b16 v[224:225], v241 offset:0
  v_mfma_f32_16x16x32_bf16 v[72:75], v[128:131], v[152:155], v[72:75]
  ds_read_b128 v[164:167], v13 offset:2048
  ds_read_b64_tr_b16 v[226:227], v241 offset:1280
  v_mfma_f32_16x16x32_bf16 v[104:107], v[136:139], v[152:155], v[104:107]
  buffer_load_dwordx4 v9, s[8:11], s58 offen offset:1024 lds
  ds_read_b64_tr_b16 v[184:185], v16 offset:8192
  s_add_u32 s49, s49, 154624
  v_mfma_f32_16x16x32_bf16 v[100:103], v[136:139], v[148:151], v[100:103]
  ds_read_b64_tr_b16 v[186:187], v16 offset:9216
  ds_read_b64_tr_b16 v[228:229], v242 offset:0
  v_mfma_f32_16x16x32_bf16 v[96:99], v[136:139], v[144:147], v[96:99]
  ds_read_b128 v[168:171], v13 offset:4096
  ds_read_b64_tr_b16 v[230:231], v242 offset:1280
  s_waitcnt lgkmcnt(12)
  v_dot2_f32_bf16 v36, v192, s77, 0
  v_dot2_f32_bf16 v38, v192, v192, 0
  v_dot2_f32_bf16 v40, v208, s77, 0
  v_dot2_f32_bf16 v36, v193, s77, v36
  v_dot2_f32_bf16 v38, v193, v193, v38
  v_dot2_f32_bf16 v40, v209, s77, v40
  v_dot2_f32_bf16 v36, v194, s77, v36
  v_dot2_f32_bf16 v38, v194, v194, v38
  v_dot2_f32_bf16 v40, v210, s77, v40
  v_dot2_f32_bf16 v36, v195, s77, v36
  v_dot2_f32_bf16 v38, v195, v195, v38
  v_dot2_f32_bf16 v40, v211, s77, v40
  v_dot2_f32_bf16 v36, v196, s77, v36
  v_dot2_f32_bf16 v38, v196, v196, v38
  v_dot2_f32_bf16 v40, v212, s77, v40
  v_dot2_f32_bf16 v36, v197, s77, v36
  v_dot2_f32_bf16 v38, v197, v197, v38
  v_dot2_f32_bf16 v40, v213, s77, v40
  v_dot2_f32_bf16 v36, v198, s77, v36
  v_dot2_f32_bf16 v38, v198, v198, v38
  v_dot2_f32_bf16 v40, v214, s77, v40
  v_dot2_f32_bf16 v36, v199, s77, v36
  v_dot2_f32_bf16 v38, v199, v199, v38
  v_dot2_f32_bf16 v40, v215, s77, v40
  v_dot2_f32_bf16 v36, v200, s77, v36
  v_dot2_f32_bf16 v38, v200, v200, v38
  v_dot2_f32_bf16 v40, v216, s77, v40
  v_dot2_f32_bf16 v36, v201, s77, v36
  v_dot2_f32_bf16 v38, v201, v201, v38
  v_dot2_f32_bf16 v40, v217, s77, v40
  v_dot2_f32_bf16 v36, v202, s77, v36
  v_dot2_f32_bf16 v38, v202, v202, v38
  v_dot2_f32_bf16 v40, v218, s77, v40
  v_dot2_f32_bf16 v36, v203, s77, v36
  v_dot2_f32_bf16 v38, v203, v203, v38
  v_dot2_f32_bf16 v40, v219, s77, v40
  v_dot2_f32_bf16 v36, v204, s77, v36
  v_dot2_f32_bf16 v38, v204, v204, v38
  v_dot2_f32_bf16 v40, v220, s77, v40
  v_dot2_f32_bf16 v36, v205, s77, v36
  v_dot2_f32_bf16 v38, v205, v205, v38
  v_dot2_f32_bf16 v40, v221, s77, v40
  v_dot2_f32_bf16 v36, v206, s77, v36
  v_dot2_f32_bf16 v38, v206, v206, v38
  v_dot2_f32_bf16 v40, v222, s77, v40
  v_dot2_f32_bf16 v36, v207, s77, v36
  v_dot2_f32_bf16 v38, v207, v207, v38
  v_dot2_f32_bf16 v40, v223, s77, v40
  v_mfma_f32_16x16x32_bf16 v[108:111], v[136:139], v[156:159], v[108:111]
  ds_read_b64_tr_b16 v[188:189], v17 offset:8192
  ds_read_b64_tr_b16 v[232:233], v246 offset:0
  v_mfma_f32_16x16x32_bf16 v[92:95], v[132:135], v[156:159], v[92:95]
  buffer_load_dwordx4 v10, s[8:11], s58 offen offset:2048 lds
  ds_read_b64_tr_b16 v[190:191], v17 offset:9216
  v_lshrrev_b32 v32, 4, v1
  v_mfma_f32_16x16x32_bf16 v[76:79], v[128:131], v[156:159], v[76:79]
  ds_read_b128 v[172:175], v13 offset:6144
  ds_read_b64_tr_b16 v[234:235], v246 offset:896
  v_mov_b32 v37, v36
  v_mov_b32 v39, v38
  v_mov_b32 v41, v40
  v_mfma_f32_16x16x32_bf16 v[124:127], v[140:143], v[156:159], v[124:127]
  ds_read_b64_tr_b16 v[236:237], v247 offset:128
  v_permlane32_swap_b32 v36, v37
  v_permlane32_swap_b32 v38, v39
  v_permlane32_swap_b32 v40, v41
  v_mfma_f32_16x16x32_bf16 v[120:123], v[140:143], v[152:155], v[120:123]
  ds_read_b64_tr_b16 v[238:239], v247 offset:1024
  v_add_f32 v36, v36, v37
  v_add_f32 v38, v38, v39
  v_add_f32 v40, v40, v41
  v_mfma_f32_16x16x32_bf16 v[116:119], v[140:143], v[148:151], v[116:119]
  buffer_load_dwordx4 v11, s[8:11], s58 offen offset:3072 lds
  v_mov_b32 v37, s37
  v_mov_b32 v39, s37
  v_mov_b32 v41, s37
  v_mfma_f32_16x16x32_bf16 v[112:115], v[140:143], v[144:147], v[112:115]
  buffer_store_dwordx4 v[36:39], v44, s[12:15], 0 offen sc1
  buffer_store_dwordx2 v[40:41], v45, s[12:15], 0 offen sc1
  s_waitcnt lgkmcnt(3)
  v_mfma_f32_16x16x32_bf16 v[64:67], v[160:163], v[176:179], v[64:67]
  s_waitcnt vmcnt(10)
  s_barrier
  ds_read_b128 v[128:131], v12 offset:16384
  v_mfma_f32_16x16x32_bf16 v[68:71], v[160:163], v[180:183], v[68:71]
  ds_read_b64_tr_b16 v[144:145], v14 offset:16384
  v_and_b32 v246, 15, v1
  s_add_u32 s56, s56, 1
  s_cmp_eq_u32 s56, 10
  s_cselect_b32 s56, 0, s56
  s_add_u32 m0, s59, 49152
  s_lshl_b32 s57, s56, 7
  v_mfma_f32_16x16x32_bf16 v[84:87], v[164:167], v[180:183], v[84:87]
  buffer_load_dwordx4 v4, s[4:7], s57 offen offset:0 lds
  ds_read_b64_tr_b16 v[146:147], v14 offset:17408
  v_cmp_gt_u32 vcc, s28, v246
  v_mfma_f32_16x16x32_bf16 v[80:83], v[164:167], v[176:179], v[80:83]
  ds_read_b64_tr_b16 v[148:149], v15 offset:16384
  s_mov_b64 s[24:25], s[12:13]
  s_mov_b32 s26, s100
  v_mfma_f32_16x16x32_bf16 v[88:91], v[164:167], v[184:187], v[88:91]
  buffer_store_dwordx4 v[24:27], v2, s[24:27], s82 offen sc1
  ds_read_b64_tr_b16 v[150:151], v15 offset:17408
  s_waitcnt lgkmcnt(6)
  v_cndmask_b32 v236, 0, v236, vcc
  v_mfma_f32_16x16x32_bf16 v[72:75], v[160:163], v[184:187], v[72:75]
  ds_read_b128 v[132:135], v12 offset:18432
  v_cndmask_b32 v237, 0, v237, vcc
  v_mfma_f32_16x16x32_bf16 v[104:107], v[168:171], v[184:187], v[104:107]
  ds_read_b64_tr_b16 v[152:153], v16 offset:16384
  v_mfma_f32_16x16x32_bf16 v[100:103], v[168:171], v[180:183], v[100:103]
  buffer_load_dwordx4 v5, s[4:7], s57 offen offset:1024 lds
  ds_read_b64_tr_b16 v[154:155], v16 offset:17408
  s_waitcnt lgkmcnt(8)
  v_cndmask_b32 v238, 0, v238, vcc
  v_mfma_f32_16x16x32_bf16 v[96:99], v[168:171], v[176:179], v[96:99]
  ds_read_b128 v[136:139], v12 offset:20480
  v_cndmask_b32 v239, 0, v239, vcc
  v_mfma_f32_16x16x32_bf16 v[108:111], v[168:171], v[188:191], v[108:111]
  ds_read_b64_tr_b16 v[156:157], v17 offset:16384
  v_mfma_f32_16x16x32_bf16 v[92:95], v[164:167], v[188:191], v[92:95]
  buffer_load_dwordx4 v6, s[4:7], s57 offen offset:2048 lds
  ds_read_b64_tr_b16 v[158:159], v17 offset:17408
  v_and_b32 v33, 15, v1
  v_mfma_f32_16x16x32_bf16 v[76:79], v[160:163], v[188:191], v[76:79]
  ds_read_b128 v[140:143], v12 offset:22528
  v_lshl_add_u32 v28, v33, 2, s49
  v_mfma_f32_16x16x32_bf16 v[124:127], v[172:175], v[188:191], v[124:127]
  v_mfma_f32_16x16x32_bf16 v[120:123], v[172:175], v[184:187], v[120:123]
  buffer_load_dwordx4 v7, s[4:7], s57 offen offset:3072 lds
  v_lshl_add_u32 v29, v32, 4, s48
  v_mfma_f32_16x16x32_bf16 v[116:119], v[172:175], v[180:183], v[116:119]
  v_mfma_f32_16x16x32_bf16 v[112:115], v[172:175], v[176:179], v[112:115]
  s_waitcnt lgkmcnt(6)
  v_mfma_f32_16x16x32_bf16 v[64:67], v[128:131], v[144:147], v[64:67]
  ds_read_b128 v[160:163], v13 offset:16384
  v_mfma_f32_16x16x32_bf16 v[68:71], v[128:131], v[148:151], v[68:71]
  ds_read_b64_tr_b16 v[176:177], v14 offset:24576
  v_and_b32 v30, 32, v1
  s_add_u32 m0, s59, 114688
  s_mul_i32 s58, s56, 245760
  v_mfma_f32_16x16x32_bf16 v[84:87], v[132:135], v[148:151], v[84:87]
  buffer_load_dwordx4 v8, s[8:11], s58 offen offset:0 lds
  ds_read_b64_tr_b16 v[178:179], v14 offset:25600
  v_mfma_f32_16x16x32_bf16 v[80:83], v[132:135], v[144:147], v[80:83]
  ds_read_b64_tr_b16 v[180:181], v15 offset:24576
  s_waitcnt lgkmcnt(4)
  v_mfma_f32_16x16x32_bf16 v[88:91], v[132:135], v[152:155], v[88:91]
  buffer_store_dwordx4 v[224:227], v2, s[24:27], s83 offen sc1
  ds_read_b64_tr_b16 v[182:183], v15 offset:25600
  v_mfma_f32_16x16x32_bf16 v[72:75], v[128:131], v[152:155], v[72:75]
  ds_read_b128 v[164:167], v13 offset:18432
  v_add_u32 v29, v29, v30
  v_mfma_f32_16x16x32_bf16 v[104:107], v[136:139], v[152:155], v[104:107]
  ds_read_b64_tr_b16 v[184:185], v16 offset:24576
  v_mfma_f32_16x16x32_bf16 v[100:103], v[136:139], v[148:151], v[100:103]
  buffer_load_dwordx4 v9, s[8:11], s58 offen offset:1024 lds
  ds_read_b64_tr_b16 v[186:187], v16 offset:25600
  v_mfma_f32_16x16x32_bf16 v[96:99], v[136:139], v[144:147], v[96:99]
  ds_read_b128 v[168:171], v13 offset:20480
  v_mfma_f32_16x16x32_bf16 v[108:111], v[136:139], v[156:159], v[108:111]
  ds_read_b64_tr_b16 v[188:189], v17 offset:24576
  v_mfma_f32_16x16x32_bf16 v[92:95], v[132:135], v[156:159], v[92:95]
  buffer_load_dwordx4 v10, s[8:11], s58 offen offset:2048 lds
  ds_read_b64_tr_b16 v[190:191], v17 offset:25600
  v_mul_u32_u24 v32, 9984, v32
  v_mfma_f32_16x16x32_bf16 v[76:79], v[128:131], v[156:159], v[76:79]
  ds_read_b128 v[172:175], v13 offset:22528
  v_mfma_f32_16x16x32_bf16 v[124:127], v[140:143], v[156:159], v[124:127]
  v_mfma_f32_16x16x32_bf16 v[120:123], v[140:143], v[152:155], v[120:123]
  buffer_load_dwordx4 v11, s[8:11], s58 offen offset:3072 lds
  v_mfma_f32_16x16x32_bf16 v[116:119], v[140:143], v[148:151], v[116:119]
  v_mfma_f32_16x16x32_bf16 v[112:115], v[140:143], v[144:147], v[112:115]
  s_waitcnt lgkmcnt(0)
  v_mfma_f32_16x16x32_bf16 v[64:67], v[160:163], v[176:179], v[64:67]
  s_waitcnt vmcnt(12)
  s_barrier
  ds_read_b128 v[128:131], v12 offset:32768
  v_mfma_f32_16x16x32_bf16 v[68:71], v[160:163], v[180:183], v[68:71]
  ds_read_b64_tr_b16 v[144:145], v14 offset:32768
  v_add_u32 v32, v2, v32
  s_add_u32 s56, s56, 1
  s_cmp_eq_u32 s56, 10
  s_cselect_b32 s56, 0, s56
  s_add_u32 m0, s59, 0
  s_lshl_b32 s57, s56, 7
  v_mfma_f32_16x16x32_bf16 v[84:87], v[164:167], v[180:183], v[84:87]
  buffer_load_dwordx4 v4, s[4:7], s57 offen offset:0 lds
  ds_read_b64_tr_b16 v[146:147], v14 offset:33792
  v_mfma_f32_16x16x32_bf16 v[80:83], v[164:167], v[176:179], v[80:83]
  ds_read_b64_tr_b16 v[148:149], v15 offset:32768
  v_mfma_f32_16x16x32_bf16 v[88:91], v[164:167], v[184:187], v[88:91]
  buffer_store_dwordx4 v[228:231], v243, s[24:27], s84 offen sc1
  ds_read_b64_tr_b16 v[150:151], v15 offset:33792
  v_mfma_f32_16x16x32_bf16 v[72:75], v[160:163], v[184:187], v[72:75]
  ds_read_b128 v[132:135], v12 offset:34816
  s_lshl4_add_u32 s61, s38, s39
  v_mfma_f32_16x16x32_bf16 v[104:107], v[168:171], v[184:187], v[104:107]
  ds_read_b64_tr_b16 v[152:153], v16 offset:32768
  v_mfma_f32_16x16x32_bf16 v[100:103], v[168:171], v[180:183], v[100:103]
  buffer_load_dwordx4 v5, s[4:7], s57 offen offset:1024 lds
  ds_read_b64_tr_b16 v[154:155], v16 offset:33792
  v_mfma_f32_16x16x32_bf16 v[96:99], v[168:171], v[176:179], v[96:99]
  ds_read_b128 v[136:139], v12 offset:36864
  v_mfma_f32_16x16x32_bf16 v[108:111], v[168:171], v[188:191], v[108:111]
  ds_read_b64_tr_b16 v[156:157], v17 offset:32768
  v_mfma_f32_16x16x32_bf16 v[92:95], v[164:167], v[188:191], v[92:95]
  buffer_load_dwordx4 v6, s[4:7], s57 offen offset:2048 lds
  ds_read_b64_tr_b16 v[158:159], v17 offset:33792
  s_lshl_b32 s61, s61, 7
  v_mfma_f32_16x16x32_bf16 v[76:79], v[160:163], v[188:191], v[76:79]
  ds_read_b128 v[140:143], v12 offset:38912
  v_mfma_f32_16x16x32_bf16 v[124:127], v[172:175], v[188:191], v[124:127]
  v_mfma_f32_16x16x32_bf16 v[120:123], v[172:175], v[184:187], v[120:123]
  buffer_load_dwordx4 v7, s[4:7], s57 offen offset:3072 lds
  v_mfma_f32_16x16x32_bf16 v[116:119], v[172:175], v[180:183], v[116:119]
  v_mfma_f32_16x16x32_bf16 v[112:115], v[172:175], v[176:179], v[112:115]
  s_waitcnt lgkmcnt(6)
  v_mfma_f32_16x16x32_bf16 v[64:67], v[128:131], v[144:147], v[64:67]
  ds_read_b128 v[160:163], v13 offset:32768
  v_mfma_f32_16x16x32_bf16 v[68:71], v[128:131], v[148:151], v[68:71]
  ds_read_b64_tr_b16 v[176:177], v14 offset:40960
  s_add_u32 s61, s61, 29327360
  s_add_u32 m0, s59, 65536
  s_mul_i32 s58, s56, 245760
  v_mfma_f32_16x16x32_bf16 v[84:87], v[132:135], v[148:151], v[84:87]
  buffer_load_dwordx4 v8, s[8:11], s58 offen offset:0 lds
  ds_read_b64_tr_b16 v[178:179], v14 offset:41984
  v_mfma_f32_16x16x32_bf16 v[80:83], v[132:135], v[144:147], v[80:83]
  ds_read_b64_tr_b16 v[180:181], v15 offset:40960
  s_mov_b64 s[16:17], s[12:13]
  s_mov_b32 s18, s79
  s_waitcnt lgkmcnt(4)
  v_mfma_f32_16x16x32_bf16 v[88:91], v[132:135], v[152:155], v[88:91]
  buffer_store_dwordx4 v[232:235], v2, s[16:19], s80 offen sc1
  ds_read_b64_tr_b16 v[182:183], v15 offset:41984
  v_mfma_f32_16x16x32_bf16 v[72:75], v[128:131], v[152:155], v[72:75]
  ds_read_b128 v[164:167], v13 offset:34816
  s_mul_i32 s52, s50, 81920
  v_mfma_f32_16x16x32_bf16 v[104:107], v[136:139], v[152:155], v[104:107]
  ds_read_b64_tr_b16 v[184:185], v16 offset:40960
  v_mfma_f32_16x16x32_bf16 v[100:103], v[136:139], v[148:151], v[100:103]
  buffer_load_dwordx4 v9, s[8:11], s58 offen offset:1024 lds
  ds_read_b64_tr_b16 v[186:187], v16 offset:41984
  v_mfma_f32_16x16x32_bf16 v[96:99], v[136:139], v[144:147], v[96:99]
  ds_read_b128 v[168:171], v13 offset:36864
  v_mfma_f32_16x16x32_bf16 v[108:111], v[136:139], v[156:159], v[108:111]
  ds_read_b64_tr_b16 v[188:189], v17 offset:40960
  v_mfma_f32_16x16x32_bf16 v[92:95], v[132:135], v[156:159], v[92:95]
  buffer_load_dwordx4 v10, s[8:11], s58 offen offset:2048 lds
  ds_read_b64_tr_b16 v[190:191], v17 offset:41984
  s_lshl_b32 s53, s51, 10
  v_mfma_f32_16x16x32_bf16 v[76:79], v[128:131], v[156:159], v[76:79]
  ds_read_b128 v[172:175], v13 offset:38912
  v_mfma_f32_16x16x32_bf16 v[124:127], v[140:143], v[156:159], v[124:127]
  v_mfma_f32_16x16x32_bf16 v[120:123], v[140:143], v[152:155], v[120:123]
  buffer_load_dwordx4 v11, s[8:11], s58 offen offset:3072 lds
  v_mfma_f32_16x16x32_bf16 v[116:119], v[140:143], v[148:151], v[116:119]
  v_mfma_f32_16x16x32_bf16 v[112:115], v[140:143], v[144:147], v[112:115]
  s_waitcnt lgkmcnt(0)
  v_mfma_f32_16x16x32_bf16 v[64:67], v[160:163], v[176:179], v[64:67]
  s_waitcnt vmcnt(10)
  s_barrier
  ds_read_b128 v[128:131], v12 offset:49152
  v_mfma_f32_16x16x32_bf16 v[68:71], v[160:163], v[180:183], v[68:71]
  ds_read_b64_tr_b16 v[144:145], v14 offset:49152
  s_add_u32 s52, s52, s53
  s_add_u32 s56, s56, 1
  s_cmp_eq_u32 s56, 10
  s_cselect_b32 s56, 0, s56
  s_add_u32 m0, s59, 16384
  s_lshl_b32 s57, s56, 7
  v_mfma_f32_16x16x32_bf16 v[84:87], v[164:167], v[180:183], v[84:87]
  buffer_load_dwordx4 v4, s[4:7], s57 offen offset:0 lds
  ds_read_b64_tr_b16 v[146:147], v14 offset:50176
  v_mfma_f32_16x16x32_bf16 v[80:83], v[164:167], v[176:179], v[80:83]
  ds_read_b64_tr_b16 v[148:149], v15 offset:49152
  v_mfma_f32_16x16x32_bf16 v[88:91], v[164:167], v[184:187], v[88:91]
  buffer_store_dwordx4 v[236:239], v248, s[16:19], s80 offen sc1
  ds_read_b64_tr_b16 v[150:151], v15 offset:50176
  v_mfma_f32_16x16x32_bf16 v[72:75], v[160:163], v[184:187], v[72:75]
  ds_read_b128 v[132:135], v12 offset:51200
  s_add_u32 s52, s52, 5222400
  v_mfma_f32_16x16x32_bf16 v[104:107], v[168:171], v[184:187], v[104:107]
  ds_read_b64_tr_b16 v[152:153], v16 offset:49152
  v_mfma_f32_16x16x32_bf16 v[100:103], v[168:171], v[180:183], v[100:103]
  buffer_load_dwordx4 v5, s[4:7], s57 offen offset:1024 lds
  ds_read_b64_tr_b16 v[154:155], v16 offset:50176
  v_mfma_f32_16x16x32_bf16 v[96:99], v[168:171], v[176:179], v[96:99]
  ds_read_b128 v[136:139], v12 offset:53248
  v_mfma_f32_16x16x32_bf16 v[108:111], v[168:171], v[188:191], v[108:111]
  ds_read_b64_tr_b16 v[156:157], v17 offset:49152
  v_mfma_f32_16x16x32_bf16 v[92:95], v[164:167], v[188:191], v[92:95]
  buffer_load_dwordx4 v6, s[4:7], s57 offen offset:2048 lds
  ds_read_b64_tr_b16 v[158:159], v17 offset:50176
  s_add_u32 s53, s52, 40960
  v_mfma_f32_16x16x32_bf16 v[76:79], v[160:163], v[188:191], v[76:79]
  ds_read_b128 v[140:143], v12 offset:55296
  v_mfma_f32_16x16x32_bf16 v[124:127], v[172:175], v[188:191], v[124:127]
  v_mfma_f32_16x16x32_bf16 v[120:123], v[172:175], v[184:187], v[120:123]
  buffer_load_dwordx4 v7, s[4:7], s57 offen offset:3072 lds
  v_mfma_f32_16x16x32_bf16 v[116:119], v[172:175], v[180:183], v[116:119]
  v_mfma_f32_16x16x32_bf16 v[112:115], v[172:175], v[176:179], v[112:115]
  s_waitcnt lgkmcnt(6)
  v_mfma_f32_16x16x32_bf16 v[64:67], v[128:131], v[144:147], v[64:67]
  ds_read_b128 v[160:163], v13 offset:49152
  v_mfma_f32_16x16x32_bf16 v[68:71], v[128:131], v[148:151], v[68:71]
  ds_read_b64_tr_b16 v[176:177], v14 offset:57344
  s_add_u32 m0, s59, 81920
  s_mul_i32 s58, s56, 245760
  v_mfma_f32_16x16x32_bf16 v[84:87], v[132:135], v[148:151], v[84:87]
  buffer_load_dwordx4 v8, s[8:11], s58 offen offset:0 lds
  ds_read_b64_tr_b16 v[178:179], v14 offset:58368
  v_mfma_f32_16x16x32_bf16 v[80:83], v[132:135], v[144:147], v[80:83]
  ds_read_b64_tr_b16 v[180:181], v15 offset:57344
  s_waitcnt lgkmcnt(4)
  v_mfma_f32_16x16x32_bf16 v[88:91], v[132:135], v[152:155], v[88:91]
  buffer_load_dword v60, v59, s[12:15], s94 offen sc1
  ds_read_b64_tr_b16 v[182:183], v15 offset:58368
  v_mfma_f32_16x16x32_bf16 v[72:75], v[128:131], v[152:155], v[72:75]
  ds_read_b128 v[164:167], v13 offset:51200
  v_mfma_f32_16x16x32_bf16 v[104:107], v[136:139], v[152:155], v[104:107]
  ds_read_b64_tr_b16 v[184:185], v16 offset:57344
  v_mfma_f32_16x16x32_bf16 v[100:103], v[136:139], v[148:151], v[100:103]
  buffer_load_dwordx4 v9, s[8:11], s58 offen offset:1024 lds
  ds_read_b64_tr_b16 v[186:187], v16 offset:58368
  v_mfma_f32_16x16x32_bf16 v[96:99], v[136:139], v[144:147], v[96:99]
  ds_read_b128 v[168:171], v13 offset:53248
  v_mfma_f32_16x16x32_bf16 v[108:111], v[136:139], v[156:159], v[108:111]
  ds_read_b64_tr_b16 v[188:189], v17 offset:57344
  v_mfma_f32_16x16x32_bf16 v[92:95], v[132:135], v[156:159], v[92:95]
  buffer_load_dwordx4 v10, s[8:11], s58 offen offset:2048 lds
  ds_read_b64_tr_b16 v[190:191], v17 offset:58368
  v_mfma_f32_16x16x32_bf16 v[76:79], v[128:131], v[156:159], v[76:79]
  ds_read_b128 v[172:175], v13 offset:55296
  v_mfma_f32_16x16x32_bf16 v[124:127], v[140:143], v[156:159], v[124:127]
  v_mfma_f32_16x16x32_bf16 v[120:123], v[140:143], v[152:155], v[120:123]
  buffer_load_dwordx4 v11, s[8:11], s58 offen offset:3072 lds
  v_mfma_f32_16x16x32_bf16 v[116:119], v[140:143], v[148:151], v[116:119]
  v_mfma_f32_16x16x32_bf16 v[112:115], v[140:143], v[144:147], v[112:115]
  s_waitcnt lgkmcnt(0)
  v_mfma_f32_16x16x32_bf16 v[64:67], v[160:163], v[176:179], v[64:67]
  s_waitcnt vmcnt(10)
  s_barrier
  ds_read_b128 v[128:131], v12 offset:0
  v_mfma_f32_16x16x32_bf16 v[68:71], v[160:163], v[180:183], v[68:71]
  ds_read_b64_tr_b16 v[144:145], v14 offset:0
  v_mfma_f32_16x16x32_bf16 v[84:87], v[164:167], v[180:183], v[84:87]
  buffer_load_dwordx4 v[192:195], v46, s[12:15], 0 offen offset:0 sc1
  ds_read_b64_tr_b16 v[146:147], v14 offset:1024
  v_mfma_f32_16x16x32_bf16 v[80:83], v[164:167], v[176:179], v[80:83]
  ds_read_b64_tr_b16 v[148:149], v15 offset:0
  v_mfma_f32_16x16x32_bf16 v[88:91], v[164:167], v[184:187], v[88:91]
  buffer_load_dwordx4 v[196:199], v46, s[12:15], 0 offen offset:512 sc1
  ds_read_b64_tr_b16 v[150:151], v15 offset:1024
  v_mfma_f32_16x16x32_bf16 v[72:75], v[160:163], v[184:187], v[72:75]
  ds_read_b128 v[132:135], v12 offset:2048
  v_mfma_f32_16x16x32_bf16 v[104:107], v[168:171], v[184:187], v[104:107]
  ds_read_b64_tr_b16 v[152:153], v16 offset:0
  v_mfma_f32_16x16x32_bf16 v[100:103], v[168:171], v[180:183], v[100:103]
  buffer_load_dwordx4 v[200:203], v46, s[12:15], 0 offen offset:1024 sc1
  ds_read_b64_tr_b16 v[154:155], v16 offset:1024
  v_mfma_f32_16x16x32_bf16 v[96:99], v[168:171], v[176:179], v[96:99]
  ds_read_b128 v[136:139], v12 offset:4096
  v_mfma_f32_16x16x32_bf16 v[108:111], v[168:171], v[188:191], v[108:111]
  ds_read_b64_tr_b16 v[156:157], v17 offset:0
  v_mfma_f32_16x16x32_bf16 v[92:95], v[164:167], v[188:191], v[92:95]
  buffer_load_dwordx4 v[204:207], v46, s[12:15], 0 offen offset:1536 sc1
  ds_read_b64_tr_b16 v[158:159], v17 offset:1024
  v_mfma_f32_16x16x32_bf16 v[76:79], v[160:163], v[188:191], v[76:79]
  ds_read_b128 v[140:143], v12 offset:6144
  v_mfma_f32_16x16x32_bf16 v[124:127], v[172:175], v[188:191], v[124:127]
  v_mfma_f32_16x16x32_bf16 v[120:123], v[172:175], v[184:187], v[120:123]
  buffer_load_dwordx4 v[208:211], v46, s[12:15], 0 offen offset:2048 sc1
  v_mfma_f32_16x16x32_bf16 v[116:119], v[172:175], v[180:183], v[116:119]
  v_mfma_f32_16x16x32_bf16 v[112:115], v[172:175], v[176:179], v[112:115]
  s_waitcnt lgkmcnt(6)
  v_mfma_f32_16x16x32_bf16 v[64:67], v[128:131], v[144:147], v[64:67]
  ds_read_b128 v[160:163], v13 offset:0
  v_mfma_f32_16x16x32_bf16 v[68:71], v[128:131], v[148:151], v[68:71]
  ds_read_b64_tr_b16 v[176:177], v14 offset:8192
  s_waitcnt vmcnt(8)
  v_cmp_ne_u32 vcc, s37, v60
  s_nop 3
  s_cbranch_vccnz Lfs_13
Lfb_14:
  v_mfma_f32_16x16x32_bf16 v[84:87], v[132:135], v[148:151], v[84:87]
  buffer_load_dwordx2 v[212:213], v47, s[12:15], 0 offen offset:0 sc1
  ds_read_b64_tr_b16 v[178:179], v14 offset:9216
  v_mfma_f32_16x16x32_bf16 v[80:83], v[132:135], v[144:147], v[80:83]
  ds_read_b64_tr_b16 v[180:181], v15 offset:8192
  s_waitcnt lgkmcnt(4)
  v_mfma_f32_16x16x32_bf16 v[88:91], v[132:135], v[152:155], v[88:91]
  buffer_load_dwordx2 v[214:215], v47, s[12:15], 0 offen offset:256 sc1
  ds_read_b64_tr_b16 v[182:183], v15 offset:9216
  v_mfma_f32_16x16x32_bf16 v[72:75], v[128:131], v[152:155], v[72:75]
  ds_read_b128 v[164:167], v13 offset:2048
  v_mfma_f32_16x16x32_bf16 v[104:107], v[136:139], v[152:155], v[104:107]
  ds_read_b64_tr_b16 v[184:185], v16 offset:8192
  v_mfma_f32_16x16x32_bf16 v[100:103], v[136:139], v[148:151], v[100:103]
  buffer_load_dwordx2 v[216:217], v47, s[12:15], 0 offen offset:512 sc1
  ds_read_b64_tr_b16 v[186:187], v16 offset:9216
  v_mfma_f32_16x16x32_bf16 v[96:99], v[136:139], v[144:147], v[96:99]
  ds_read_b128 v[168:171], v13 offset:4096
  v_mfma_f32_16x16x32_bf16 v[108:111], v[136:139], v[156:159], v[108:111]
  ds_read_b64_tr_b16 v[188:189], v17 offset:8192
  v_mfma_f32_16x16x32_bf16 v[92:95], v[132:135], v[156:159], v[92:95]
  buffer_load_dwordx2 v[218:219], v47, s[12:15], 0 offen offset:768 sc1
  ds_read_b64_tr_b16 v[190:191], v17 offset:9216
  v_mfma_f32_16x16x32_bf16 v[76:79], v[128:131], v[156:159], v[76:79]
  ds_read_b128 v[172:175], v13 offset:6144
  v_mfma_f32_16x16x32_bf16 v[124:127], v[140:143], v[156:159], v[124:127]
  v_mfma_f32_16x16x32_bf16 v[120:123], v[140:143], v[152:155], v[120:123]
  buffer_load_dwordx2 v[220:221], v47, s[12:15], 0 offen offset:1024 sc1
  v_mfma_f32_16x16x32_bf16 v[116:119], v[140:143], v[148:151], v[116:119]
  v_mfma_f32_16x16x32_bf16 v[112:115], v[140:143], v[144:147], v[112:115]
  s_waitcnt lgkmcnt(0)
  v_mfma_f32_16x16x32_bf16 v[64:67], v[160:163], v[176:179], v[64:67]
  s_waitcnt vmcnt(10)
  s_barrier
  ds_read_b128 v[128:131], v12 offset:16384
  v_mfma_f32_16x16x32_bf16 v[68:71], v[160:163], v[180:183], v[68:71]
  ds_read_b64_tr_b16 v[144:145], v14 offset:16384
  v_add_u32 v250, s90, v2
  v_mfma_f32_16x16x32_bf16 v[84:87], v[164:167], v[180:183], v[84:87]
  global_load_dwordx4 a[156:159], v250, s[12:13] offset:-4096 sc1
  ds_read_b64_tr_b16 v[146:147], v14 offset:17408
  v_mfma_f32_16x16x32_bf16 v[80:83], v[164:167], v[176:179], v[80:83]
  ds_read_b64_tr_b16 v[148:149], v15 offset:16384
  v_mfma_f32_16x16x32_bf16 v[88:91], v[164:167], v[184:187], v[88:91]
  global_load_dwordx4 a[160:163], v250, s[12:13] offset:-3072 sc1
  ds_read_b64_tr_b16 v[150:151], v15 offset:17408
  v_mfma_f32_16x16x32_bf16 v[72:75], v[160:163], v[184:187], v[72:75]
  ds_read_b128 v[132:135], v12 offset:18432
  v_mfma_f32_16x16x32_bf16 v[104:107], v[168:171], v[184:187], v[104:107]
  global_load_dwordx4 a[164:167], v250, s[12:13] offset:-2048 sc1
  ds_read_b64_tr_b16 v[152:153], v16 offset:16384
  v_mfma_f32_16x16x32_bf16 v[100:103], v[168:171], v[180:183], v[100:103]
  ds_read_b64_tr_b16 v[154:155], v16 offset:17408
  v_mfma_f32_16x16x32_bf16 v[96:99], v[168:171], v[176:179], v[96:99]
  global_load_dwordx4 a[168:171], v250, s[12:13] offset:-1024 sc1
  ds_read_b128 v[136:139], v12 offset:20480
  v_mfma_f32_16x16x32_bf16 v[108:111], v[168:171], v[188:191], v[108:111]
  ds_read_b64_tr_b16 v[156:157], v17 offset:16384
  v_mfma_f32_16x16x32_bf16 v[92:95], v[164:167], v[188:191], v[92:95]
  global_load_dwordx4 a[172:175], v250, s[12:13] offset:0 sc1
  ds_read_b64_tr_b16 v[158:159], v17 offset:17408
  v_mfma_f32_16x16x32_bf16 v[76:79], v[160:163], v[188:191], v[76:79]
  ds_read_b128 v[140:143], v12 offset:22528
  v_mfma_f32_16x16x32_bf16 v[124:127], v[172:175], v[188:191], v[124:127]
  global_load_dwordx4 a[176:179], v250, s[12:13] offset:1024 sc1
  v_mfma_f32_16x16x32_bf16 v[120:123], v[172:175], v[184:187], v[120:123]
  v_mfma_f32_16x16x32_bf16 v[116:119], v[172:175], v[180:183], v[116:119]
  global_load_dwordx4 a[180:183], v250, s[12:13] offset:2048 sc1
  v_mfma_f32_16x16x32_bf16 v[112:115], v[172:175], v[176:179], v[112:115]
  s_waitcnt lgkmcnt(6)
  v_mfma_f32_16x16x32_bf16 v[64:67], v[128:131], v[144:147], v[64:67]
  ds_read_b128 v[160:163], v13 offset:16384
  v_mfma_f32_16x16x32_bf16 v[68:71], v[128:131], v[148:151], v[68:71]
  ds_read_b64_tr_b16 v[176:177], v14 offset:24576
  s_waitcnt vmcnt(7)
  v_xor_b32 v51, s37, v221
  v_bitop3_b32 v51, v193, s37, v51 bitop3:0xbe
  v_bitop3_b32 v51, v195, s37, v51 bitop3:0xbe
  v_mfma_f32_16x16x32_bf16 v[84:87], v[132:135], v[148:151], v[84:87]
  global_load_dwordx4 a[184:187], v250, s[12:13] offset:3072 sc1
  ds_read_b64_tr_b16 v[178:179], v14 offset:25600
  v_bitop3_b32 v51, v197, s37, v51 bitop3:0xbe
  v_bitop3_b32 v51, v199, s37, v51 bitop3:0xbe
  v_mfma_f32_16x16x32_bf16 v[80:83], v[132:135], v[144:147], v[80:83]
  ds_read_b64_tr_b16 v[180:181], v15 offset:24576
  v_bitop3_b32 v51, v201, s37, v51 bitop3:0xbe
  v_bitop3_b32 v51, v203, s37, v51 bitop3:0xbe
  v_add_u32 v250, 8192, v250
  s_waitcnt lgkmcnt(4)
  v_mfma_f32_16x16x32_bf16 v[88:91], v[132:135], v[152:155], v[88:91]
  global_load_dwordx4 a[188:191], v250, s[12:13] offset:-4096 sc1
  ds_read_b64_tr_b16 v[182:183], v15 offset:25600
  v_bitop3_b32 v51, v205, s37, v51 bitop3:0xbe
  v_bitop3_b32 v51, v207, s37, v51 bitop3:0xbe
  v_mfma_f32_16x16x32_bf16 v[72:75], v[128:131], v[152:155], v[72:75]
  ds_read_b128 v[164:167], v13 offset:18432
  v_bitop3_b32 v51, v209, s37, v51 bitop3:0xbe
  v_bitop3_b32 v51, v211, s37, v51 bitop3:0xbe
  v_bitop3_b32 v51, v213, s37, v51 bitop3:0xbe
  v_mfma_f32_16x16x32_bf16 v[104:107], v[136:139], v[152:155], v[104:107]
  global_load_dwordx4 a[192:195], v250, s[12:13] offset:-3072 sc1
  ds_read_b64_tr_b16 v[184:185], v16 offset:24576
  v_bitop3_b32 v51, v215, s37, v51 bitop3:0xbe
  v_bitop3_b32 v51, v217, s37, v51 bitop3:0xbe
  v_mfma_f32_16x16x32_bf16 v[100:103], v[136:139], v[148:151], v[100:103]
  ds_read_b64_tr_b16 v[186:187], v16 offset:25600
  v_bitop3_b32 v51, v219, s37, v51 bitop3:0xbe
  v_cmp_ne_u32 vcc, 0, v51
  v_mfma_f32_16x16x32_bf16 v[96:99], v[136:139], v[144:147], v[96:99]
  global_load_dwordx4 a[196:199], v250, s[12:13] offset:-2048 sc1
  ds_read_b128 v[168:171], v13 offset:20480
  s_nop 3
  s_cbranch_vccnz Lss_17
Lsb_18:
  v_add_f32 v4, v192, v196
  v_mfma_f32_16x16x32_bf16 v[108:111], v[136:139], v[156:159], v[108:111]
  ds_read_b64_tr_b16 v[188:189], v17 offset:24576
  v_add_f32 v5, v194, v198
  v_add_f32 v8, v212, v214
  v_mfma_f32_16x16x32_bf16 v[92:95], v[132:135], v[156:159], v[92:95]
  global_load_dwordx4 a[200:203], v250, s[12:13] offset:-1024 sc1
  ds_read_b64_tr_b16 v[190:191], v17 offset:25600
  v_add_f32 v4, v4, v200
  v_add_f32 v5, v5, v202
  v_add_f32 v8, v8, v216
  v_mfma_f32_16x16x32_bf16 v[76:79], v[128:131], v[156:159], v[76:79]
  ds_read_b128 v[172:175], v13 offset:22528
  v_add_f32 v4, v4, v204
  v_add_f32 v5, v5, v206
  v_mfma_f32_16x16x32_bf16 v[124:127], v[140:143], v[156:159], v[124:127]
  global_load_dwordx4 a[204:207], v250, s[12:13] offset:0 sc1
  v_add_f32 v8, v8, v218
  v_add_f32 v4, v4, v208
  v_mfma_f32_16x16x32_bf16 v[120:123], v[140:143], v[152:155], v[120:123]
  v_add_f32 v5, v5, v210
  v_add_f32 v8, v8, v220
  v_mfma_f32_16x16x32_bf16 v[116:119], v[140:143], v[148:151], v[116:119]
  global_load_dwordx4 a[208:211], v250, s[12:13] offset:1024 sc1
  v_mov_b32 v6, v4
  v_mov_b32 v7, v5
  v_mfma_f32_16x16x32_bf16 v[112:115], v[140:143], v[144:147], v[112:115]
  s_waitcnt lgkmcnt(0)
  v_mfma_f32_16x16x32_bf16 v[64:67], v[160:163], v[176:179], v[64:67]
  v_mov_b32 v9, v8
  v_permlane32_swap_b32 v4, v6
  v_permlane32_swap_b32 v5, v7
  v_mfma_f32_16x16x32_bf16 v[68:71], v[160:163], v[180:183], v[68:71]
  v_permlane32_swap_b32 v8, v9
  v_add_f32 v4, v4, v6
  v_add_f32 v5, v5, v7
  v_mfma_f32_16x16x32_bf16 v[84:87], v[164:167], v[180:183], v[84:87]
  global_load_dwordx4 a[212:215], v250, s[12:13] offset:2048 sc1
  v_mul_f32 v4, 0xbacccccd, v4
  v_mul_f32 v5, 0x3acccccd, v5
  v_add_f32 v8, v8, v9
  v_mfma_f32_16x16x32_bf16 v[80:83], v[164:167], v[176:179], v[80:83]
  v_fma_f32 v5, -v4, v4, v5
  ds_write_b32 v50, v4
  v_max_f32 v5, 0, v5
  v_mfma_f32_16x16x32_bf16 v[88:91], v[164:167], v[184:187], v[88:91]
  global_load_dwordx4 a[216:219], v250, s[12:13] offset:3072 sc1
  v_add_f32 v5, 0x3727c5ac, v5
  v_rsq_f32 v5, v5
  ds_write_b32 v50, v8 offset:1024
  v_mfma_f32_16x16x32_bf16 v[72:75], v[160:163], v[184:187], v[72:75]
  ds_write_b32 v50, v5 offset:512
  v_add_u32 v250, 8192, v250
  v_mfma_f32_16x16x32_bf16 v[104:107], v[168:171], v[184:187], v[104:107]
  global_load_dwordx4 a[220:223], v250, s[12:13] offset:-4096 sc1
  v_mfma_f32_16x16x32_bf16 v[100:103], v[168:171], v[180:183], v[100:103]
  s_waitcnt lgkmcnt(0)
  s_barrier
  v_mfma_f32_16x16x32_bf16 v[96:99], v[168:171], v[176:179], v[96:99]
  global_load_dwordx4 a[224:227], v250, s[12:13] offset:-3072 sc1
  ds_read2_b32 v[36:37], v28 offset0:0 offset1:16
  ds_read2_b32 v[38:39], v28 offset0:32 offset1:48
  v_mfma_f32_16x16x32_bf16 v[108:111], v[168:171], v[188:191], v[108:111]
  ds_read_b128 v[208:211], v29 offset:0
  v_mfma_f32_16x16x32_bf16 v[92:95], v[164:167], v[188:191], v[92:95]
  global_load_dwordx4 a[228:231], v250, s[12:13] offset:-2048 sc1
  ds_read_b128 v[224:227], v29 offset:512
  ds_read_b128 v[212:215], v29 offset:32
  v_mfma_f32_16x16x32_bf16 v[76:79], v[160:163], v[188:191], v[76:79]
  ds_read_b128 v[228:231], v29 offset:544
  v_mfma_f32_16x16x32_bf16 v[124:127], v[172:175], v[188:191], v[124:127]
  global_load_dwordx4 a[232:235], v250, s[12:13] offset:-1024 sc1
  ds_read_b128 v[216:219], v29 offset:128
  ds_read_b128 v[232:235], v29 offset:640
  v_mfma_f32_16x16x32_bf16 v[120:123], v[172:175], v[184:187], v[120:123]
  ds_read_b128 v[220:223], v29 offset:160
  v_mfma_f32_16x16x32_bf16 v[116:119], v[172:175], v[180:183], v[116:119]
  global_load_dwordx4 a[236:239], v250, s[12:13] offset:0 sc1
  ds_read_b128 v[236:239], v29 offset:672
  v_mfma_f32_16x16x32_bf16 v[112:115], v[172:175], v[176:179], v[112:115]
  s_waitcnt lgkmcnt(7)
  v_pk_fma_f32 v[64:65], v[208:209], v[36:37], v[64:65] op_sel_hi:[1,0,1]
  v_pk_fma_f32 v[66:67], v[210:211], v[36:37], v[66:67] op_sel_hi:[1,0,1]
  s_waitcnt lgkmcnt(5)
  v_pk_fma_f32 v[80:81], v[212:213], v[36:37], v[80:81] op_sel_hi:[1,0,1]
  v_pk_fma_f32 v[82:83], v[214:215], v[36:37], v[82:83] op_sel_hi:[1,0,1]
  v_pk_mul_f32 v[64:65], v[64:65], v[224:225]
  v_pk_mul_f32 v[66:67], v[66:67], v[226:227]
  s_waitcnt lgkmcnt(4)
  v_pk_mul_f32 v[80:81], v[80:81], v[228:229]
  v_pk_mul_f32 v[82:83], v[82:83], v[230:231]
  v_cvt_pk_bf16_f32 v128, v64, v65
  v_cvt_pk_bf16_f32 v129, v66, v67
  v_cvt_pk_bf16_f32 v130, v80, v81
  v_cvt_pk_bf16_f32 v131, v82, v83
  buffer_store_dwordx4 v[128:131], v32, s[12:15], s52 offen offset:0 sc1
  v_pk_fma_f32 v[68:69], v[208:209], v[36:37], v[68:69] op_sel:[0,1,0] op_sel_hi:[1,1,1]
  v_pk_fma_f32 v[70:71], v[210:211], v[36:37], v[70:71] op_sel:[0,1,0] op_sel_hi:[1,1,1]
  v_pk_fma_f32 v[84:85], v[212:213], v[36:37], v[84:85] op_sel:[0,1,0] op_sel_hi:[1,1,1]
  v_pk_fma_f32 v[86:87], v[214:215], v[36:37], v[86:87] op_sel:[0,1,0] op_sel_hi:[1,1,1]
  v_pk_mul_f32 v[68:69], v[68:69], v[224:225]
  v_pk_mul_f32 v[70:71], v[70:71], v[226:227]
  v_pk_mul_f32 v[84:85], v[84:85], v[228:229]
  v_pk_mul_f32 v[86:87], v[86:87], v[230:231]
  v_cvt_pk_bf16_f32 v132, v68, v69
  v_cvt_pk_bf16_f32 v133, v70, v71
  v_cvt_pk_bf16_f32 v134, v84, v85
  v_cvt_pk_bf16_f32 v135, v86, v87
  buffer_store_dwordx4 v[132:135], v32, s[12:15], s52 offen offset:256 sc1
  v_pk_fma_f32 v[72:73], v[208:209], v[38:39], v[72:73] op_sel_hi:[1,0,1]
  v_pk_fma_f32 v[74:75], v[210:211], v[38:39], v[74:75] op_sel_hi:[1,0,1]
  v_pk_fma_f32 v[88:89], v[212:213], v[38:39], v[88:89] op_sel_hi:[1,0,1]
  v_pk_fma_f32 v[90:91], v[214:215], v[38:39], v[90:91] op_sel_hi:[1,0,1]
  v_pk_mul_f32 v[72:73], v[72:73], v[224:225]
  v_pk_mul_f32 v[74:75], v[74:75], v[226:227]
  v_pk_mul_f32 v[88:89], v[88:89], v[228:229]
  v_pk_mul_f32 v[90:91], v[90:91], v[230:231]
  v_cvt_pk_bf16_f32 v136, v72, v73
  v_cvt_pk_bf16_f32 v137, v74, v75
  v_cvt_pk_bf16_f32 v138, v88, v89
  v_cvt_pk_bf16_f32 v139, v90, v91
  buffer_store_dwordx4 v[136:139], v32, s[12:15], s52 offen offset:512 sc1
  v_pk_fma_f32 v[76:77], v[208:209], v[38:39], v[76:77] op_sel:[0,1,0] op_sel_hi:[1,1,1]
  v_pk_fma_f32 v[78:79], v[210:211], v[38:39], v[78:79] op_sel:[0,1,0] op_sel_hi:[1,1,1]
  v_pk_fma_f32 v[92:93], v[212:213], v[38:39], v[92:93] op_sel:[0,1,0] op_sel_hi:[1,1,1]
  v_pk_fma_f32 v[94:95], v[214:215], v[38:39], v[94:95] op_sel:[0,1,0] op_sel_hi:[1,1,1]
  v_pk_mul_f32 v[76:77], v[76:77], v[224:225]
  v_pk_mul_f32 v[78:79], v[78:79], v[226:227]
  v_pk_mul_f32 v[92:93], v[92:93], v[228:229]
  v_pk_mul_f32 v[94:95], v[94:95], v[230:231]
  v_cvt_pk_bf16_f32 v140, v76, v77
  v_cvt_pk_bf16_f32 v141, v78, v79
  v_cvt_pk_bf16_f32 v142, v92, v93
  v_cvt_pk_bf16_f32 v143, v94, v95
  buffer_store_dwordx4 v[140:143], v32, s[12:15], s52 offen offset:768 sc1
  s_waitcnt lgkmcnt(3)
  v_pk_fma_f32 v[96:97], v[216:217], v[36:37], v[96:97] op_sel_hi:[1,0,1]
  v_pk_fma_f32 v[98:99], v[218:219], v[36:37], v[98:99] op_sel_hi:[1,0,1]
  s_waitcnt lgkmcnt(1)
  v_pk_fma_f32 v[112:113], v[220:221], v[36:37], v[112:113] op_sel_hi:[1,0,1]
  v_pk_fma_f32 v[114:115], v[222:223], v[36:37], v[114:115] op_sel_hi:[1,0,1]
  v_pk_mul_f32 v[96:97], v[96:97], v[232:233]
  v_pk_mul_f32 v[98:99], v[98:99], v[234:235]
  s_waitcnt lgkmcnt(0)
  v_pk_mul_f32 v[112:113], v[112:113], v[236:237]
  v_pk_mul_f32 v[114:115], v[114:115], v[238:239]
  v_cvt_pk_bf16_f32 v144, v96, v97
  v_cvt_pk_bf16_f32 v145, v98, v99
  v_cvt_pk_bf16_f32 v146, v112, v113
  v_cvt_pk_bf16_f32 v147, v114, v115
  buffer_store_dwordx4 v[144:147], v32, s[12:15], s53 offen offset:0 sc1
  v_pk_fma_f32 v[100:101], v[216:217], v[36:37], v[100:101] op_sel:[0,1,0] op_sel_hi:[1,1,1]
  v_pk_fma_f32 v[102:103], v[218:219], v[36:37], v[102:103] op_sel:[0,1,0] op_sel_hi:[1,1,1]
  v_pk_fma_f32 v[116:117], v[220:221], v[36:37], v[116:117] op_sel:[0,1,0] op_sel_hi:[1,1,1]
  v_pk_fma_f32 v[118:119], v[222:223], v[36:37], v[118:119] op_sel:[0,1,0] op_sel_hi:[1,1,1]
  v_pk_mul_f32 v[100:101], v[100:101], v[232:233]
  v_pk_mul_f32 v[102:103], v[102:103], v[234:235]
  v_pk_mul_f32 v[116:117], v[116:117], v[236:237]
  v_pk_mul_f32 v[118:119], v[118:119], v[238:239]
  v_cvt_pk_bf16_f32 v148, v100, v101
  v_cvt_pk_bf16_f32 v149, v102, v103
  v_cvt_pk_bf16_f32 v150, v116, v117
  v_cvt_pk_bf16_f32 v151, v118, v119
  buffer_store_dwordx4 v[148:151], v32, s[12:15], s53 offen offset:256 sc1
  v_pk_fma_f32 v[104:105], v[216:217], v[38:39], v[104:105] op_sel_hi:[1,0,1]
  v_pk_fma_f32 v[106:107], v[218:219], v[38:39], v[106:107] op_sel_hi:[1,0,1]
  v_pk_fma_f32 v[120:121], v[220:221], v[38:39], v[120:121] op_sel_hi:[1,0,1]
  v_pk_fma_f32 v[122:123], v[222:223], v[38:39], v[122:123] op_sel_hi:[1,0,1]
  v_pk_mul_f32 v[104:105], v[104:105], v[232:233]
  v_pk_mul_f32 v[106:107], v[106:107], v[234:235]
  v_pk_mul_f32 v[120:121], v[120:121], v[236:237]
  v_pk_mul_f32 v[122:123], v[122:123], v[238:239]
  v_cvt_pk_bf16_f32 v152, v104, v105
  v_cvt_pk_bf16_f32 v153, v106, v107
  v_cvt_pk_bf16_f32 v154, v120, v121
  v_cvt_pk_bf16_f32 v155, v122, v123
  buffer_store_dwordx4 v[152:155], v32, s[12:15], s53 offen offset:512 sc1
  v_pk_fma_f32 v[108:109], v[216:217], v[38:39], v[108:109] op_sel:[0,1,0] op_sel_hi:[1,1,1]
  v_pk_fma_f32 v[110:111], v[218:219], v[38:39], v[110:111] op_sel:[0,1,0] op_sel_hi:[1,1,1]
  v_pk_fma_f32 v[124:125], v[220:221], v[38:39], v[124:125] op_sel:[0,1,0] op_sel_hi:[1,1,1]
  v_pk_fma_f32 v[126:127], v[222:223], v[38:39], v[126:127] op_sel:[0,1,0] op_sel_hi:[1,1,1]
  v_pk_mul_f32 v[108:109], v[108:109], v[232:233]
  v_pk_mul_f32 v[110:111], v[110:111], v[234:235]
  v_pk_mul_f32 v[124:125], v[124:125], v[236:237]
  v_pk_mul_f32 v[126:127], v[126:127], v[238:239]
  v_cvt_pk_bf16_f32 v156, v108, v109
  v_cvt_pk_bf16_f32 v157, v110, v111
  v_cvt_pk_bf16_f32 v158, v124, v125
  v_cvt_pk_bf16_f32 v159, v126, v127
  buffer_store_dwordx4 v[156:159], v32, s[12:15], s53 offen offset:768 sc1
  s_nop 1
Lp1_done:
  s_cmp_ge_u32 s40, 4
  s_cselect_b32 s81, 0x3f803f80, 0
  v_mov_b32 v63, s81
  v_accvgpr_write_b32 a0, v63
  v_accvgpr_write_b32 a1, v63
  v_accvgpr_write_b32 a2, v63
  v_accvgpr_write_b32 a3, v63
  v_accvgpr_write_b32 a4, v63
  v_accvgpr_write_b32 a5, v63
  v_accvgpr_write_b32 a6, v63
  v_accvgpr_write_b32 a7, v63
  v_accvgpr_write_b32 a8, v63
  v_accvgpr_write_b32 a9, v63
  v_accvgpr_write_b32 a10, v63
  v_accvgpr_write_b32 a11, v63
  v_accvgpr_write_b32 a12, v63
  v_accvgpr_write_b32 a13, v63
  v_accvgpr_write_b32 a14, v63
  v_accvgpr_write_b32 a15, v63
  s_cmp_ge_u32 s40, 3
  s_cselect_b32 s81, 0x3f803f80, 0
  v_mov_b32 v63, s81
  v_accvgpr_write_b32 a16, v63
  v_accvgpr_write_b32 a17, v63
  v_accvgpr_write_b32 a18, v63
  v_accvgpr_write_b32 a19, v63
  v_accvgpr_write_b32 a20, v63
  v_accvgpr_write_b32 a21, v63
  v_accvgpr_write_b32 a22, v63
  v_accvgpr_write_b32 a23, v63
  v_accvgpr_write_b32 a24, v63
  v_accvgpr_write_b32 a25, v63
  v_accvgpr_write_b32 a26, v63
  v_accvgpr_write_b32 a27, v63
  v_accvgpr_write_b32 a28, v63
  v_accvgpr_write_b32 a29, v63
  v_accvgpr_write_b32 a30, v63
  v_accvgpr_write_b32 a31, v63
  s_cmp_ge_u32 s40, 2
  s_cselect_b32 s81, 0x3f803f80, 0
  v_mov_b32 v63, s81
  v_accvgpr_write_b32 a32, v63
  v_accvgpr_write_b32 a33, v63
  v_accvgpr_write_b32 a34, v63
  v_accvgpr_write_b32 a35, v63
  v_accvgpr_write_b32 a36, v63
  v_accvgpr_write_b32 a37, v63
  v_accvgpr_write_b32 a38, v63
  v_accvgpr_write_b32 a39, v63
  v_accvgpr_write_b32 a40, v63
  v_accvgpr_write_b32 a41, v63
  v_accvgpr_write_b32 a42, v63
  v_accvgpr_write_b32 a43, v63
  v_accvgpr_write_b32 a44, v63
  v_accvgpr_write_b32 a45, v63
  v_accvgpr_write_b32 a46, v63
  v_accvgpr_write_b32 a47, v63
  s_cmp_ge_u32 s40, 1
  s_cselect_b32 s81, 0x3f803f80, 0
  v_mov_b32 v63, s81
  v_accvgpr_write_b32 a48, v63
  v_accvgpr_write_b32 a49, v63
  v_accvgpr_write_b32 a50, v63
  v_accvgpr_write_b32 a51, v63
  v_accvgpr_write_b32 a52, v63
  v_accvgpr_write_b32 a53, v63
  v_accvgpr_write_b32 a54, v63
  v_accvgpr_write_b32 a55, v63
  v_accvgpr_write_b32 a56, v63
  v_accvgpr_write_b32 a57, v63
  v_accvgpr_write_b32 a58, v63
  v_accvgpr_write_b32 a59, v63
  v_accvgpr_write_b32 a60, v63
  v_accvgpr_write_b32 a61, v63
  v_accvgpr_write_b32 a62, v63
  v_accvgpr_write_b32 a63, v63
  s_cmp_ge_u32 s40, 0
  s_cselect_b32 s81, 0x3f803f80, 0
  v_mov_b32 v63, s81
  v_accvgpr_write_b32 a64, v63
  v_accvgpr_write_b32 a65, v63
  v_accvgpr_write_b32 a66, v63
  v_accvgpr_write_b32 a67, v63
  v_accvgpr_write_b32 a68, v63
  v_accvgpr_write_b32 a69, v63
  v_accvgpr_write_b32 a70, v63
  v_accvgpr_write_b32 a71, v63
  v_accvgpr_write_b32 a72, v63
  v_accvgpr_write_b32 a73, v63
  v_accvgpr_write_b32 a74, v63
  v_accvgpr_write_b32 a75, v63
  v_accvgpr_write_b32 a76, v63
  v_accvgpr_write_b32 a77, v63
  v_accvgpr_write_b32 a78, v63
  v_accvgpr_write_b32 a79, v63
  s_nop 1
Lp1_join:
  s_mov_b32 s88, 0x000fffff
  s_mov_b32 s89, 0x000fffff
  s_mov_b32 s16, s12
  s_mov_b32 s17, s13
  s_mov_b32 s19, 0x20000
  v_and_b32 v3, 0x1f0, v2
  v_lshrrev_b32 v8, 1, v1
  v_xor_b32 v8, v8, v1
  v_and_b32 v8, 4, v8
  v_mul_u32_u24 v8, 48, v8
  v_xor_b32 v8, v8, v3
  v_lshrrev_b32 v9, 5, v1
  v_mul_u32_u24 v10, 10240, v9
  v_add_u32 v4, v8, v10
  v_and_b32 v8, 31, v1
  v_lshlrev_b32 v9, 2, v9
  v_sub_u32 v8, v8, v9
  v_mov_b32 v10, 0xff800000
  v_cmp_gt_i32 s[48:49], 0, v8
  v_cmp_gt_i32 s[50:51], 1, v8
  v_cmp_gt_i32 s[52:53], 2, v8
  v_cmp_gt_i32 s[54:55], 3, v8
  v_cndmask_b32 v194, 0, v10, s[48:49]
  v_cndmask_b32 v195, 0, v10, s[50:51]
  v_cndmask_b32 v196, 0, v10, s[52:53]
  v_cndmask_b32 v197, 0, v10, s[54:55]
  v_xor_b32 v178, v194, v10
  v_xor_b32 v179, v195, v10
  v_xor_b32 v180, v196, v10
  v_xor_b32 v181, v197, v10
  v_cmp_gt_i32 s[48:49], 8, v8
  v_cmp_gt_i32 s[50:51], 9, v8
  v_cmp_gt_i32 s[52:53], 10, v8
  v_cmp_gt_i32 s[54:55], 11, v8
  v_cndmask_b32 v198, 0, v10, s[48:49]
  v_cndmask_b32 v199, 0, v10, s[50:51]
  v_cndmask_b32 v200, 0, v10, s[52:53]
  v_cndmask_b32 v201, 0, v10, s[54:55]
  v_xor_b32 v182, v198, v10
  v_xor_b32 v183, v199, v10
  v_xor_b32 v184, v200, v10
  v_xor_b32 v185, v201, v10
  v_cmp_gt_i32 s[48:49], 16, v8
  v_cmp_gt_i32 s[50:51], 17, v8
  v_cmp_gt_i32 s[52:53], 18, v8
  v_cmp_gt_i32 s[54:55], 19, v8
  v_cndmask_b32 v202, 0, v10, s[48:49]
  v_cndmask_b32 v203, 0, v10, s[50:51]
  v_cndmask_b32 v204, 0, v10, s[52:53]
  v_cndmask_b32 v205, 0, v10, s[54:55]
  v_xor_b32 v186, v202, v10
  v_xor_b32 v187, v203, v10
  v_xor_b32 v188, v204, v10
  v_xor_b32 v189, v205, v10
  v_cmp_gt_i32 s[48:49], 24, v8
  v_cmp_gt_i32 s[50:51], 25, v8
  v_cmp_gt_i32 s[52:53], 26, v8
  v_cmp_gt_i32 s[54:55], 27, v8
  v_cndmask_b32 v206, 0, v10, s[48:49]
  v_cndmask_b32 v207, 0, v10, s[50:51]
  v_cndmask_b32 v208, 0, v10, s[52:53]
  v_cndmask_b32 v209, 0, v10, s[54:55]
  v_xor_b32 v190, v206, v10
  v_xor_b32 v191, v207, v10
  v_xor_b32 v192, v208, v10
  v_xor_b32 v193, v209, v10
  s_lshl_b32 s50, s40, 10
  s_add_u32 s50, s50, 131072
  v_and_b32 v8, 7, v1
  v_lshl_add_u32 v5, v8, 7, s50
  s_mul_i32 s48, s85, 896
  s_lshr_b32 s49, s41, 1
  s_lshl_b32 s49, s49, 13
  s_add_u32 s48, s48, s49
  s_add_u32 s48, s48, 163840
  v_min_u32 v8, 6, v8
  v_lshl_add_u32 v9, v8, 7, s48
  v_cndmask_b32 v5, v5, v9, s[44:45]
  s_mul_i32 s48, s36, 640
  s_lshl_b32 s49, s43, 12
  s_add_u32 s48, s48, s49
  s_add_u32 s48, s48, 65536
  v_cmp_lt_u32 vcc, 47, v1
  v_min_u32 v8, 4, v8
  v_lshl_add_u32 v8, v8, 7, s48
  v_cndmask_b32 v5, v5, v8, vcc
  s_mul_i32 s48, s41, 80
  s_add_u32 s49, s48, 79
  s_lshr_b32 s48, s48, 7
  s_lshr_b32 s49, s49, 7
  s_sub_u32 s49, s49, s48
  v_lshrrev_b32 v8, 2, v1
  v_min_u32 v8, 2, v8
  v_bfe_u32 v9, v1, 1, 1
  v_add_u32 v9, 1, v9
  v_cmp_lt_u32 vcc, 11, v1
  v_and_b32 v10, s49, v1
  s_nop 0
  v_cndmask_b32 v9, v9, 0, vcc
  v_mad_u32_u24 v9, v9, 5, v10
  v_add_u32 v9, s48, v9
  s_waitcnt vmcnt(0)
  s_barrier
  s_cmp_lg_u32 s36, 2
  s_cbranch_scc1 Lf1_25
  v_mov_b32 v254, s37
  v_lshlrev_b32 v253, 2, v1
  s_not_b64 exec, s[44:45]
  buffer_store_dword v254, v253, s[12:15], s61 offen sc1
  s_mov_b64 exec, -1
Lf1_25:
  s_cmp_lg_u32 s36, 0
  s_cbranch_scc1 Lf1_26
  v_mov_b32 v254, s37
  buffer_store_dword v254, v244, s[24:27], 0 offen sc1
Lf1_26:
  s_sub_u32 s48, s42, 2
  global_load_dwordx4 a[240:243], v250, s[12:13] offset:1024 sc1
  v_add_u32 v8, s48, v8
  v_max_i32 v8, 0, v8
  v_lshl_add_u32 v8, v8, 4, v9
  v_lshlrev_b32 v8, 7, v8
  v_add_u32 v7, 229376, v8
  v_add_u32 v8, 0, v1
  v_mul_u32_u24 v9, 6554, v8
  v_lshrrev_b32 v9, 16, v9
  v_mul_u32_u24 v9, 1120, v9
  v_add_u32 v226, v2, v9
  v_add_u32 v8, 64, v1
  v_mul_u32_u24 v9, 6554, v8
  v_lshrrev_b32 v9, 16, v9
  v_mul_u32_u24 v9, 1120, v9
  v_add_u32 v227, v2, v9
  v_add_u32 v8, 128, v1
  v_mul_u32_u24 v9, 6554, v8
  v_lshrrev_b32 v9, 16, v9
  v_mul_u32_u24 v9, 1120, v9
  v_add_u32 v228, v2, v9
  v_mov_b32 v8, 2147418112
  v_cndmask_b32 v228, v228, v8, s[44:45]
  v_add_u32 v9, 20480, v4
  global_load_dwordx4 a[244:247], v250, s[12:13] offset:2048 sc1
  v_add_u32 v10, 40960, v4
  v_add_u32 v11, 61440, v4
  v_and_b32 v12, 15, v1
  v_bfe_u32 v8, v1, 4, 1
  v_lshlrev_b32 v12, 4, v12
  v_lshl_add_u32 v12, v8, 9, v12
  v_lshrrev_b32 v8, 5, v1
  v_lshl_add_u32 v12, v8, 8, v12
  s_lshl_b32 s48, s40, 7
  s_add_u32 s48, s48, 4096
  v_and_b32 v14, 1, v1
  v_mul_u32_u24 v14, 12288, v14
  v_add_u32 v14, s48, v14
  s_lshl_b32 s79, s40, 5
  s_add_u32 s79, s79, s47
  s_mul_i32 s79, s79, 2560
  s_add_u32 s79, s79, 25985024
  v_mov_b32 v16, -1
  v_mov_b32 v17, -1
  v_mov_b32 v18, -1
  v_mov_b32 v19, -1
  v_lshlrev_b32 v20, 3, v1
  s_andn2_b32 s49, s40, 4
  global_load_dwordx4 a[248:251], v250, s[12:13] offset:3072 sc1
  s_lshl_b32 s49, s49, 10
  s_add_u32 s49, s49, 294912
  v_and_b32 v15, 8, v1
  v_mul_u32_u24 v15, 4, v15
  v_and_or_b32 v15, v1, 7, v15
  v_lshl_add_u32 v15, v15, 7, s49
  v_cndmask_b32 v14, v14, v15, s[44:45]
  s_lshr_b32 s48, s2, 3
  s_lshl2_add_u32 s48, s48, s36
  s_lshl_b32 s48, s48, 7
  s_add_u32 s48, s48, Lattn_done-Lpc1
  s_min_u32 s48, s48, Lmain_end-Lpc1
  v_mov_b32 v245, s48
  s_getpc_b64 s[30:31]
Lpc1:
  s_mul_i32 s53, s47, 2560
  s_add_u32 s54, s53, 81920
  s_mul_i32 s55, s47, 320
  s_add_u32 s55, s55, 5242880
  s_mul_i32 s52, s40, 163840
  s_add_u32 s53, s53, s52
  s_lshl2_add_u32 s51, s40, s93
  s_mul_i32 s51, s51, 20480
  v_add_u32 v250, 8192, v250
  global_load_dwordx4 a[252:255], v250, s[12:13] offset:-4096 sc1
  s_mul_i32 s50, s41, 160
  s_add_u32 s51, s51, s50
  s_sub_u32 s48, s40, 4
  s_cselect_b32 s66, 0, 29786112
  s_cselect_b32 s48, 0, s48
  s_mul_i32 s65, s48, 81920
  s_lshl1_add_u32 s64, s65, s54
  s_add_u32 s65, s65, s55
  s_sub_u32 s48, s40, 3
  s_cselect_b32 s69, 0, 29786112
  s_cselect_b32 s48, 0, s48
  s_mul_i32 s68, s48, 81920
  s_lshl1_add_u32 s67, s68, s54
  s_add_u32 s68, s68, s55
  s_sub_u32 s48, s40, 2
  s_cselect_b32 s72, 0, 29786112
  s_cselect_b32 s48, 0, s48
  s_mul_i32 s71, s48, 81920
  s_lshl1_add_u32 s70, s71, s54
  s_add_u32 s71, s71, s55
  s_sub_u32 s48, s40, 1
  s_cselect_b32 s75, 0, 29786112
  s_cselect_b32 s48, 0, s48
  s_mul_i32 s74, s48, 81920
  s_lshl1_add_u32 s73, s74, s54
  s_add_u32 s74, s74, s55
  s_sub_u32 s48, s40, 0
  s_cselect_b32 s78, 0, 29786112
  s_cselect_b32 s48, 0, s48
  s_mul_i32 s77, s48, 81920
  s_lshl1_add_u32 s76, s77, s54
  s_add_u32 s77, s77, s55
  v_mov_b32 v136, 0
  v_mov_b32 v137, 0
  v_mov_b32 v140, 0
  v_mov_b32 v141, 0
  v_mov_b32 v144, 0
  v_mov_b32 v145, 0
  s_cmp_lg_u32 s36, 2
  s_cbranch_scc1 Lw1_38
  s_mov_b32 s60, 200000
Lpl_39:
  buffer_load_dword v254, v7, s[12:15], s94 offen sc1
  s_sub_u32 s60, s60, 1
  s_cbranch_scc1 Lpd_40
  s_waitcnt vmcnt(0)
  v_cmp_ne_u32 vcc, s37, v254
  s_nop 3
  s_cbranch_vccnz Lpl_39
Lpd_40:
  s_waitcnt vmcnt(0)
Lw1_38:
  s_and_b32 s48, s40, 3
  s_cmp_eq_u32 s48, 1
  s_cbranch_scc1 Lav_42
  s_cmp_eq_u32 s48, 2
  s_cbranch_scc1 Lav_43
  s_cmp_eq_u32 s48, 3
  s_cbranch_scc1 Lav_44
Lav_41:
  s_mov_b32 s18, s75
  s_barrier
  buffer_load_dwordx4 v[124:127], v2, s[12:15], s53 offen sc1
  buffer_load_dwordx4 v[128:131], v2, s[12:15], s53 offen offset:1024 sc1
  buffer_load_dwordx4 v[100:103], v2, s[16:19], s73 offen sc1
  buffer_load_dwordx4 v[104:107], v2, s[16:19], s73 offen offset:1024 sc1
  buffer_load_dwordx4 v[132:135], v3, s[12:15], s53 offen offset:2048 sc1
  buffer_load_dwordx4 v[108:111], v3, s[16:19], s73 offen offset:2048 sc1
  s_mov_b64 exec, s[88:89]
  buffer_load_dwordx4 a[48:51], v4, s[16:19], s74 offen sc1
  s_mov_b64 exec, -1
  s_mov_b64 exec, s[88:89]
  buffer_load_dwordx4 a[52:55], v9, s[16:19], s74 offen sc1
  s_mov_b64 exec, -1
  s_mov_b64 exec, s[88:89]
  buffer_load_dwordx4 a[56:59], v10, s[16:19], s74 offen sc1
  s_mov_b64 exec, -1
  s_mov_b64 exec, s[88:89]
  buffer_load_dwordx4 a[60:63], v11, s[16:19], s74 offen sc1
  s_mov_b64 exec, -1
  s_mov_b32 s18, s78
  buffer_load_dwordx4 v[112:115], v2, s[16:19], s76 offen sc1
  buffer_load_dwordx4 v[116:119], v2, s[16:19], s76 offen offset:1024 sc1
  buffer_load_dwordx4 v[120:123], v3, s[16:19], s76 offen offset:2048 sc1
  s_waitcnt vmcnt(11)
  v_swap_b32 v126, v128
  v_swap_b32 v127, v129
  s_waitcnt vmcnt(8)
  v_cndmask_b32 v138, v132, 0, s[44:45]
  v_cndmask_b32 v139, v133, 0, s[44:45]
  v_cndmask_b32 v142, v134, 0, s[44:45]
  v_cndmask_b32 v143, v135, 0, s[44:45]
  v_swap_b32 v102, v104
  v_swap_b32 v103, v105
  s_nop 1
  v_mfma_f32_32x32x16_bf16 v[146:161], v[100:103], v[124:127], 0
  s_waitcnt vmcnt(7)
  v_mfma_f32_32x32x16_bf16 v[146:161], v[108:111], v[138:141], v[146:161]
  s_mov_b64 exec, s[88:89]
  buffer_load_dwordx4 a[64:67], v4, s[16:19], s77 offen sc1
  s_mov_b64 exec, -1
  s_mov_b64 exec, s[88:89]
  buffer_load_dwordx4 a[68:71], v9, s[16:19], s77 offen sc1
  s_mov_b64 exec, -1
  s_nop 5
  v_exp_f32 v146, v146
  v_exp_f32 v147, v147
  v_exp_f32 v148, v148
  v_exp_f32 v149, v149
  s_mov_b64 exec, s[88:89]
  v_mfma_f32_32x32x16_bf16 v[162:177], v[100:103], v[128:131], 0
  buffer_load_dwordx4 a[72:75], v10, s[16:19], s77 offen sc1
  s_mov_b64 exec, -1
  v_exp_f32 v150, v150
  v_exp_f32 v151, v151
  v_exp_f32 v152, v152
  v_exp_f32 v153, v153
  v_cvt_pk_bf16_f32 v210, v146, v147
  v_cvt_pk_bf16_f32 v211, v148, v149
  s_mov_b64 exec, s[88:89]
  v_mfma_f32_32x32x16_bf16 v[162:177], v[108:111], v[142:145], v[162:177]
  buffer_load_dwordx4 a[76:79], v11, s[16:19], s77 offen sc1
  s_mov_b64 exec, -1
  v_exp_f32 v154, v154
  v_exp_f32 v155, v155
  v_exp_f32 v156, v156
  v_exp_f32 v157, v157
  v_cvt_pk_bf16_f32 v212, v150, v151
  v_cvt_pk_bf16_f32 v213, v152, v153
  v_exp_f32 v158, v158
  v_exp_f32 v159, v159
  v_exp_f32 v160, v160
  v_exp_f32 v161, v161
  v_cvt_pk_bf16_f32 v214, v154, v155
  v_cvt_pk_bf16_f32 v215, v156, v157
  s_waitcnt vmcnt(10)
  v_mfma_f32_32x32x16_bf16 v[32:47], a[48:51], v[210:213], 0
  v_cvt_pk_bf16_f32 v216, v158, v159
  v_cvt_pk_bf16_f32 v217, v160, v161
  v_exp_f32 v162, v162
  v_exp_f32 v163, v163
  v_exp_f32 v164, v164
  v_exp_f32 v165, v165
  s_mov_b32 s18, s72
  v_mfma_f32_32x32x16_bf16 v[146:161], v[104:107], v[124:127], 0
  buffer_load_dwordx4 v[88:91], v2, s[16:19], s70 offen sc1
  v_exp_f32 v166, v166
  v_exp_f32 v167, v167
  v_exp_f32 v168, v168
  v_exp_f32 v169, v169
  v_cvt_pk_bf16_f32 v218, v162, v163
  v_cvt_pk_bf16_f32 v219, v164, v165
  v_mfma_f32_32x32x16_bf16 v[146:161], v[108:111], v[136:139], v[146:161]
  buffer_load_dwordx4 v[92:95], v2, s[16:19], s70 offen offset:1024 sc1
  v_exp_f32 v170, v170
  v_exp_f32 v171, v171
  v_exp_f32 v172, v172
  v_exp_f32 v173, v173
  v_cvt_pk_bf16_f32 v220, v166, v167
  v_cvt_pk_bf16_f32 v221, v168, v169
  s_waitcnt vmcnt(11)
  v_mfma_f32_32x32x16_bf16 v[32:47], a[52:55], v[214:217], v[32:47]
  v_exp_f32 v174, v174
  v_exp_f32 v175, v175
  v_exp_f32 v176, v176
  v_exp_f32 v177, v177
  v_cvt_pk_bf16_f32 v222, v170, v171
  v_cvt_pk_bf16_f32 v223, v172, v173
  v_mfma_f32_32x32x16_bf16 v[48:63], a[48:51], v[218:221], 0
  buffer_load_dwordx4 v[96:99], v3, s[16:19], s70 offen offset:2048 sc1
  v_cvt_pk_bf16_f32 v224, v174, v175
  v_cvt_pk_bf16_f32 v225, v176, v177
  v_exp_f32 v146, v146
  v_exp_f32 v147, v147
  v_exp_f32 v148, v148
  v_exp_f32 v149, v149
  s_mov_b64 exec, s[88:89]
  v_mfma_f32_32x32x16_bf16 v[162:177], v[104:107], v[128:131], 0
  buffer_load_dwordx4 a[32:35], v4, s[16:19], s71 offen sc1
  s_mov_b64 exec, -1
  v_exp_f32 v150, v150
  v_exp_f32 v151, v151
  v_exp_f32 v152, v152
  v_exp_f32 v153, v153
  v_cvt_pk_bf16_f32 v210, v146, v147
  v_cvt_pk_bf16_f32 v211, v148, v149
  v_mfma_f32_32x32x16_bf16 v[162:177], v[108:111], v[140:143], v[162:177]
  buffer_load_dword v6, v5, s[12:15], s94 offen sc1
  v_exp_f32 v154, v154
  v_exp_f32 v155, v155
  v_exp_f32 v156, v156
  v_exp_f32 v157, v157
  v_cvt_pk_bf16_f32 v212, v150, v151
  v_cvt_pk_bf16_f32 v213, v152, v153
  s_mov_b64 exec, s[88:89]
  v_mfma_f32_32x32x16_bf16 v[48:63], a[52:55], v[222:225], v[48:63]
  buffer_load_dwordx4 a[36:39], v9, s[16:19], s71 offen sc1
  s_mov_b64 exec, -1
  v_exp_f32 v158, v158
  v_exp_f32 v159, v159
  v_exp_f32 v160, v160
  v_exp_f32 v161, v161
  v_cvt_pk_bf16_f32 v214, v154, v155
  v_cvt_pk_bf16_f32 v215, v156, v157
  s_mov_b64 exec, s[88:89]
  s_waitcnt vmcnt(14)
  v_mfma_f32_32x32x16_bf16 v[32:47], a[56:59], v[210:213], v[32:47]
  buffer_load_dwordx4 a[40:43], v10, s[16:19], s71 offen sc1
  s_mov_b64 exec, -1
  v_cvt_pk_bf16_f32 v216, v158, v159
  v_cvt_pk_bf16_f32 v217, v160, v161
  s_waitcnt vmcnt(12)
  v_swap_b32 v114, v116
  v_swap_b32 v115, v117
  v_exp_f32 v162, v162
  v_exp_f32 v163, v163
  v_exp_f32 v164, v164
  v_exp_f32 v165, v165
  v_mfma_f32_32x32x16_bf16 v[146:161], v[112:115], v[124:127], v[194:209]
  v_exp_f32 v166, v166
  v_exp_f32 v167, v167
  v_exp_f32 v168, v168
  v_exp_f32 v169, v169
  v_cvt_pk_bf16_f32 v218, v162, v163
  v_cvt_pk_bf16_f32 v219, v164, v165
  s_mov_b64 exec, s[88:89]
  s_waitcnt vmcnt(11)
  v_mfma_f32_32x32x16_bf16 v[146:161], v[120:123], v[138:141], v[146:161]
  buffer_load_dwordx4 a[44:47], v11, s[16:19], s71 offen sc1
  s_mov_b64 exec, -1
  v_exp_f32 v170, v170
  v_exp_f32 v171, v171
  v_exp_f32 v172, v172
  v_exp_f32 v173, v173
  v_cvt_pk_bf16_f32 v220, v166, v167
  v_cvt_pk_bf16_f32 v221, v168, v169
  s_mov_b32 s18, s69
  v_mfma_f32_32x32x16_bf16 v[32:47], a[60:63], v[214:217], v[32:47]
  buffer_load_dwordx4 v[76:79], v2, s[16:19], s67 offen sc1
  v_exp_f32 v174, v174
  v_exp_f32 v175, v175
  v_exp_f32 v176, v176
  v_exp_f32 v177, v177
  v_cvt_pk_bf16_f32 v222, v170, v171
  v_cvt_pk_bf16_f32 v223, v172, v173
  v_mfma_f32_32x32x16_bf16 v[48:63], a[56:59], v[218:221], v[48:63]
  v_cvt_pk_bf16_f32 v224, v174, v175
  v_cvt_pk_bf16_f32 v225, v176, v177
  v_exp_f32 v146, v146
  v_exp_f32 v147, v147
  v_exp_f32 v148, v148
  v_exp_f32 v149, v149
  v_mfma_f32_32x32x16_bf16 v[162:177], v[112:115], v[128:131], 0
  buffer_load_dwordx4 v[80:83], v2, s[16:19], s67 offen offset:1024 sc1
  v_exp_f32 v150, v150
  v_exp_f32 v151, v151
  v_exp_f32 v152, v152
  v_exp_f32 v153, v153
  v_cvt_pk_bf16_f32 v210, v146, v147
  v_cvt_pk_bf16_f32 v211, v148, v149
  v_mfma_f32_32x32x16_bf16 v[162:177], v[120:123], v[142:145], v[162:177]
  buffer_load_dwordx4 v[84:87], v3, s[16:19], s67 offen offset:2048 sc1
  v_exp_f32 v154, v154
  v_exp_f32 v155, v155
  v_exp_f32 v156, v156
  v_exp_f32 v157, v157
  v_cvt_pk_bf16_f32 v212, v150, v151
  v_cvt_pk_bf16_f32 v213, v152, v153
  v_mfma_f32_32x32x16_bf16 v[48:63], a[60:63], v[222:225], v[48:63]
  v_exp_f32 v158, v158
  v_exp_f32 v159, v159
  v_exp_f32 v160, v160
  v_exp_f32 v161, v161
  v_cvt_pk_bf16_f32 v214, v154, v155
  v_cvt_pk_bf16_f32 v215, v156, v157
  s_mov_b64 exec, s[88:89]
  s_waitcnt vmcnt(14)
  v_mfma_f32_32x32x16_bf16 v[32:47], a[64:67], v[210:213], v[32:47]
  buffer_load_dwordx4 a[16:19], v4, s[16:19], s68 offen sc1
  s_mov_b64 exec, -1
  v_cvt_pk_bf16_f32 v216, v158, v159
  v_cvt_pk_bf16_f32 v217, v160, v161
  v_exp_f32 v162, v162
  v_exp_f32 v163, v163
  v_exp_f32 v164, v164
  v_exp_f32 v165, v165
  s_mov_b64 exec, s[88:89]
  v_mfma_f32_32x32x16_bf16 v[146:161], v[116:119], v[128:131], v[194:209]
  buffer_load_dwordx4 a[20:23], v9, s[16:19], s68 offen sc1
  s_mov_b64 exec, -1
  v_exp_f32 v166, v166
  v_exp_f32 v167, v167
  v_exp_f32 v168, v168
  v_exp_f32 v169, v169
  v_cvt_pk_bf16_f32 v218, v162, v163
  v_cvt_pk_bf16_f32 v219, v164, v165
  v_mfma_f32_32x32x16_bf16 v[146:161], v[120:123], v[140:143], v[146:161]
  v_exp_f32 v170, v170
  v_exp_f32 v171, v171
  v_exp_f32 v172, v172
  v_exp_f32 v173, v173
  v_cvt_pk_bf16_f32 v220, v166, v167
  v_cvt_pk_bf16_f32 v221, v168, v169
  s_mov_b64 exec, s[88:89]
  s_waitcnt vmcnt(15)
  v_mfma_f32_32x32x16_bf16 v[32:47], a[68:71], v[214:217], v[32:47]
  buffer_load_dwordx4 a[24:27], v10, s[16:19], s68 offen sc1
  s_mov_b64 exec, -1
  v_exp_f32 v174, v174
  v_exp_f32 v175, v175
  v_exp_f32 v176, v176
  v_exp_f32 v177, v177
  v_cvt_pk_bf16_f32 v222, v170, v171
  v_cvt_pk_bf16_f32 v223, v172, v173
  s_mov_b64 exec, s[88:89]
  v_mfma_f32_32x32x16_bf16 v[48:63], a[64:67], v[218:221], v[48:63]
  buffer_load_dwordx4 a[28:31], v11, s[16:19], s68 offen sc1
  s_mov_b64 exec, -1
  v_cvt_pk_bf16_f32 v224, v174, v175
  v_cvt_pk_bf16_f32 v225, v176, v177
  s_waitcnt vmcnt(13)
  v_swap_b32 v90, v92
  v_swap_b32 v91, v93
  v_exp_f32 v146, v146
  v_exp_f32 v147, v147
  v_exp_f32 v148, v148
  v_exp_f32 v149, v149
  v_mfma_f32_32x32x16_bf16 v[162:177], v[88:91], v[124:127], 0
  v_exp_f32 v150, v150
  v_exp_f32 v151, v151
  v_exp_f32 v152, v152
  v_exp_f32 v153, v153
  v_cvt_pk_bf16_f32 v210, v146, v147
  v_cvt_pk_bf16_f32 v211, v148, v149
  s_mov_b32 s18, s66
  s_waitcnt vmcnt(12)
  v_mfma_f32_32x32x16_bf16 v[162:177], v[96:99], v[138:141], v[162:177]
  buffer_load_dwordx4 v[64:67], v2, s[16:19], s64 offen sc1
  v_exp_f32 v154, v154
  v_exp_f32 v155, v155
  v_exp_f32 v156, v156
  v_exp_f32 v157, v157
  v_cvt_pk_bf16_f32 v212, v150, v151
  v_cvt_pk_bf16_f32 v213, v152, v153
  v_mfma_f32_32x32x16_bf16 v[48:63], a[68:71], v[222:225], v[48:63]
  buffer_load_dwordx4 v[68:71], v2, s[16:19], s64 offen offset:1024 sc1
  v_exp_f32 v158, v158
  v_exp_f32 v159, v159
  v_exp_f32 v160, v160
  v_exp_f32 v161, v161
  v_cvt_pk_bf16_f32 v214, v154, v155
  v_cvt_pk_bf16_f32 v215, v156, v157
  v_mfma_f32_32x32x16_bf16 v[48:63], a[72:75], v[210:213], v[48:63]
  v_cvt_pk_bf16_f32 v216, v158, v159
  v_cvt_pk_bf16_f32 v217, v160, v161
  v_exp_f32 v162, v162
  v_exp_f32 v163, v163
  v_exp_f32 v164, v164
  v_exp_f32 v165, v165
  v_mfma_f32_32x32x16_bf16 v[146:161], v[88:91], v[128:131], 0
  buffer_load_dwordx4 v[72:75], v3, s[16:19], s64 offen offset:2048 sc1
  v_exp_f32 v166, v166
  v_exp_f32 v167, v167
  v_exp_f32 v168, v168
  v_exp_f32 v169, v169
  v_cvt_pk_bf16_f32 v218, v162, v163
  v_cvt_pk_bf16_f32 v219, v164, v165
  s_mov_b64 exec, s[88:89]
  v_mfma_f32_32x32x16_bf16 v[146:161], v[96:99], v[142:145], v[146:161]
  buffer_load_dwordx4 a[0:3], v4, s[16:19], s65 offen sc1
  s_mov_b64 exec, -1
  v_exp_f32 v170, v170
  v_exp_f32 v171, v171
  v_exp_f32 v172, v172
  v_exp_f32 v173, v173
  v_cvt_pk_bf16_f32 v220, v166, v167
  v_cvt_pk_bf16_f32 v221, v168, v169
  v_mfma_f32_32x32x16_bf16 v[48:63], a[76:79], v[214:217], v[48:63]
  v_exp_f32 v174, v174
  v_exp_f32 v175, v175
  v_exp_f32 v176, v176
  v_exp_f32 v177, v177
  v_cvt_pk_bf16_f32 v222, v170, v171
  v_cvt_pk_bf16_f32 v223, v172, v173
  s_mov_b64 exec, s[88:89]
  s_waitcnt vmcnt(15)
  v_mfma_f32_32x32x16_bf16 v[32:47], a[32:35], v[218:221], v[32:47]
  buffer_load_dwordx4 a[4:7], v9, s[16:19], s65 offen sc1
  s_mov_b64 exec, -1
  v_cvt_pk_bf16_f32 v224, v174, v175
  v_cvt_pk_bf16_f32 v225, v176, v177
  v_exp_f32 v146, v146
  v_exp_f32 v147, v147
  v_exp_f32 v148, v148
  v_exp_f32 v149, v149
  s_mov_b64 exec, s[88:89]
  v_mfma_f32_32x32x16_bf16 v[162:177], v[92:95], v[124:127], 0
  buffer_load_dwordx4 a[8:11], v10, s[16:19], s65 offen sc1
  s_mov_b64 exec, -1
  v_exp_f32 v150, v150
  v_exp_f32 v151, v151
  v_exp_f32 v152, v152
  v_exp_f32 v153, v153
  v_cvt_pk_bf16_f32 v210, v146, v147
  v_cvt_pk_bf16_f32 v211, v148, v149
  v_mfma_f32_32x32x16_bf16 v[162:177], v[96:99], v[136:139], v[162:177]
  v_exp_f32 v154, v154
  v_exp_f32 v155, v155
  v_exp_f32 v156, v156
  v_exp_f32 v157, v157
  v_cvt_pk_bf16_f32 v212, v150, v151
  v_cvt_pk_bf16_f32 v213, v152, v153
  s_mov_b64 exec, s[88:89]
  s_waitcnt vmcnt(15)
  v_mfma_f32_32x32x16_bf16 v[32:47], a[36:39], v[222:225], v[32:47]
  buffer_load_dwordx4 a[12:15], v11, s[16:19], s65 offen sc1
  s_mov_b64 exec, -1
  v_exp_f32 v158, v158
  v_exp_f32 v159, v159
  v_exp_f32 v160, v160
  v_exp_f32 v161, v161
  v_cvt_pk_bf16_f32 v214, v154, v155
  v_cvt_pk_bf16_f32 v215, v156, v157
  v_mfma_f32_32x32x16_bf16 v[48:63], a[32:35], v[210:213], v[48:63]
  v_cvt_pk_bf16_f32 v216, v158, v159
  v_cvt_pk_bf16_f32 v217, v160, v161
  v_exp_f32 v162, v162
  v_exp_f32 v163, v163
  v_exp_f32 v164, v164
  v_exp_f32 v165, v165
  v_mfma_f32_32x32x16_bf16 v[146:161], v[92:95], v[128:131], 0
  buffer_load_dword v15, v14, s[12:15], s94 offen sc1
  v_exp_f32 v166, v166
  v_exp_f32 v167, v167
  v_exp_f32 v168, v168
  v_exp_f32 v169, v169
  v_cvt_pk_bf16_f32 v218, v162, v163
  v_cvt_pk_bf16_f32 v219, v164, v165
  v_mfma_f32_32x32x16_bf16 v[146:161], v[96:99], v[140:143], v[146:161]
  global_load_dword v249, v245, s[30:31]
  v_exp_f32 v170, v170
  v_exp_f32 v171, v171
  v_exp_f32 v172, v172
  v_exp_f32 v173, v173
  v_cvt_pk_bf16_f32 v220, v166, v167
  v_cvt_pk_bf16_f32 v221, v168, v169
  s_add_u32 m0, s95, 32768
  v_mfma_f32_32x32x16_bf16 v[48:63], a[36:39], v[214:217], v[48:63]
  buffer_load_dwordx4 v226, s[4:7], s51 offen offset:0 lds
  v_exp_f32 v174, v174
  v_exp_f32 v175, v175
  v_exp_f32 v176, v176
  v_exp_f32 v177, v177
  v_cvt_pk_bf16_f32 v222, v170, v171
  v_cvt_pk_bf16_f32 v223, v172, v173
  s_waitcnt vmcnt(18)
  v_mfma_f32_32x32x16_bf16 v[32:47], a[40:43], v[218:221], v[32:47]
  buffer_load_dwordx4 v227, s[4:7], s51 offen offset:1024 lds
  v_cvt_pk_bf16_f32 v224, v174, v175
  v_cvt_pk_bf16_f32 v225, v176, v177
  s_waitcnt vmcnt(16)
  v_swap_b32 v78, v80
  v_swap_b32 v79, v81
  v_exp_f32 v146, v146
  v_exp_f32 v147, v147
  v_exp_f32 v148, v148
  v_exp_f32 v149, v149
  v_mfma_f32_32x32x16_bf16 v[162:177], v[76:79], v[124:127], 0
  buffer_load_dwordx4 v228, s[4:7], s51 offen offset:2048 lds
  v_exp_f32 v150, v150
  v_exp_f32 v151, v151
  v_exp_f32 v152, v152
  v_exp_f32 v153, v153
  v_cvt_pk_bf16_f32 v210, v146, v147
  v_cvt_pk_bf16_f32 v211, v148, v149
  s_waitcnt vmcnt(16)
  v_mfma_f32_32x32x16_bf16 v[162:177], v[84:87], v[138:141], v[162:177]
  buffer_store_dwordx4 v[16:19], v2, s[12:15], s79 offen offset:0 sc1
  v_exp_f32 v154, v154
  v_exp_f32 v155, v155
  v_exp_f32 v156, v156
  v_exp_f32 v157, v157
  v_cvt_pk_bf16_f32 v212, v150, v151
  v_cvt_pk_bf16_f32 v213, v152, v153
  v_mfma_f32_32x32x16_bf16 v[32:47], a[44:47], v[222:225], v[32:47]
  v_exp_f32 v158, v158
  v_exp_f32 v159, v159
  v_exp_f32 v160, v160
  v_exp_f32 v161, v161
  v_cvt_pk_bf16_f32 v214, v154, v155
  v_cvt_pk_bf16_f32 v215, v156, v157
  v_mfma_f32_32x32x16_bf16 v[48:63], a[40:43], v[210:213], v[48:63]
  buffer_store_dwordx4 v[16:19], v2, s[12:15], s79 offen offset:1024 sc1
  v_cvt_pk_bf16_f32 v216, v158, v159
  v_cvt_pk_bf16_f32 v217, v160, v161
  v_exp_f32 v162, v162
  v_exp_f32 v163, v163
  v_exp_f32 v164, v164
  v_exp_f32 v165, v165
  v_mfma_f32_32x32x16_bf16 v[146:161], v[76:79], v[128:131], 0
  v_exp_f32 v166, v166
  v_exp_f32 v167, v167
  v_exp_f32 v168, v168
  v_exp_f32 v169, v169
  v_cvt_pk_bf16_f32 v218, v162, v163
  v_cvt_pk_bf16_f32 v219, v164, v165
  v_mfma_f32_32x32x16_bf16 v[146:161], v[84:87], v[142:145], v[146:161]
  buffer_store_dwordx2 v[16:17], v20, s[12:15], s79 offen offset:2048 sc1
  v_exp_f32 v170, v170
  v_exp_f32 v171, v171
  v_exp_f32 v172, v172
  v_exp_f32 v173, v173
  v_cvt_pk_bf16_f32 v220, v166, v167
  v_cvt_pk_bf16_f32 v221, v168, v169
  v_mfma_f32_32x32x16_bf16 v[48:63], a[44:47], v[214:217], v[48:63]
  v_exp_f32 v174, v174
  v_exp_f32 v175, v175
  v_exp_f32 v176, v176
  v_exp_f32 v177, v177
  v_cvt_pk_bf16_f32 v222, v170, v171
  v_cvt_pk_bf16_f32 v223, v172, v173
  s_waitcnt vmcnt(18)
  v_mfma_f32_32x32x16_bf16 v[32:47], a[16:19], v[218:221], v[32:47]
  v_cvt_pk_bf16_f32 v224, v174, v175
  v_cvt_pk_bf16_f32 v225, v176, v177
  v_exp_f32 v146, v146
  v_exp_f32 v147, v147
  v_exp_f32 v148, v148
  v_exp_f32 v149, v149
  v_mfma_f32_32x32x16_bf16 v[162:177], v[80:83], v[124:127], 0
  v_exp_f32 v150, v150
  v_exp_f32 v151, v151
  v_exp_f32 v152, v152
  v_exp_f32 v153, v153
  v_cvt_pk_bf16_f32 v210, v146, v147
  v_cvt_pk_bf16_f32 v211, v148, v149
  v_mfma_f32_32x32x16_bf16 v[162:177], v[84:87], v[136:139], v[162:177]
  v_exp_f32 v154, v154
  v_exp_f32 v155, v155
  v_exp_f32 v156, v156
  v_exp_f32 v157, v157
  v_cvt_pk_bf16_f32 v212, v150, v151
  v_cvt_pk_bf16_f32 v213, v152, v153
  s_waitcnt vmcnt(17)
  v_mfma_f32_32x32x16_bf16 v[32:47], a[20:23], v[222:225], v[32:47]
  v_exp_f32 v158, v158
  v_exp_f32 v159, v159
  v_exp_f32 v160, v160
  v_exp_f32 v161, v161
  v_cvt_pk_bf16_f32 v214, v154, v155
  v_cvt_pk_bf16_f32 v215, v156, v157
  v_mfma_f32_32x32x16_bf16 v[48:63], a[16:19], v[210:213], v[48:63]
  v_subrev_u32 v253, s37, v6
  v_cmp_le_u32 vcc, 16, v253
  s_nop 3
  s_cbranch_vccnz Lfs_45
Lfb_46:
  s_add_u32 s49, s37, s87
  v_cmp_ne_u32 vcc, s49, v6
  s_nop 0
  s_andn2_b64 vcc, vcc, s[44:45]
  s_cselect_b32 s86, 0, 1
  v_cvt_pk_bf16_f32 v216, v158, v159
  v_cvt_pk_bf16_f32 v217, v160, v161
  v_exp_f32 v162, v162
  v_exp_f32 v163, v163
  v_exp_f32 v164, v164
  v_exp_f32 v165, v165
  s_add_u32 m0, s95, 0
  v_add_u32 v251, s91, v2
  v_mfma_f32_32x32x16_bf16 v[146:161], v[80:83], v[128:131], 0
  global_load_lds_dwordx4 v251, s[12:13] offset:0 sc1
  v_exp_f32 v166, v166
  v_exp_f32 v167, v167
  v_exp_f32 v168, v168
  v_exp_f32 v169, v169
  v_cvt_pk_bf16_f32 v218, v162, v163
  v_cvt_pk_bf16_f32 v219, v164, v165
  v_mfma_f32_32x32x16_bf16 v[146:161], v[84:87], v[140:143], v[146:161]
  global_load_lds_dwordx4 v251, s[12:13] offset:1024 sc1
  v_exp_f32 v170, v170
  v_exp_f32 v171, v171
  v_exp_f32 v172, v172
  v_exp_f32 v173, v173
  v_cvt_pk_bf16_f32 v220, v166, v167
  v_cvt_pk_bf16_f32 v221, v168, v169
  v_mfma_f32_32x32x16_bf16 v[48:63], a[20:23], v[214:217], v[48:63]
  global_load_lds_dwordx4 v251, s[12:13] offset:2048 sc1
  v_exp_f32 v174, v174
  v_exp_f32 v175, v175
  v_exp_f32 v176, v176
  v_exp_f32 v177, v177
  v_cvt_pk_bf16_f32 v222, v170, v171
  v_cvt_pk_bf16_f32 v223, v172, v173
  s_waitcnt vmcnt(19)
  v_mfma_f32_32x32x16_bf16 v[32:47], a[24:27], v[218:221], v[32:47]
  global_load_lds_dwordx4 v251, s[12:13] offset:3072 sc1
  v_cvt_pk_bf16_f32 v224, v174, v175
  v_cvt_pk_bf16_f32 v225, v176, v177
  s_waitcnt vmcnt(17)
  v_swap_b32 v66, v68
  v_swap_b32 v67, v69
  v_exp_f32 v146, v146
  v_exp_f32 v147, v147
  v_exp_f32 v148, v148
  v_exp_f32 v149, v149
  s_add_u32 m0, s95, 4096
  v_add_u32 v251, 4096, v251
  v_mfma_f32_32x32x16_bf16 v[162:177], v[64:67], v[124:127], v[178:193]
  global_load_lds_dwordx4 v251, s[12:13] offset:0 sc1
  v_exp_f32 v150, v150
  v_exp_f32 v151, v151
  v_exp_f32 v152, v152
  v_exp_f32 v153, v153
  v_cvt_pk_bf16_f32 v210, v146, v147
  v_cvt_pk_bf16_f32 v211, v148, v149
  s_waitcnt vmcnt(17)
  v_mfma_f32_32x32x16_bf16 v[162:177], v[72:75], v[138:141], v[162:177]
  global_load_lds_dwordx4 v251, s[12:13] offset:1024 sc1
  v_exp_f32 v154, v154
  v_exp_f32 v155, v155
  v_exp_f32 v156, v156
  v_exp_f32 v157, v157
  v_cvt_pk_bf16_f32 v212, v150, v151
  v_cvt_pk_bf16_f32 v213, v152, v153
  v_mfma_f32_32x32x16_bf16 v[32:47], a[28:31], v[222:225], v[32:47]
  global_load_lds_dwordx4 v251, s[12:13] offset:2048 sc1
  v_exp_f32 v158, v158
  v_exp_f32 v159, v159
  v_exp_f32 v160, v160
  v_exp_f32 v161, v161
  v_cvt_pk_bf16_f32 v214, v154, v155
  v_cvt_pk_bf16_f32 v215, v156, v157
  v_mfma_f32_32x32x16_bf16 v[48:63], a[24:27], v[210:213], v[48:63]
  global_load_lds_dwordx4 v251, s[12:13] offset:3072 sc1
  v_cvt_pk_bf16_f32 v216, v158, v159
  v_cvt_pk_bf16_f32 v217, v160, v161
  v_exp_f32 v162, v162
  v_exp_f32 v163, v163
  v_exp_f32 v164, v164
  v_exp_f32 v165, v165
  s_add_u32 m0, s95, 8192
  v_add_u32 v251, 4096, v251
  v_mfma_f32_32x32x16_bf16 v[146:161], v[68:71], v[124:127], 0
  global_load_lds_dwordx4 v251, s[12:13] offset:0 sc1
  v_exp_f32 v166, v166
  v_exp_f32 v167, v167
  v_exp_f32 v168, v168
  v_exp_f32 v169, v169
  v_cvt_pk_bf16_f32 v218, v162, v163
  v_cvt_pk_bf16_f32 v219, v164, v165
  v_mfma_f32_32x32x16_bf16 v[146:161], v[72:75], v[136:139], v[146:161]
  global_load_lds_dwordx4 v251, s[12:13] offset:1024 sc1
  v_exp_f32 v170, v170
  v_exp_f32 v171, v171
  v_exp_f32 v172, v172
  v_exp_f32 v173, v173
  v_cvt_pk_bf16_f32 v220, v166, v167
  v_cvt_pk_bf16_f32 v221, v168, v169
  v_mfma_f32_32x32x16_bf16 v[48:63], a[28:31], v[214:217], v[48:63]
  global_load_lds_dwordx4 v251, s[12:13] offset:2048 sc1
  v_exp_f32 v174, v174
  v_exp_f32 v175, v175
  v_exp_f32 v176, v176
  v_exp_f32 v177, v177
  v_cvt_pk_bf16_f32 v222, v170, v171
  v_cvt_pk_bf16_f32 v223, v172, v173
  s_waitcnt vmcnt(22)
  v_mfma_f32_32x32x16_bf16 v[32:47], a[0:3], v[218:221], v[32:47]
  global_load_lds_dwordx4 v251, s[12:13] offset:3072 sc1
  v_cvt_pk_bf16_f32 v224, v174, v175
  v_cvt_pk_bf16_f32 v225, v176, v177
  v_exp_f32 v146, v146
  v_exp_f32 v147, v147
  v_exp_f32 v148, v148
  v_exp_f32 v149, v149
  s_add_u32 m0, s95, 12288
  v_add_u32 v251, 4096, v251
  v_mfma_f32_32x32x16_bf16 v[162:177], v[68:71], v[128:131], v[178:193]
  global_load_lds_dwordx4 v251, s[12:13] offset:0 sc1
  v_exp_f32 v150, v150
  v_exp_f32 v151, v151
  v_exp_f32 v152, v152
  v_exp_f32 v153, v153
  v_cvt_pk_bf16_f32 v210, v146, v147
  v_cvt_pk_bf16_f32 v211, v148, v149
  v_mfma_f32_32x32x16_bf16 v[162:177], v[72:75], v[140:143], v[162:177]
  global_load_lds_dwordx4 v251, s[12:13] offset:1024 sc1
  v_exp_f32 v154, v154
  v_exp_f32 v155, v155
  v_exp_f32 v156, v156
  v_exp_f32 v157, v157
  v_cvt_pk_bf16_f32 v212, v150, v151
  v_cvt_pk_bf16_f32 v213, v152, v153
  s_waitcnt vmcnt(24)
  v_mfma_f32_32x32x16_bf16 v[32:47], a[4:7], v[222:225], v[32:47]
  v_exp_f32 v158, v158
  v_exp_f32 v159, v159
  v_exp_f32 v160, v160
  v_exp_f32 v161, v161
  v_cvt_pk_bf16_f32 v214, v154, v155
  v_cvt_pk_bf16_f32 v215, v156, v157
  s_waitcnt vmcnt(23)
  v_mfma_f32_32x32x16_bf16 v[32:47], a[8:11], v[210:213], v[32:47]
  v_cvt_pk_bf16_f32 v216, v158, v159
  v_cvt_pk_bf16_f32 v217, v160, v161
  v_exp_f32 v162, v162
  v_exp_f32 v163, v163
  v_exp_f32 v164, v164
  v_exp_f32 v165, v165
  v_exp_f32 v166, v166
  v_exp_f32 v167, v167
  v_exp_f32 v168, v168
  v_exp_f32 v169, v169
  v_cvt_pk_bf16_f32 v218, v162, v163
  v_cvt_pk_bf16_f32 v219, v164, v165
  v_exp_f32 v170, v170
  v_exp_f32 v171, v171
  v_exp_f32 v172, v172
  v_exp_f32 v173, v173
  v_cvt_pk_bf16_f32 v220, v166, v167
  v_cvt_pk_bf16_f32 v221, v168, v169
  s_waitcnt vmcnt(22)
  v_mfma_f32_32x32x16_bf16 v[32:47], a[12:15], v[214:217], v[32:47]
  v_exp_f32 v174, v174
  v_exp_f32 v175, v175
  v_exp_f32 v176, v176
  v_exp_f32 v177, v177
  v_cvt_pk_bf16_f32 v222, v170, v171
  v_cvt_pk_bf16_f32 v223, v172, v173
  v_mfma_f32_32x32x16_bf16 v[48:63], a[8:11], v[218:221], v[48:63]
  v_cvt_pk_bf16_f32 v224, v174, v175
  v_cvt_pk_bf16_f32 v225, v176, v177
  s_nop 1
  v_mfma_f32_32x32x16_bf16 v[48:63], a[12:15], v[222:225], v[48:63]
  s_nop 10
  s_branch Lattn_done
Lav_42:
  s_mov_b32 s18, s72
  s_barrier
  buffer_load_dwordx4 v[124:127], v2, s[12:15], s53 offen sc1
  buffer_load_dwordx4 v[128:131], v2, s[12:15], s53 offen offset:1024 sc1
  buffer_load_dwordx4 v[88:91], v2, s[16:19], s70 offen sc1
  buffer_load_dwordx4 v[92:95], v2, s[16:19], s70 offen offset:1024 sc1
  buffer_load_dwordx4 v[132:135], v3, s[12:15], s53 offen offset:2048 sc1
  buffer_load_dwordx4 v[96:99], v3, s[16:19], s70 offen offset:2048 sc1
  s_mov_b64 exec, s[88:89]
  buffer_load_dwordx4 a[32:35], v4, s[16:19], s71 offen sc1
  s_mov_b64 exec, -1
  s_mov_b64 exec, s[88:89]
  buffer_load_dwordx4 a[36:39], v9, s[16:19], s71 offen sc1
  s_mov_b64 exec, -1
  s_mov_b64 exec, s[88:89]
  buffer_load_dwordx4 a[40:43], v10, s[16:19], s71 offen sc1
  s_mov_b64 exec, -1
  s_mov_b64 exec, s[88:89]
  buffer_load_dwordx4 a[44:47], v11, s[16:19], s71 offen sc1
  s_mov_b64 exec, -1
  s_mov_b32 s18, s75
  buffer_load_dwordx4 v[100:103], v2, s[16:19], s73 offen sc1
  buffer_load_dwordx4 v[104:107], v2, s[16:19], s73 offen offset:1024 sc1
  buffer_load_dwordx4 v[108:111], v3, s[16:19], s73 offen offset:2048 sc1
  s_waitcnt vmcnt(11)
  v_swap_b32 v126, v128
  v_swap_b32 v127, v129
  s_waitcnt vmcnt(8)
  v_cndmask_b32 v138, v132, 0, s[44:45]
  v_cndmask_b32 v139, v133, 0, s[44:45]
  v_cndmask_b32 v142, v134, 0, s[44:45]
  v_cndmask_b32 v143, v135, 0, s[44:45]
  v_swap_b32 v90, v92
  v_swap_b32 v91, v93
  s_nop 1
  v_mfma_f32_32x32x16_bf16 v[146:161], v[88:91], v[124:127], 0
  s_waitcnt vmcnt(7)
  v_mfma_f32_32x32x16_bf16 v[146:161], v[96:99], v[138:141], v[146:161]
  s_mov_b64 exec, s[88:89]
  buffer_load_dwordx4 a[48:51], v4, s[16:19], s74 offen sc1
  s_mov_b64 exec, -1
  s_mov_b64 exec, s[88:89]
  buffer_load_dwordx4 a[52:55], v9, s[16:19], s74 offen sc1
  s_mov_b64 exec, -1
  s_nop 5
  v_exp_f32 v146, v146
  v_exp_f32 v147, v147
  v_exp_f32 v148, v148
  v_exp_f32 v149, v149
  s_mov_b64 exec, s[88:89]
  v_mfma_f32_32x32x16_bf16 v[162:177], v[88:91], v[128:131], 0
  buffer_load_dwordx4 a[56:59], v10, s[16:19], s74 offen sc1
  s_mov_b64 exec, -1
  v_exp_f32 v150, v150
  v_exp_f32 v151, v151
  v_exp_f32 v152, v152
  v_exp_f32 v153, v153
  v_cvt_pk_bf16_f32 v210, v146, v147
  v_cvt_pk_bf16_f32 v211, v148, v149
  s_mov_b64 exec, s[88:89]
  v_mfma_f32_32x32x16_bf16 v[162:177], v[96:99], v[142:145], v[162:177]
  buffer_load_dwordx4 a[60:63], v11, s[16:19], s74 offen sc1
  s_mov_b64 exec, -1
  v_exp_f32 v154, v154
  v_exp_f32 v155, v155
  v_exp_f32 v156, v156
  v_exp_f32 v157, v157
  v_cvt_pk_bf16_f32 v212, v150, v151
  v_cvt_pk_bf16_f32 v213, v152, v153
  v_exp_f32 v158, v158
  v_exp_f32 v159, v159
  v_exp_f32 v160, v160
  v_exp_f32 v161, v161
  v_cvt_pk_bf16_f32 v214, v154, v155
  v_cvt_pk_bf16_f32 v215, v156, v157
  s_waitcnt vmcnt(10)
  v_mfma_f32_32x32x16_bf16 v[32:47], a[32:35], v[210:213], 0
  v_cvt_pk_bf16_f32 v216, v158, v159
  v_cvt_pk_bf16_f32 v217, v160, v161
  v_exp_f32 v162, v162
  v_exp_f32 v163, v163
  v_exp_f32 v164, v164
  v_exp_f32 v165, v165
  s_mov_b32 s18, s69
  v_mfma_f32_32x32x16_bf16 v[146:161], v[92:95], v[124:127], 0
  buffer_load_dwordx4 v[76:79], v2, s[16:19], s67 offen sc1
  v_exp_f32 v166, v166
  v_exp_f32 v167, v167
  v_exp_f32 v168, v168
  v_exp_f32 v169, v169
  v_cvt_pk_bf16_f32 v218, v162, v163
  v_cvt_pk_bf16_f32 v219, v164, v165
  v_mfma_f32_32x32x16_bf16 v[146:161], v[96:99], v[136:139], v[146:161]
  buffer_load_dwordx4 v[80:83], v2, s[16:19], s67 offen offset:1024 sc1
  v_exp_f32 v170, v170
  v_exp_f32 v171, v171
  v_exp_f32 v172, v172
  v_exp_f32 v173, v173
  v_cvt_pk_bf16_f32 v220, v166, v167
  v_cvt_pk_bf16_f32 v221, v168, v169
  s_waitcnt vmcnt(11)
  v_mfma_f32_32x32x16_bf16 v[32:47], a[36:39], v[214:217], v[32:47]
  v_exp_f32 v174, v174
  v_exp_f32 v175, v175
  v_exp_f32 v176, v176
  v_exp_f32 v177, v177
  v_cvt_pk_bf16_f32 v222, v170, v171
  v_cvt_pk_bf16_f32 v223, v172, v173
  v_mfma_f32_32x32x16_bf16 v[48:63], a[32:35], v[218:221], 0
  buffer_load_dwordx4 v[84:87], v3, s[16:19], s67 offen offset:2048 sc1
  v_cvt_pk_bf16_f32 v224, v174, v175
  v_cvt_pk_bf16_f32 v225, v176, v177
  v_exp_f32 v146, v146
  v_exp_f32 v147, v147
  v_exp_f32 v148, v148
  v_exp_f32 v149, v149
  s_mov_b64 exec, s[88:89]
  v_mfma_f32_32x32x16_bf16 v[162:177], v[92:95], v[128:131], 0
  buffer_load_dwordx4 a[16:19], v4, s[16:19], s68 offen sc1
  s_mov_b64 exec, -1
  v_exp_f32 v150, v150
  v_exp_f32 v151, v151
  v_exp_f32 v152, v152
  v_exp_f32 v153, v153
  v_cvt_pk_bf16_f32 v210, v146, v147
  v_cvt_pk_bf16_f32 v211, v148, v149
  v_mfma_f32_32x32x16_bf16 v[162:177], v[96:99], v[140:143], v[162:177]
  buffer_load_dword v6, v5, s[12:15], s94 offen sc1
  v_exp_f32 v154, v154
  v_exp_f32 v155, v155
  v_exp_f32 v156, v156
  v_exp_f32 v157, v157
  v_cvt_pk_bf16_f32 v212, v150, v151
  v_cvt_pk_bf16_f32 v213, v152, v153
  s_mov_b64 exec, s[88:89]
  v_mfma_f32_32x32x16_bf16 v[48:63], a[36:39], v[222:225], v[48:63]
  buffer_load_dwordx4 a[20:23], v9, s[16:19], s68 offen sc1
  s_mov_b64 exec, -1
  v_exp_f32 v158, v158
  v_exp_f32 v159, v159
  v_exp_f32 v160, v160
  v_exp_f32 v161, v161
  v_cvt_pk_bf16_f32 v214, v154, v155
  v_cvt_pk_bf16_f32 v215, v156, v157
  s_mov_b64 exec, s[88:89]
  s_waitcnt vmcnt(14)
  v_mfma_f32_32x32x16_bf16 v[32:47], a[40:43], v[210:213], v[32:47]
  buffer_load_dwordx4 a[24:27], v10, s[16:19], s68 offen sc1
  s_mov_b64 exec, -1
  v_cvt_pk_bf16_f32 v216, v158, v159
  v_cvt_pk_bf16_f32 v217, v160, v161
  s_waitcnt vmcnt(12)
  v_swap_b32 v102, v104
  v_swap_b32 v103, v105
  v_exp_f32 v162, v162
  v_exp_f32 v163, v163
  v_exp_f32 v164, v164
  v_exp_f32 v165, v165
  v_mfma_f32_32x32x16_bf16 v[146:161], v[100:103], v[124:127], 0
  v_exp_f32 v166, v166
  v_exp_f32 v167, v167
  v_exp_f32 v168, v168
  v_exp_f32 v169, v169
  v_cvt_pk_bf16_f32 v218, v162, v163
  v_cvt_pk_bf16_f32 v219, v164, v165
  s_mov_b64 exec, s[88:89]
  s_waitcnt vmcnt(11)
  v_mfma_f32_32x32x16_bf16 v[146:161], v[108:111], v[138:141], v[146:161]
  buffer_load_dwordx4 a[28:31], v11, s[16:19], s68 offen sc1
  s_mov_b64 exec, -1
  v_exp_f32 v170, v170
  v_exp_f32 v171, v171
  v_exp_f32 v172, v172
  v_exp_f32 v173, v173
  v_cvt_pk_bf16_f32 v220, v166, v167
  v_cvt_pk_bf16_f32 v221, v168, v169
  s_mov_b32 s18, s78
  v_mfma_f32_32x32x16_bf16 v[32:47], a[44:47], v[214:217], v[32:47]
  buffer_load_dwordx4 v[112:115], v2, s[16:19], s76 offen sc1
  v_exp_f32 v174, v174
  v_exp_f32 v175, v175
  v_exp_f32 v176, v176
  v_exp_f32 v177, v177
  v_cvt_pk_bf16_f32 v222, v170, v171
  v_cvt_pk_bf16_f32 v223, v172, v173
  v_mfma_f32_32x32x16_bf16 v[48:63], a[40:43], v[218:221], v[48:63]
  v_cvt_pk_bf16_f32 v224, v174, v175
  v_cvt_pk_bf16_f32 v225, v176, v177
  v_exp_f32 v146, v146
  v_exp_f32 v147, v147
  v_exp_f32 v148, v148
  v_exp_f32 v149, v149
  v_mfma_f32_32x32x16_bf16 v[162:177], v[100:103], v[128:131], 0
  buffer_load_dwordx4 v[116:119], v2, s[16:19], s76 offen offset:1024 sc1
  v_exp_f32 v150, v150
  v_exp_f32 v151, v151
  v_exp_f32 v152, v152
  v_exp_f32 v153, v153
  v_cvt_pk_bf16_f32 v210, v146, v147
  v_cvt_pk_bf16_f32 v211, v148, v149
  v_mfma_f32_32x32x16_bf16 v[162:177], v[108:111], v[142:145], v[162:177]
  buffer_load_dwordx4 v[120:123], v3, s[16:19], s76 offen offset:2048 sc1
  v_exp_f32 v154, v154
  v_exp_f32 v155, v155
  v_exp_f32 v156, v156
  v_exp_f32 v157, v157
  v_cvt_pk_bf16_f32 v212, v150, v151
  v_cvt_pk_bf16_f32 v213, v152, v153
  v_mfma_f32_32x32x16_bf16 v[48:63], a[44:47], v[222:225], v[48:63]
  v_exp_f32 v158, v158
  v_exp_f32 v159, v159
  v_exp_f32 v160, v160
  v_exp_f32 v161, v161
  v_cvt_pk_bf16_f32 v214, v154, v155
  v_cvt_pk_bf16_f32 v215, v156, v157
  s_mov_b64 exec, s[88:89]
  s_waitcnt vmcnt(14)
  v_mfma_f32_32x32x16_bf16 v[32:47], a[48:51], v[210:213], v[32:47]
  buffer_load_dwordx4 a[64:67], v4, s[16:19], s77 offen sc1
  s_mov_b64 exec, -1
  v_cvt_pk_bf16_f32 v216, v158, v159
  v_cvt_pk_bf16_f32 v217, v160, v161
  v_exp_f32 v162, v162
  v_exp_f32 v163, v163
  v_exp_f32 v164, v164
  v_exp_f32 v165, v165
  s_mov_b64 exec, s[88:89]
  v_mfma_f32_32x32x16_bf16 v[146:161], v[104:107], v[124:127], 0
  buffer_load_dwordx4 a[68:71], v9, s[16:19], s77 offen sc1
  s_mov_b64 exec, -1
  v_exp_f32 v166, v166
  v_exp_f32 v167, v167
  v_exp_f32 v168, v168
  v_exp_f32 v169, v169
  v_cvt_pk_bf16_f32 v218, v162, v163
  v_cvt_pk_bf16_f32 v219, v164, v165
  v_mfma_f32_32x32x16_bf16 v[146:161], v[108:111], v[136:139], v[146:161]
  v_exp_f32 v170, v170
  v_exp_f32 v171, v171
  v_exp_f32 v172, v172
  v_exp_f32 v173, v173
  v_cvt_pk_bf16_f32 v220, v166, v167
  v_cvt_pk_bf16_f32 v221, v168, v169
  s_mov_b64 exec, s[88:89]
  s_waitcnt vmcnt(15)
  v_mfma_f32_32x32x16_bf16 v[32:47], a[52:55], v[214:217], v[32:47]
  buffer_load_dwordx4 a[72:75], v10, s[16:19], s77 offen sc1
  s_mov_b64 exec, -1
  v_exp_f32 v174, v174
  v_exp_f32 v175, v175
  v_exp_f32 v176, v176
  v_exp_f32 v177, v177
  v_cvt_pk_bf16_f32 v222, v170, v171
  v_cvt_pk_bf16_f32 v223, v172, v173
  s_mov_b64 exec, s[88:89]
  v_mfma_f32_32x32x16_bf16 v[48:63], a[48:51], v[218:221], v[48:63]
  buffer_load_dwordx4 a[76:79], v11, s[16:19], s77 offen sc1
  s_mov_b64 exec, -1
  v_cvt_pk_bf16_f32 v224, v174, v175
  v_cvt_pk_bf16_f32 v225, v176, v177
  v_exp_f32 v146, v146
  v_exp_f32 v147, v147
  v_exp_f32 v148, v148
  v_exp_f32 v149, v149
  v_mfma_f32_32x32x16_bf16 v[162:177], v[104:107], v[128:131], 0
  v_exp_f32 v150, v150
  v_exp_f32 v151, v151
  v_exp_f32 v152, v152
  v_exp_f32 v153, v153
  v_cvt_pk_bf16_f32 v210, v146, v147
  v_cvt_pk_bf16_f32 v211, v148, v149
  s_mov_b32 s18, s66
  v_mfma_f32_32x32x16_bf16 v[162:177], v[108:111], v[140:143], v[162:177]
  buffer_load_dwordx4 v[64:67], v2, s[16:19], s64 offen sc1
  v_exp_f32 v154, v154
  v_exp_f32 v155, v155
  v_exp_f32 v156, v156
  v_exp_f32 v157, v157
  v_cvt_pk_bf16_f32 v212, v150, v151
  v_cvt_pk_bf16_f32 v213, v152, v153
  v_mfma_f32_32x32x16_bf16 v[48:63], a[52:55], v[222:225], v[48:63]
  buffer_load_dwordx4 v[68:71], v2, s[16:19], s64 offen offset:1024 sc1
  v_exp_f32 v158, v158
  v_exp_f32 v159, v159
  v_exp_f32 v160, v160
  v_exp_f32 v161, v161
  v_cvt_pk_bf16_f32 v214, v154, v155
  v_cvt_pk_bf16_f32 v215, v156, v157
  s_waitcnt vmcnt(18)
  v_mfma_f32_32x32x16_bf16 v[32:47], a[56:59], v[210:213], v[32:47]
  v_cvt_pk_bf16_f32 v216, v158, v159
  v_cvt_pk_bf16_f32 v217, v160, v161
  s_waitcnt vmcnt(15)
  v_swap_b32 v78, v80
  v_swap_b32 v79, v81
  v_exp_f32 v162, v162
  v_exp_f32 v163, v163
  v_exp_f32 v164, v164
  v_exp_f32 v165, v165
  v_mfma_f32_32x32x16_bf16 v[146:161], v[76:79], v[124:127], 0
  buffer_load_dwordx4 v[72:75], v3, s[16:19], s64 offen offset:2048 sc1
  v_exp_f32 v166, v166
  v_exp_f32 v167, v167
  v_exp_f32 v168, v168
  v_exp_f32 v169, v169
  v_cvt_pk_bf16_f32 v218, v162, v163
  v_cvt_pk_bf16_f32 v219, v164, v165
  s_mov_b64 exec, s[88:89]
  s_waitcnt vmcnt(15)
  v_mfma_f32_32x32x16_bf16 v[146:161], v[84:87], v[138:141], v[146:161]
  buffer_load_dwordx4 a[0:3], v4, s[16:19], s65 offen sc1
  s_mov_b64 exec, -1
  v_exp_f32 v170, v170
  v_exp_f32 v171, v171
  v_exp_f32 v172, v172
  v_exp_f32 v173, v173
  v_cvt_pk_bf16_f32 v220, v166, v167
  v_cvt_pk_bf16_f32 v221, v168, v169
  v_mfma_f32_32x32x16_bf16 v[32:47], a[60:63], v[214:217], v[32:47]
  v_exp_f32 v174, v174
  v_exp_f32 v175, v175
  v_exp_f32 v176, v176
  v_exp_f32 v177, v177
  v_cvt_pk_bf16_f32 v222, v170, v171
  v_cvt_pk_bf16_f32 v223, v172, v173
  s_mov_b64 exec, s[88:89]
  v_mfma_f32_32x32x16_bf16 v[48:63], a[56:59], v[218:221], v[48:63]
  buffer_load_dwordx4 a[4:7], v9, s[16:19], s65 offen sc1
  s_mov_b64 exec, -1
  v_cvt_pk_bf16_f32 v224, v174, v175
  v_cvt_pk_bf16_f32 v225, v176, v177
  v_exp_f32 v146, v146
  v_exp_f32 v147, v147
  v_exp_f32 v148, v148
  v_exp_f32 v149, v149
  s_mov_b64 exec, s[88:89]
  v_mfma_f32_32x32x16_bf16 v[162:177], v[76:79], v[128:131], 0
  buffer_load_dwordx4 a[8:11], v10, s[16:19], s65 offen sc1
  s_mov_b64 exec, -1
  v_exp_f32 v150, v150
  v_exp_f32 v151, v151
  v_exp_f32 v152, v152
  v_exp_f32 v153, v153
  v_cvt_pk_bf16_f32 v210, v146, v147
  v_cvt_pk_bf16_f32 v211, v148, v149
  v_mfma_f32_32x32x16_bf16 v[162:177], v[84:87], v[142:145], v[162:177]
  v_exp_f32 v154, v154
  v_exp_f32 v155, v155
  v_exp_f32 v156, v156
  v_exp_f32 v157, v157
  v_cvt_pk_bf16_f32 v212, v150, v151
  v_cvt_pk_bf16_f32 v213, v152, v153
  s_mov_b64 exec, s[88:89]
  v_mfma_f32_32x32x16_bf16 v[48:63], a[60:63], v[222:225], v[48:63]
  buffer_load_dwordx4 a[12:15], v11, s[16:19], s65 offen sc1
  s_mov_b64 exec, -1
  v_exp_f32 v158, v158
  v_exp_f32 v159, v159
  v_exp_f32 v160, v160
  v_exp_f32 v161, v161
  v_cvt_pk_bf16_f32 v214, v154, v155
  v_cvt_pk_bf16_f32 v215, v156, v157
  s_waitcnt vmcnt(18)
  v_mfma_f32_32x32x16_bf16 v[32:47], a[16:19], v[210:213], v[32:47]
  v_cvt_pk_bf16_f32 v216, v158, v159
  v_cvt_pk_bf16_f32 v217, v160, v161
  v_exp_f32 v162, v162
  v_exp_f32 v163, v163
  v_exp_f32 v164, v164
  v_exp_f32 v165, v165
  v_mfma_f32_32x32x16_bf16 v[146:161], v[80:83], v[124:127], 0
  buffer_load_dword v15, v14, s[12:15], s94 offen sc1
  v_exp_f32 v166, v166
  v_exp_f32 v167, v167
  v_exp_f32 v168, v168
  v_exp_f32 v169, v169
  v_cvt_pk_bf16_f32 v218, v162, v163
  v_cvt_pk_bf16_f32 v219, v164, v165
  v_mfma_f32_32x32x16_bf16 v[146:161], v[84:87], v[136:139], v[146:161]
  global_load_dword v249, v245, s[30:31]
  v_exp_f32 v170, v170
  v_exp_f32 v171, v171
  v_exp_f32 v172, v172
  v_exp_f32 v173, v173
  v_cvt_pk_bf16_f32 v220, v166, v167
  v_cvt_pk_bf16_f32 v221, v168, v169
  s_add_u32 m0, s95, 32768
  s_waitcnt vmcnt(18)
  v_mfma_f32_32x32x16_bf16 v[32:47], a[20:23], v[214:217], v[32:47]
  buffer_load_dwordx4 v226, s[4:7], s51 offen offset:0 lds
  v_exp_f32 v174, v174
  v_exp_f32 v175, v175
  v_exp_f32 v176, v176
  v_exp_f32 v177, v177
  v_cvt_pk_bf16_f32 v222, v170, v171
  v_cvt_pk_bf16_f32 v223, v172, v173
  v_mfma_f32_32x32x16_bf16 v[48:63], a[16:19], v[218:221], v[48:63]
  buffer_load_dwordx4 v227, s[4:7], s51 offen offset:1024 lds
  v_cvt_pk_bf16_f32 v224, v174, v175
  v_cvt_pk_bf16_f32 v225, v176, v177
  v_exp_f32 v146, v146
  v_exp_f32 v147, v147
  v_exp_f32 v148, v148
  v_exp_f32 v149, v149
  v_mfma_f32_32x32x16_bf16 v[162:177], v[80:83], v[128:131], 0
  buffer_load_dwordx4 v228, s[4:7], s51 offen offset:2048 lds
  v_exp_f32 v150, v150
  v_exp_f32 v151, v151
  v_exp_f32 v152, v152
  v_exp_f32 v153, v153
  v_cvt_pk_bf16_f32 v210, v146, v147
  v_cvt_pk_bf16_f32 v211, v148, v149
  v_mfma_f32_32x32x16_bf16 v[162:177], v[84:87], v[140:143], v[162:177]
  buffer_store_dwordx4 v[16:19], v2, s[12:15], s79 offen offset:0 sc1
  v_exp_f32 v154, v154
  v_exp_f32 v155, v155
  v_exp_f32 v156, v156
  v_exp_f32 v157, v157
  v_cvt_pk_bf16_f32 v212, v150, v151
  v_cvt_pk_bf16_f32 v213, v152, v153
  v_mfma_f32_32x32x16_bf16 v[48:63], a[20:23], v[222:225], v[48:63]
  v_exp_f32 v158, v158
  v_exp_f32 v159, v159
  v_exp_f32 v160, v160
  v_exp_f32 v161, v161
  v_cvt_pk_bf16_f32 v214, v154, v155
  v_cvt_pk_bf16_f32 v215, v156, v157
  s_waitcnt vmcnt(21)
  v_mfma_f32_32x32x16_bf16 v[32:47], a[24:27], v[210:213], v[32:47]
  buffer_store_dwordx4 v[16:19], v2, s[12:15], s79 offen offset:1024 sc1
  v_cvt_pk_bf16_f32 v216, v158, v159
  v_cvt_pk_bf16_f32 v217, v160, v161
  s_waitcnt vmcnt(19)
  v_swap_b32 v114, v116
  v_swap_b32 v115, v117
  v_exp_f32 v162, v162
  v_exp_f32 v163, v163
  v_exp_f32 v164, v164
  v_exp_f32 v165, v165
  v_mfma_f32_32x32x16_bf16 v[146:161], v[112:115], v[124:127], v[194:209]
  v_exp_f32 v166, v166
  v_exp_f32 v167, v167
  v_exp_f32 v168, v168
  v_exp_f32 v169, v169
  v_cvt_pk_bf16_f32 v218, v162, v163
  v_cvt_pk_bf16_f32 v219, v164, v165
  s_waitcnt vmcnt(18)
  v_mfma_f32_32x32x16_bf16 v[146:161], v[120:123], v[138:141], v[146:161]
  buffer_store_dwordx2 v[16:17], v20, s[12:15], s79 offen offset:2048 sc1
  v_exp_f32 v170, v170
  v_exp_f32 v171, v171
  v_exp_f32 v172, v172
  v_exp_f32 v173, v173
  v_cvt_pk_bf16_f32 v220, v166, v167
  v_cvt_pk_bf16_f32 v221, v168, v169
  v_mfma_f32_32x32x16_bf16 v[32:47], a[28:31], v[214:217], v[32:47]
  v_exp_f32 v174, v174
  v_exp_f32 v175, v175
  v_exp_f32 v176, v176
  v_exp_f32 v177, v177
  v_cvt_pk_bf16_f32 v222, v170, v171
  v_cvt_pk_bf16_f32 v223, v172, v173
  v_mfma_f32_32x32x16_bf16 v[48:63], a[24:27], v[218:221], v[48:63]
  v_cvt_pk_bf16_f32 v224, v174, v175
  v_cvt_pk_bf16_f32 v225, v176, v177
  v_exp_f32 v146, v146
  v_exp_f32 v147, v147
  v_exp_f32 v148, v148
  v_exp_f32 v149, v149
  v_mfma_f32_32x32x16_bf16 v[162:177], v[112:115], v[128:131], 0
  v_exp_f32 v150, v150
  v_exp_f32 v151, v151
  v_exp_f32 v152, v152
  v_exp_f32 v153, v153
  v_cvt_pk_bf16_f32 v210, v146, v147
  v_cvt_pk_bf16_f32 v211, v148, v149
  v_mfma_f32_32x32x16_bf16 v[162:177], v[120:123], v[142:145], v[162:177]
  v_exp_f32 v154, v154
  v_exp_f32 v155, v155
  v_exp_f32 v156, v156
  v_exp_f32 v157, v157
  v_cvt_pk_bf16_f32 v212, v150, v151
  v_cvt_pk_bf16_f32 v213, v152, v153
  v_mfma_f32_32x32x16_bf16 v[48:63], a[28:31], v[222:225], v[48:63]
  v_exp_f32 v158, v158
  v_exp_f32 v159, v159
  v_exp_f32 v160, v160
  v_exp_f32 v161, v161
  v_cvt_pk_bf16_f32 v214, v154, v155
  v_cvt_pk_bf16_f32 v215, v156, v157
  s_waitcnt vmcnt(18)
  v_mfma_f32_32x32x16_bf16 v[32:47], a[64:67], v[210:213], v[32:47]
  v_subrev_u32 v253, s37, v6
  v_cmp_le_u32 vcc, 16, v253
  s_nop 3
  s_cbranch_vccnz Lfs_49
Lfb_50:
  s_add_u32 s49, s37, s87
  v_cmp_ne_u32 vcc, s49, v6
  s_nop 0
  s_andn2_b64 vcc, vcc, s[44:45]
  s_cselect_b32 s86, 0, 1
  v_cvt_pk_bf16_f32 v216, v158, v159
  v_cvt_pk_bf16_f32 v217, v160, v161
  v_exp_f32 v162, v162
  v_exp_f32 v163, v163
  v_exp_f32 v164, v164
  v_exp_f32 v165, v165
  s_add_u32 m0, s95, 0
  v_add_u32 v251, s91, v2
  v_mfma_f32_32x32x16_bf16 v[146:161], v[116:119], v[128:131], v[194:209]
  global_load_lds_dwordx4 v251, s[12:13] offset:0 sc1
  v_exp_f32 v166, v166
  v_exp_f32 v167, v167
  v_exp_f32 v168, v168
  v_exp_f32 v169, v169
  v_cvt_pk_bf16_f32 v218, v162, v163
  v_cvt_pk_bf16_f32 v219, v164, v165
  v_mfma_f32_32x32x16_bf16 v[146:161], v[120:123], v[140:143], v[146:161]
  global_load_lds_dwordx4 v251, s[12:13] offset:1024 sc1
  v_exp_f32 v170, v170
  v_exp_f32 v171, v171
  v_exp_f32 v172, v172
  v_exp_f32 v173, v173
  v_cvt_pk_bf16_f32 v220, v166, v167
  v_cvt_pk_bf16_f32 v221, v168, v169
  s_waitcnt vmcnt(19)
  v_mfma_f32_32x32x16_bf16 v[32:47], a[68:71], v[214:217], v[32:47]
  global_load_lds_dwordx4 v251, s[12:13] offset:2048 sc1
  v_exp_f32 v174, v174
  v_exp_f32 v175, v175
  v_exp_f32 v176, v176
  v_exp_f32 v177, v177
  v_cvt_pk_bf16_f32 v222, v170, v171
  v_cvt_pk_bf16_f32 v223, v172, v173
  v_mfma_f32_32x32x16_bf16 v[48:63], a[64:67], v[218:221], v[48:63]
  global_load_lds_dwordx4 v251, s[12:13] offset:3072 sc1
  v_cvt_pk_bf16_f32 v224, v174, v175
  v_cvt_pk_bf16_f32 v225, v176, v177
  s_waitcnt vmcnt(17)
  v_swap_b32 v66, v68
  v_swap_b32 v67, v69
  v_exp_f32 v146, v146
  v_exp_f32 v147, v147
  v_exp_f32 v148, v148
  v_exp_f32 v149, v149
  s_add_u32 m0, s95, 4096
  v_add_u32 v251, 4096, v251
  v_mfma_f32_32x32x16_bf16 v[162:177], v[64:67], v[124:127], v[178:193]
  global_load_lds_dwordx4 v251, s[12:13] offset:0 sc1
  v_exp_f32 v150, v150
  v_exp_f32 v151, v151
  v_exp_f32 v152, v152
  v_exp_f32 v153, v153
  v_cvt_pk_bf16_f32 v210, v146, v147
  v_cvt_pk_bf16_f32 v211, v148, v149
  s_waitcnt vmcnt(17)
  v_mfma_f32_32x32x16_bf16 v[162:177], v[72:75], v[138:141], v[162:177]
  global_load_lds_dwordx4 v251, s[12:13] offset:1024 sc1
  v_exp_f32 v154, v154
  v_exp_f32 v155, v155
  v_exp_f32 v156, v156
  v_exp_f32 v157, v157
  v_cvt_pk_bf16_f32 v212, v150, v151
  v_cvt_pk_bf16_f32 v213, v152, v153
  v_mfma_f32_32x32x16_bf16 v[48:63], a[68:71], v[222:225], v[48:63]
  global_load_lds_dwordx4 v251, s[12:13] offset:2048 sc1
  v_exp_f32 v158, v158
  v_exp_f32 v159, v159
  v_exp_f32 v160, v160
  v_exp_f32 v161, v161
  v_cvt_pk_bf16_f32 v214, v154, v155
  v_cvt_pk_bf16_f32 v215, v156, v157
  v_mfma_f32_32x32x16_bf16 v[48:63], a[72:75], v[210:213], v[48:63]
  global_load_lds_dwordx4 v251, s[12:13] offset:3072 sc1
  v_cvt_pk_bf16_f32 v216, v158, v159
  v_cvt_pk_bf16_f32 v217, v160, v161
  v_exp_f32 v162, v162
  v_exp_f32 v163, v163
  v_exp_f32 v164, v164
  v_exp_f32 v165, v165
  s_add_u32 m0, s95, 8192
  v_add_u32 v251, 4096, v251
  v_mfma_f32_32x32x16_bf16 v[146:161], v[68:71], v[124:127], 0
  global_load_lds_dwordx4 v251, s[12:13] offset:0 sc1
  v_exp_f32 v166, v166
  v_exp_f32 v167, v167
  v_exp_f32 v168, v168
  v_exp_f32 v169, v169
  v_cvt_pk_bf16_f32 v218, v162, v163
  v_cvt_pk_bf16_f32 v219, v164, v165
  v_mfma_f32_32x32x16_bf16 v[146:161], v[72:75], v[136:139], v[146:161]
  global_load_lds_dwordx4 v251, s[12:13] offset:1024 sc1
  v_exp_f32 v170, v170
  v_exp_f32 v171, v171
  v_exp_f32 v172, v172
  v_exp_f32 v173, v173
  v_cvt_pk_bf16_f32 v220, v166, v167
  v_cvt_pk_bf16_f32 v221, v168, v169
  v_mfma_f32_32x32x16_bf16 v[48:63], a[76:79], v[214:217], v[48:63]
  global_load_lds_dwordx4 v251, s[12:13] offset:2048 sc1
  v_exp_f32 v174, v174
  v_exp_f32 v175, v175
  v_exp_f32 v176, v176
  v_exp_f32 v177, v177
  v_cvt_pk_bf16_f32 v222, v170, v171
  v_cvt_pk_bf16_f32 v223, v172, v173
  s_waitcnt vmcnt(22)
  v_mfma_f32_32x32x16_bf16 v[32:47], a[0:3], v[218:221], v[32:47]
  global_load_lds_dwordx4 v251, s[12:13] offset:3072 sc1
  v_cvt_pk_bf16_f32 v224, v174, v175
  v_cvt_pk_bf16_f32 v225, v176, v177
  v_exp_f32 v146, v146
  v_exp_f32 v147, v147
  v_exp_f32 v148, v148
  v_exp_f32 v149, v149
  s_add_u32 m0, s95, 12288
  v_add_u32 v251, 4096, v251
  v_mfma_f32_32x32x16_bf16 v[162:177], v[68:71], v[128:131], v[178:193]
  global_load_lds_dwordx4 v251, s[12:13] offset:0 sc1
  v_exp_f32 v150, v150
  v_exp_f32 v151, v151
  v_exp_f32 v152, v152
  v_exp_f32 v153, v153
  v_cvt_pk_bf16_f32 v210, v146, v147
  v_cvt_pk_bf16_f32 v211, v148, v149
  v_mfma_f32_32x32x16_bf16 v[162:177], v[72:75], v[140:143], v[162:177]
  global_load_lds_dwordx4 v251, s[12:13] offset:1024 sc1
  v_exp_f32 v154, v154
  v_exp_f32 v155, v155
  v_exp_f32 v156, v156
  v_exp_f32 v157, v157
  v_cvt_pk_bf16_f32 v212, v150, v151
  v_cvt_pk_bf16_f32 v213, v152, v153
  s_waitcnt vmcnt(24)
  v_mfma_f32_32x32x16_bf16 v[32:47], a[4:7], v[222:225], v[32:47]
  v_exp_f32 v158, v158
  v_exp_f32 v159, v159
  v_exp_f32 v160, v160
  v_exp_f32 v161, v161
  v_cvt_pk_bf16_f32 v214, v154, v155
  v_cvt_pk_bf16_f32 v215, v156, v157
  s_waitcnt vmcnt(23)
  v_mfma_f32_32x32x16_bf16 v[32:47], a[8:11], v[210:213], v[32:47]
  v_cvt_pk_bf16_f32 v216, v158, v159
  v_cvt_pk_bf16_f32 v217, v160, v161
  v_exp_f32 v162, v162
  v_exp_f32 v163, v163
  v_exp_f32 v164, v164
  v_exp_f32 v165, v165
  v_exp_f32 v166, v166
  v_exp_f32 v167, v167
  v_exp_f32 v168, v168
  v_exp_f32 v169, v169
  v_cvt_pk_bf16_f32 v218, v162, v163
  v_cvt_pk_bf16_f32 v219, v164, v165
  v_exp_f32 v170, v170
  v_exp_f32 v171, v171
  v_exp_f32 v172, v172
  v_exp_f32 v173, v173
  v_cvt_pk_bf16_f32 v220, v166, v167
  v_cvt_pk_bf16_f32 v221, v168, v169
  s_waitcnt vmcnt(22)
  v_mfma_f32_32x32x16_bf16 v[32:47], a[12:15], v[214:217], v[32:47]
  v_exp_f32 v174, v174
  v_exp_f32 v175, v175
  v_exp_f32 v176, v176
  v_exp_f32 v177, v177
  v_cvt_pk_bf16_f32 v222, v170, v171
  v_cvt_pk_bf16_f32 v223, v172, v173
  v_mfma_f32_32x32x16_bf16 v[48:63], a[8:11], v[218:221], v[48:63]
  v_cvt_pk_bf16_f32 v224, v174, v175
  v_cvt_pk_bf16_f32 v225, v176, v177
  s_nop 1
  v_mfma_f32_32x32x16_bf16 v[48:63], a[12:15], v[222:225], v[48:63]
  s_nop 10
  s_branch Lattn_done
Lav_43:
  s_mov_b32 s18, s69
  s_barrier
  buffer_load_dwordx4 v[124:127], v2, s[12:15], s53 offen sc1
  buffer_load_dwordx4 v[128:131], v2, s[12:15], s53 offen offset:1024 sc1
  buffer_load_dwordx4 v[76:79], v2, s[16:19], s67 offen sc1
  buffer_load_dwordx4 v[80:83], v2, s[16:19], s67 offen offset:1024 sc1
  buffer_load_dwordx4 v[132:135], v3, s[12:15], s53 offen offset:2048 sc1
  buffer_load_dwordx4 v[84:87], v3, s[16:19], s67 offen offset:2048 sc1
  s_mov_b64 exec, s[88:89]
  buffer_load_dwordx4 a[16:19], v4, s[16:19], s68 offen sc1
  s_mov_b64 exec, -1
  s_mov_b64 exec, s[88:89]
  buffer_load_dwordx4 a[20:23], v9, s[16:19], s68 offen sc1
  s_mov_b64 exec, -1
  s_mov_b64 exec, s[88:89]
  buffer_load_dwordx4 a[24:27], v10, s[16:19], s68 offen sc1
  s_mov_b64 exec, -1
  s_mov_b64 exec, s[88:89]
  buffer_load_dwordx4 a[28:31], v11, s[16:19], s68 offen sc1
  s_mov_b64 exec, -1
  s_mov_b32 s18, s72
  buffer_load_dwordx4 v[88:91], v2, s[16:19], s70 offen sc1
  buffer_load_dwordx4 v[92:95], v2, s[16:19], s70 offen offset:1024 sc1
  buffer_load_dwordx4 v[96:99], v3, s[16:19], s70 offen offset:2048 sc1
  s_waitcnt vmcnt(11)
  v_swap_b32 v126, v128
  v_swap_b32 v127, v129
  s_waitcnt vmcnt(8)
  v_cndmask_b32 v138, v132, 0, s[44:45]
  v_cndmask_b32 v139, v133, 0, s[44:45]
  v_cndmask_b32 v142, v134, 0, s[44:45]
  v_cndmask_b32 v143, v135, 0, s[44:45]
  v_swap_b32 v78, v80
  v_swap_b32 v79, v81
  s_nop 1
  v_mfma_f32_32x32x16_bf16 v[146:161], v[76:79], v[124:127], 0
  s_waitcnt vmcnt(7)
  v_mfma_f32_32x32x16_bf16 v[146:161], v[84:87], v[138:141], v[146:161]
  s_mov_b64 exec, s[88:89]
  buffer_load_dwordx4 a[32:35], v4, s[16:19], s71 offen sc1
  s_mov_b64 exec, -1
  s_mov_b64 exec, s[88:89]
  buffer_load_dwordx4 a[36:39], v9, s[16:19], s71 offen sc1
  s_mov_b64 exec, -1
  s_nop 5
  v_exp_f32 v146, v146
  v_exp_f32 v147, v147
  v_exp_f32 v148, v148
  v_exp_f32 v149, v149
  s_mov_b64 exec, s[88:89]
  v_mfma_f32_32x32x16_bf16 v[162:177], v[76:79], v[128:131], 0
  buffer_load_dwordx4 a[40:43], v10, s[16:19], s71 offen sc1
  s_mov_b64 exec, -1
  v_exp_f32 v150, v150
  v_exp_f32 v151, v151
  v_exp_f32 v152, v152
  v_exp_f32 v153, v153
  v_cvt_pk_bf16_f32 v210, v146, v147
  v_cvt_pk_bf16_f32 v211, v148, v149
  s_mov_b64 exec, s[88:89]
  v_mfma_f32_32x32x16_bf16 v[162:177], v[84:87], v[142:145], v[162:177]
  buffer_load_dwordx4 a[44:47], v11, s[16:19], s71 offen sc1
  s_mov_b64 exec, -1
  v_exp_f32 v154, v154
  v_exp_f32 v155, v155
  v_exp_f32 v156, v156
  v_exp_f32 v157, v157
  v_cvt_pk_bf16_f32 v212, v150, v151
  v_cvt_pk_bf16_f32 v213, v152, v153
  v_exp_f32 v158, v158
  v_exp_f32 v159, v159
  v_exp_f32 v160, v160
  v_exp_f32 v161, v161
  v_cvt_pk_bf16_f32 v214, v154, v155
  v_cvt_pk_bf16_f32 v215, v156, v157
  s_waitcnt vmcnt(10)
  v_mfma_f32_32x32x16_bf16 v[32:47], a[16:19], v[210:213], 0
  v_cvt_pk_bf16_f32 v216, v158, v159
  v_cvt_pk_bf16_f32 v217, v160, v161
  v_exp_f32 v162, v162
  v_exp_f32 v163, v163
  v_exp_f32 v164, v164
  v_exp_f32 v165, v165
  s_mov_b32 s18, s75
  v_mfma_f32_32x32x16_bf16 v[146:161], v[80:83], v[124:127], 0
  buffer_load_dwordx4 v[100:103], v2, s[16:19], s73 offen sc1
  v_exp_f32 v166, v166
  v_exp_f32 v167, v167
  v_exp_f32 v168, v168
  v_exp_f32 v169, v169
  v_cvt_pk_bf16_f32 v218, v162, v163
  v_cvt_pk_bf16_f32 v219, v164, v165
  v_mfma_f32_32x32x16_bf16 v[146:161], v[84:87], v[136:139], v[146:161]
  buffer_load_dwordx4 v[104:107], v2, s[16:19], s73 offen offset:1024 sc1
  v_exp_f32 v170, v170
  v_exp_f32 v171, v171
  v_exp_f32 v172, v172
  v_exp_f32 v173, v173
  v_cvt_pk_bf16_f32 v220, v166, v167
  v_cvt_pk_bf16_f32 v221, v168, v169
  s_waitcnt vmcnt(11)
  v_mfma_f32_32x32x16_bf16 v[32:47], a[20:23], v[214:217], v[32:47]
  v_exp_f32 v174, v174
  v_exp_f32 v175, v175
  v_exp_f32 v176, v176
  v_exp_f32 v177, v177
  v_cvt_pk_bf16_f32 v222, v170, v171
  v_cvt_pk_bf16_f32 v223, v172, v173
  v_mfma_f32_32x32x16_bf16 v[48:63], a[16:19], v[218:221], 0
  buffer_load_dwordx4 v[108:111], v3, s[16:19], s73 offen offset:2048 sc1
  v_cvt_pk_bf16_f32 v224, v174, v175
  v_cvt_pk_bf16_f32 v225, v176, v177
  v_exp_f32 v146, v146
  v_exp_f32 v147, v147
  v_exp_f32 v148, v148
  v_exp_f32 v149, v149
  s_mov_b64 exec, s[88:89]
  v_mfma_f32_32x32x16_bf16 v[162:177], v[80:83], v[128:131], 0
  buffer_load_dwordx4 a[48:51], v4, s[16:19], s74 offen sc1
  s_mov_b64 exec, -1
  v_exp_f32 v150, v150
  v_exp_f32 v151, v151
  v_exp_f32 v152, v152
  v_exp_f32 v153, v153
  v_cvt_pk_bf16_f32 v210, v146, v147
  v_cvt_pk_bf16_f32 v211, v148, v149
  v_mfma_f32_32x32x16_bf16 v[162:177], v[84:87], v[140:143], v[162:177]
  buffer_load_dword v6, v5, s[12:15], s94 offen sc1
  v_exp_f32 v154, v154
  v_exp_f32 v155, v155
  v_exp_f32 v156, v156
  v_exp_f32 v157, v157
  v_cvt_pk_bf16_f32 v212, v150, v151
  v_cvt_pk_bf16_f32 v213, v152, v153
  s_mov_b64 exec, s[88:89]
  v_mfma_f32_32x32x16_bf16 v[48:63], a[20:23], v[222:225], v[48:63]
  buffer_load_dwordx4 a[52:55], v9, s[16:19], s74 offen sc1
  s_mov_b64 exec, -1
  v_exp_f32 v158, v158
  v_exp_f32 v159, v159
  v_exp_f32 v160, v160
  v_exp_f32 v161, v161
  v_cvt_pk_bf16_f32 v214, v154, v155
  v_cvt_pk_bf16_f32 v215, v156, v157
  s_mov_b64 exec, s[88:89]
  s_waitcnt vmcnt(14)
  v_mfma_f32_32x32x16_bf16 v[32:47], a[24:27], v[210:213], v[32:47]
  buffer_load_dwordx4 a[56:59], v10, s[16:19], s74 offen sc1
  s_mov_b64 exec, -1
  v_cvt_pk_bf16_f32 v216, v158, v159
  v_cvt_pk_bf16_f32 v217, v160, v161
  s_waitcnt vmcnt(12)
  v_swap_b32 v90, v92
  v_swap_b32 v91, v93
  v_exp_f32 v162, v162
  v_exp_f32 v163, v163
  v_exp_f32 v164, v164
  v_exp_f32 v165, v165
  v_mfma_f32_32x32x16_bf16 v[146:161], v[88:91], v[124:127], 0
  v_exp_f32 v166, v166
  v_exp_f32 v167, v167
  v_exp_f32 v168, v168
  v_exp_f32 v169, v169
  v_cvt_pk_bf16_f32 v218, v162, v163
  v_cvt_pk_bf16_f32 v219, v164, v165
  s_mov_b64 exec, s[88:89]
  s_waitcnt vmcnt(11)
  v_mfma_f32_32x32x16_bf16 v[146:161], v[96:99], v[138:141], v[146:161]
  buffer_load_dwordx4 a[60:63], v11, s[16:19], s74 offen sc1
  s_mov_b64 exec, -1
  v_exp_f32 v170, v170
  v_exp_f32 v171, v171
  v_exp_f32 v172, v172
  v_exp_f32 v173, v173
  v_cvt_pk_bf16_f32 v220, v166, v167
  v_cvt_pk_bf16_f32 v221, v168, v169
  s_mov_b32 s18, s66
  v_mfma_f32_32x32x16_bf16 v[32:47], a[28:31], v[214:217], v[32:47]
  buffer_load_dwordx4 v[64:67], v2, s[16:19], s64 offen sc1
  v_exp_f32 v174, v174
  v_exp_f32 v175, v175
  v_exp_f32 v176, v176
  v_exp_f32 v177, v177
  v_cvt_pk_bf16_f32 v222, v170, v171
  v_cvt_pk_bf16_f32 v223, v172, v173
  v_mfma_f32_32x32x16_bf16 v[48:63], a[24:27], v[218:221], v[48:63]
  v_cvt_pk_bf16_f32 v224, v174, v175
  v_cvt_pk_bf16_f32 v225, v176, v177
  v_exp_f32 v146, v146
  v_exp_f32 v147, v147
  v_exp_f32 v148, v148
  v_exp_f32 v149, v149
  v_mfma_f32_32x32x16_bf16 v[162:177], v[88:91], v[128:131], 0
  buffer_load_dwordx4 v[68:71], v2, s[16:19], s64 offen offset:1024 sc1
  v_exp_f32 v150, v150
  v_exp_f32 v151, v151
  v_exp_f32 v152, v152
  v_exp_f32 v153, v153
  v_cvt_pk_bf16_f32 v210, v146, v147
  v_cvt_pk_bf16_f32 v211, v148, v149
  v_mfma_f32_32x32x16_bf16 v[162:177], v[96:99], v[142:145], v[162:177]
  buffer_load_dwordx4 v[72:75], v3, s[16:19], s64 offen offset:2048 sc1
  v_exp_f32 v154, v154
  v_exp_f32 v155, v155
  v_exp_f32 v156, v156
  v_exp_f32 v157, v157
  v_cvt_pk_bf16_f32 v212, v150, v151
  v_cvt_pk_bf16_f32 v213, v152, v153
  v_mfma_f32_32x32x16_bf16 v[48:63], a[28:31], v[222:225], v[48:63]
  v_exp_f32 v158, v158
  v_exp_f32 v159, v159
  v_exp_f32 v160, v160
  v_exp_f32 v161, v161
  v_cvt_pk_bf16_f32 v214, v154, v155
  v_cvt_pk_bf16_f32 v215, v156, v157
  s_mov_b64 exec, s[88:89]
  s_waitcnt vmcnt(14)
  v_mfma_f32_32x32x16_bf16 v[32:47], a[32:35], v[210:213], v[32:47]
  buffer_load_dwordx4 a[0:3], v4, s[16:19], s65 offen sc1
  s_mov_b64 exec, -1
  v_cvt_pk_bf16_f32 v216, v158, v159
  v_cvt_pk_bf16_f32 v217, v160, v161
  v_exp_f32 v162, v162
  v_exp_f32 v163, v163
  v_exp_f32 v164, v164
  v_exp_f32 v165, v165
  s_mov_b64 exec, s[88:89]
  v_mfma_f32_32x32x16_bf16 v[146:161], v[92:95], v[124:127], 0
  buffer_load_dwordx4 a[4:7], v9, s[16:19], s65 offen sc1
  s_mov_b64 exec, -1
  v_exp_f32 v166, v166
  v_exp_f32 v167, v167
  v_exp_f32 v168, v168
  v_exp_f32 v169, v169
  v_cvt_pk_bf16_f32 v218, v162, v163
  v_cvt_pk_bf16_f32 v219, v164, v165
  v_mfma_f32_32x32x16_bf16 v[146:161], v[96:99], v[136:139], v[146:161]
  v_exp_f32 v170, v170
  v_exp_f32 v171, v171
  v_exp_f32 v172, v172
  v_exp_f32 v173, v173
  v_cvt_pk_bf16_f32 v220, v166, v167
  v_cvt_pk_bf16_f32 v221, v168, v169
  s_mov_b64 exec, s[88:89]
  s_waitcnt vmcnt(15)
  v_mfma_f32_32x32x16_bf16 v[32:47], a[36:39], v[214:217], v[32:47]
  buffer_load_dwordx4 a[8:11], v10, s[16:19], s65 offen sc1
  s_mov_b64 exec, -1
  v_exp_f32 v174, v174
  v_exp_f32 v175, v175
  v_exp_f32 v176, v176
  v_exp_f32 v177, v177
  v_cvt_pk_bf16_f32 v222, v170, v171
  v_cvt_pk_bf16_f32 v223, v172, v173
  s_mov_b64 exec, s[88:89]
  v_mfma_f32_32x32x16_bf16 v[48:63], a[32:35], v[218:221], v[48:63]
  buffer_load_dwordx4 a[12:15], v11, s[16:19], s65 offen sc1
  s_mov_b64 exec, -1
  v_cvt_pk_bf16_f32 v224, v174, v175
  v_cvt_pk_bf16_f32 v225, v176, v177
  v_exp_f32 v146, v146
  v_exp_f32 v147, v147
  v_exp_f32 v148, v148
  v_exp_f32 v149, v149
  v_mfma_f32_32x32x16_bf16 v[162:177], v[92:95], v[128:131], 0
  v_exp_f32 v150, v150
  v_exp_f32 v151, v151
  v_exp_f32 v152, v152
  v_exp_f32 v153, v153
  v_cvt_pk_bf16_f32 v210, v146, v147
  v_cvt_pk_bf16_f32 v211, v148, v149
  s_mov_b32 s18, s78
  v_mfma_f32_32x32x16_bf16 v[162:177], v[96:99], v[140:143], v[162:177]
  buffer_load_dwordx4 v[112:115], v2, s[16:19], s76 offen sc1
  v_exp_f32 v154, v154
  v_exp_f32 v155, v155
  v_exp_f32 v156, v156
  v_exp_f32 v157, v157
  v_cvt_pk_bf16_f32 v212, v150, v151
  v_cvt_pk_bf16_f32 v213, v152, v153
  v_mfma_f32_32x32x16_bf16 v[48:63], a[36:39], v[222:225], v[48:63]
  buffer_load_dwordx4 v[116:119], v2, s[16:19], s76 offen offset:1024 sc1
  v_exp_f32 v158, v158
  v_exp_f32 v159, v159
  v_exp_f32 v160, v160
  v_exp_f32 v161, v161
  v_cvt_pk_bf16_f32 v214, v154, v155
  v_cvt_pk_bf16_f32 v215, v156, v157
  s_waitcnt vmcnt(18)
  v_mfma_f32_32x32x16_bf16 v[32:47], a[40:43], v[210:213], v[32:47]
  v_cvt_pk_bf16_f32 v216, v158, v159
  v_cvt_pk_bf16_f32 v217, v160, v161
  s_waitcnt vmcnt(15)
  v_swap_b32 v102, v104
  v_swap_b32 v103, v105
  v_exp_f32 v162, v162
  v_exp_f32 v163, v163
  v_exp_f32 v164, v164
  v_exp_f32 v165, v165
  v_mfma_f32_32x32x16_bf16 v[146:161], v[100:103], v[124:127], 0
  buffer_load_dwordx4 v[120:123], v3, s[16:19], s76 offen offset:2048 sc1
  v_exp_f32 v166, v166
  v_exp_f32 v167, v167
  v_exp_f32 v168, v168
  v_exp_f32 v169, v169
  v_cvt_pk_bf16_f32 v218, v162, v163
  v_cvt_pk_bf16_f32 v219, v164, v165
  s_mov_b64 exec, s[88:89]
  s_waitcnt vmcnt(15)
  v_mfma_f32_32x32x16_bf16 v[146:161], v[108:111], v[138:141], v[146:161]
  buffer_load_dwordx4 a[64:67], v4, s[16:19], s77 offen sc1
  s_mov_b64 exec, -1
  v_exp_f32 v170, v170
  v_exp_f32 v171, v171
  v_exp_f32 v172, v172
  v_exp_f32 v173, v173
  v_cvt_pk_bf16_f32 v220, v166, v167
  v_cvt_pk_bf16_f32 v221, v168, v169
  v_mfma_f32_32x32x16_bf16 v[32:47], a[44:47], v[214:217], v[32:47]
  v_exp_f32 v174, v174
  v_exp_f32 v175, v175
  v_exp_f32 v176, v176
  v_exp_f32 v177, v177
  v_cvt_pk_bf16_f32 v222, v170, v171
  v_cvt_pk_bf16_f32 v223, v172, v173
  s_mov_b64 exec, s[88:89]
  v_mfma_f32_32x32x16_bf16 v[48:63], a[40:43], v[218:221], v[48:63]
  buffer_load_dwordx4 a[68:71], v9, s[16:19], s77 offen sc1
  s_mov_b64 exec, -1
  v_cvt_pk_bf16_f32 v224, v174, v175
  v_cvt_pk_bf16_f32 v225, v176, v177
  v_exp_f32 v146, v146
  v_exp_f32 v147, v147
  v_exp_f32 v148, v148
  v_exp_f32 v149, v149
  s_mov_b64 exec, s[88:89]
  v_mfma_f32_32x32x16_bf16 v[162:177], v[100:103], v[128:131], 0
  buffer_load_dwordx4 a[72:75], v10, s[16:19], s77 offen sc1
  s_mov_b64 exec, -1
  v_exp_f32 v150, v150
  v_exp_f32 v151, v151
  v_exp_f32 v152, v152
  v_exp_f32 v153, v153
  v_cvt_pk_bf16_f32 v210, v146, v147
  v_cvt_pk_bf16_f32 v211, v148, v149
  v_mfma_f32_32x32x16_bf16 v[162:177], v[108:111], v[142:145], v[162:177]
  v_exp_f32 v154, v154
  v_exp_f32 v155, v155
  v_exp_f32 v156, v156
  v_exp_f32 v157, v157
  v_cvt_pk_bf16_f32 v212, v150, v151
  v_cvt_pk_bf16_f32 v213, v152, v153
  s_mov_b64 exec, s[88:89]
  v_mfma_f32_32x32x16_bf16 v[48:63], a[44:47], v[222:225], v[48:63]
  buffer_load_dwordx4 a[76:79], v11, s[16:19], s77 offen sc1
  s_mov_b64 exec, -1
  v_exp_f32 v158, v158
  v_exp_f32 v159, v159
  v_exp_f32 v160, v160
  v_exp_f32 v161, v161
  v_cvt_pk_bf16_f32 v214, v154, v155
  v_cvt_pk_bf16_f32 v215, v156, v157
  s_waitcnt vmcnt(18)
  v_mfma_f32_32x32x16_bf16 v[32:47], a[48:51], v[210:213], v[32:47]
  v_cvt_pk_bf16_f32 v216, v158, v159
  v_cvt_pk_bf16_f32 v217, v160, v161
  v_exp_f32 v162, v162
  v_exp_f32 v163, v163
  v_exp_f32 v164, v164
  v_exp_f32 v165, v165
  v_mfma_f32_32x32x16_bf16 v[146:161], v[104:107], v[124:127], 0
  buffer_load_dword v15, v14, s[12:15], s94 offen sc1
  v_exp_f32 v166, v166
  v_exp_f32 v167, v167
  v_exp_f32 v168, v168
  v_exp_f32 v169, v169
  v_cvt_pk_bf16_f32 v218, v162, v163
  v_cvt_pk_bf16_f32 v219, v164, v165
  v_mfma_f32_32x32x16_bf16 v[146:161], v[108:111], v[136:139], v[146:161]
  global_load_dword v249, v245, s[30:31]
  v_exp_f32 v170, v170
  v_exp_f32 v171, v171
  v_exp_f32 v172, v172
  v_exp_f32 v173, v173
  v_cvt_pk_bf16_f32 v220, v166, v167
  v_cvt_pk_bf16_f32 v221, v168, v169
  s_add_u32 m0, s95, 32768
  s_waitcnt vmcnt(18)
  v_mfma_f32_32x32x16_bf16 v[32:47], a[52:55], v[214:217], v[32:47]
  buffer_load_dwordx4 v226, s[4:7], s51 offen offset:0 lds
  v_exp_f32 v174, v174
  v_exp_f32 v175, v175
  v_exp_f32 v176, v176
  v_exp_f32 v177, v177
  v_cvt_pk_bf16_f32 v222, v170, v171
  v_cvt_pk_bf16_f32 v223, v172, v173
  v_mfma_f32_32x32x16_bf16 v[48:63], a[48:51], v[218:221], v[48:63]
  buffer_load_dwordx4 v227, s[4:7], s51 offen offset:1024 lds
  v_cvt_pk_bf16_f32 v224, v174, v175
  v_cvt_pk_bf16_f32 v225, v176, v177
  v_exp_f32 v146, v146
  v_exp_f32 v147, v147
  v_exp_f32 v148, v148
  v_exp_f32 v149, v149
  v_mfma_f32_32x32x16_bf16 v[162:177], v[104:107], v[128:131], 0
  buffer_load_dwordx4 v228, s[4:7], s51 offen offset:2048 lds
  v_exp_f32 v150, v150
  v_exp_f32 v151, v151
  v_exp_f32 v152, v152
  v_exp_f32 v153, v153
  v_cvt_pk_bf16_f32 v210, v146, v147
  v_cvt_pk_bf16_f32 v211, v148, v149
  v_mfma_f32_32x32x16_bf16 v[162:177], v[108:111], v[140:143], v[162:177]
  buffer_store_dwordx4 v[16:19], v2, s[12:15], s79 offen offset:0 sc1
  v_exp_f32 v154, v154
  v_exp_f32 v155, v155
  v_exp_f32 v156, v156
  v_exp_f32 v157, v157
  v_cvt_pk_bf16_f32 v212, v150, v151
  v_cvt_pk_bf16_f32 v213, v152, v153
  v_mfma_f32_32x32x16_bf16 v[48:63], a[52:55], v[222:225], v[48:63]
  v_exp_f32 v158, v158
  v_exp_f32 v159, v159
  v_exp_f32 v160, v160
  v_exp_f32 v161, v161
  v_cvt_pk_bf16_f32 v214, v154, v155
  v_cvt_pk_bf16_f32 v215, v156, v157
  s_waitcnt vmcnt(21)
  v_mfma_f32_32x32x16_bf16 v[32:47], a[56:59], v[210:213], v[32:47]
  buffer_store_dwordx4 v[16:19], v2, s[12:15], s79 offen offset:1024 sc1
  v_cvt_pk_bf16_f32 v216, v158, v159
  v_cvt_pk_bf16_f32 v217, v160, v161
  s_waitcnt vmcnt(19)
  v_swap_b32 v66, v68
  v_swap_b32 v67, v69
  v_exp_f32 v162, v162
  v_exp_f32 v163, v163
  v_exp_f32 v164, v164
  v_exp_f32 v165, v165
  v_mfma_f32_32x32x16_bf16 v[146:161], v[64:67], v[124:127], v[178:193]
  v_exp_f32 v166, v166
  v_exp_f32 v167, v167
  v_exp_f32 v168, v168
  v_exp_f32 v169, v169
  v_cvt_pk_bf16_f32 v218, v162, v163
  v_cvt_pk_bf16_f32 v219, v164, v165
  s_waitcnt vmcnt(18)
  v_mfma_f32_32x32x16_bf16 v[146:161], v[72:75], v[138:141], v[146:161]
  buffer_store_dwordx2 v[16:17], v20, s[12:15], s79 offen offset:2048 sc1
  v_exp_f32 v170, v170
  v_exp_f32 v171, v171
  v_exp_f32 v172, v172
  v_exp_f32 v173, v173
  v_cvt_pk_bf16_f32 v220, v166, v167
  v_cvt_pk_bf16_f32 v221, v168, v169
  v_mfma_f32_32x32x16_bf16 v[32:47], a[60:63], v[214:217], v[32:47]
  v_exp_f32 v174, v174
  v_exp_f32 v175, v175
  v_exp_f32 v176, v176
  v_exp_f32 v177, v177
  v_cvt_pk_bf16_f32 v222, v170, v171
  v_cvt_pk_bf16_f32 v223, v172, v173
  v_mfma_f32_32x32x16_bf16 v[48:63], a[56:59], v[218:221], v[48:63]
  v_cvt_pk_bf16_f32 v224, v174, v175
  v_cvt_pk_bf16_f32 v225, v176, v177
  v_exp_f32 v146, v146
  v_exp_f32 v147, v147
  v_exp_f32 v148, v148
  v_exp_f32 v149, v149
  v_mfma_f32_32x32x16_bf16 v[162:177], v[68:71], v[124:127], 0
  v_exp_f32 v150, v150
  v_exp_f32 v151, v151
  v_exp_f32 v152, v152
  v_exp_f32 v153, v153
  v_cvt_pk_bf16_f32 v210, v146, v147
  v_cvt_pk_bf16_f32 v211, v148, v149
  v_mfma_f32_32x32x16_bf16 v[162:177], v[72:75], v[136:139], v[162:177]
  v_exp_f32 v154, v154
  v_exp_f32 v155, v155
  v_exp_f32 v156, v156
  v_exp_f32 v157, v157
  v_cvt_pk_bf16_f32 v212, v150, v151
  v_cvt_pk_bf16_f32 v213, v152, v153
  v_mfma_f32_32x32x16_bf16 v[48:63], a[60:63], v[222:225], v[48:63]
  v_exp_f32 v158, v158
  v_exp_f32 v159, v159
  v_exp_f32 v160, v160
  v_exp_f32 v161, v161
  v_cvt_pk_bf16_f32 v214, v154, v155
  v_cvt_pk_bf16_f32 v215, v156, v157
  s_waitcnt vmcnt(18)
  v_mfma_f32_32x32x16_bf16 v[32:47], a[0:3], v[210:213], v[32:47]
  v_subrev_u32 v253, s37, v6
  v_cmp_le_u32 vcc, 16, v253
  s_nop 3
  s_cbranch_vccnz Lfs_53
Lfb_54:
  s_add_u32 s49, s37, s87
  v_cmp_ne_u32 vcc, s49, v6
  s_nop 0
  s_andn2_b64 vcc, vcc, s[44:45]
  s_cselect_b32 s86, 0, 1
  v_cvt_pk_bf16_f32 v216, v158, v159
  v_cvt_pk_bf16_f32 v217, v160, v161
  v_exp_f32 v162, v162
  v_exp_f32 v163, v163
  v_exp_f32 v164, v164
  v_exp_f32 v165, v165
  s_add_u32 m0, s95, 0
  v_add_u32 v251, s91, v2
  v_mfma_f32_32x32x16_bf16 v[146:161], v[68:71], v[128:131], v[178:193]
  global_load_lds_dwordx4 v251, s[12:13] offset:0 sc1
  v_exp_f32 v166, v166
  v_exp_f32 v167, v167
  v_exp_f32 v168, v168
  v_exp_f32 v169, v169
  v_cvt_pk_bf16_f32 v218, v162, v163
  v_cvt_pk_bf16_f32 v219, v164, v165
  v_mfma_f32_32x32x16_bf16 v[146:161], v[72:75], v[140:143], v[146:161]
  global_load_lds_dwordx4 v251, s[12:13] offset:1024 sc1
  v_exp_f32 v170, v170
  v_exp_f32 v171, v171
  v_exp_f32 v172, v172
  v_exp_f32 v173, v173
  v_cvt_pk_bf16_f32 v220, v166, v167
  v_cvt_pk_bf16_f32 v221, v168, v169
  s_waitcnt vmcnt(19)
  v_mfma_f32_32x32x16_bf16 v[32:47], a[4:7], v[214:217], v[32:47]
  global_load_lds_dwordx4 v251, s[12:13] offset:2048 sc1
  v_exp_f32 v174, v174
  v_exp_f32 v175, v175
  v_exp_f32 v176, v176
  v_exp_f32 v177, v177
  v_cvt_pk_bf16_f32 v222, v170, v171
  v_cvt_pk_bf16_f32 v223, v172, v173
  s_waitcnt vmcnt(19)
  v_mfma_f32_32x32x16_bf16 v[32:47], a[8:11], v[218:221], v[32:47]
  global_load_lds_dwordx4 v251, s[12:13] offset:3072 sc1
  v_cvt_pk_bf16_f32 v224, v174, v175
  v_cvt_pk_bf16_f32 v225, v176, v177
  s_waitcnt vmcnt(17)
  v_swap_b32 v114, v116
  v_swap_b32 v115, v117
  v_exp_f32 v146, v146
  v_exp_f32 v147, v147
  v_exp_f32 v148, v148
  v_exp_f32 v149, v149
  s_add_u32 m0, s95, 4096
  v_add_u32 v251, 4096, v251
  v_mfma_f32_32x32x16_bf16 v[162:177], v[112:115], v[124:127], v[194:209]
  global_load_lds_dwordx4 v251, s[12:13] offset:0 sc1
  v_exp_f32 v150, v150
  v_exp_f32 v151, v151
  v_exp_f32 v152, v152
  v_exp_f32 v153, v153
  v_cvt_pk_bf16_f32 v210, v146, v147
  v_cvt_pk_bf16_f32 v211, v148, v149
  s_waitcnt vmcnt(17)
  v_mfma_f32_32x32x16_bf16 v[162:177], v[120:123], v[138:141], v[162:177]
  global_load_lds_dwordx4 v251, s[12:13] offset:1024 sc1
  v_exp_f32 v154, v154
  v_exp_f32 v155, v155
  v_exp_f32 v156, v156
  v_exp_f32 v157, v157
  v_cvt_pk_bf16_f32 v212, v150, v151
  v_cvt_pk_bf16_f32 v213, v152, v153
  v_mfma_f32_32x32x16_bf16 v[32:47], a[12:15], v[222:225], v[32:47]
  global_load_lds_dwordx4 v251, s[12:13] offset:2048 sc1
  v_exp_f32 v158, v158
  v_exp_f32 v159, v159
  v_exp_f32 v160, v160
  v_exp_f32 v161, v161
  v_cvt_pk_bf16_f32 v214, v154, v155
  v_cvt_pk_bf16_f32 v215, v156, v157
  v_mfma_f32_32x32x16_bf16 v[48:63], a[8:11], v[210:213], v[48:63]
  global_load_lds_dwordx4 v251, s[12:13] offset:3072 sc1
  v_cvt_pk_bf16_f32 v216, v158, v159
  v_cvt_pk_bf16_f32 v217, v160, v161
  v_exp_f32 v162, v162
  v_exp_f32 v163, v163
  v_exp_f32 v164, v164
  v_exp_f32 v165, v165
  s_add_u32 m0, s95, 8192
  v_add_u32 v251, 4096, v251
  v_mfma_f32_32x32x16_bf16 v[146:161], v[112:115], v[128:131], 0
  global_load_lds_dwordx4 v251, s[12:13] offset:0 sc1
  v_exp_f32 v166, v166
  v_exp_f32 v167, v167
  v_exp_f32 v168, v168
  v_exp_f32 v169, v169
  v_cvt_pk_bf16_f32 v218, v162, v163
  v_cvt_pk_bf16_f32 v219, v164, v165
  v_mfma_f32_32x32x16_bf16 v[146:161], v[120:123], v[142:145], v[146:161]
  global_load_lds_dwordx4 v251, s[12:13] offset:1024 sc1
  v_exp_f32 v170, v170
  v_exp_f32 v171, v171
  v_exp_f32 v172, v172
  v_exp_f32 v173, v173
  v_cvt_pk_bf16_f32 v220, v166, v167
  v_cvt_pk_bf16_f32 v221, v168, v169
  v_mfma_f32_32x32x16_bf16 v[48:63], a[12:15], v[214:217], v[48:63]
  global_load_lds_dwordx4 v251, s[12:13] offset:2048 sc1
  v_exp_f32 v174, v174
  v_exp_f32 v175, v175
  v_exp_f32 v176, v176
  v_exp_f32 v177, v177
  v_cvt_pk_bf16_f32 v222, v170, v171
  v_cvt_pk_bf16_f32 v223, v172, v173
  s_waitcnt vmcnt(22)
  v_mfma_f32_32x32x16_bf16 v[32:47], a[64:67], v[218:221], v[32:47]
  global_load_lds_dwordx4 v251, s[12:13] offset:3072 sc1
  v_cvt_pk_bf16_f32 v224, v174, v175
  v_cvt_pk_bf16_f32 v225, v176, v177
  v_exp_f32 v146, v146
  v_exp_f32 v147, v147
  v_exp_f32 v148, v148
  v_exp_f32 v149, v149
  s_add_u32 m0, s95, 12288
  v_add_u32 v251, 4096, v251
  v_mfma_f32_32x32x16_bf16 v[162:177], v[116:119], v[128:131], v[194:209]
  global_load_lds_dwordx4 v251, s[12:13] offset:0 sc1
  v_exp_f32 v150, v150
  v_exp_f32 v151, v151
  v_exp_f32 v152, v152
  v_exp_f32 v153, v153
  v_cvt_pk_bf16_f32 v210, v146, v147
  v_cvt_pk_bf16_f32 v211, v148, v149
  v_mfma_f32_32x32x16_bf16 v[162:177], v[120:123], v[140:143], v[162:177]
  global_load_lds_dwordx4 v251, s[12:13] offset:1024 sc1
  v_exp_f32 v154, v154
  v_exp_f32 v155, v155
  v_exp_f32 v156, v156
  v_exp_f32 v157, v157
  v_cvt_pk_bf16_f32 v212, v150, v151
  v_cvt_pk_bf16_f32 v213, v152, v153
  s_waitcnt vmcnt(24)
  v_mfma_f32_32x32x16_bf16 v[32:47], a[68:71], v[222:225], v[32:47]
  v_exp_f32 v158, v158
  v_exp_f32 v159, v159
  v_exp_f32 v160, v160
  v_exp_f32 v161, v161
  v_cvt_pk_bf16_f32 v214, v154, v155
  v_cvt_pk_bf16_f32 v215, v156, v157
  v_mfma_f32_32x32x16_bf16 v[48:63], a[64:67], v[210:213], v[48:63]
  v_cvt_pk_bf16_f32 v216, v158, v159
  v_cvt_pk_bf16_f32 v217, v160, v161
  v_exp_f32 v162, v162
  v_exp_f32 v163, v163
  v_exp_f32 v164, v164
  v_exp_f32 v165, v165
  v_exp_f32 v166, v166
  v_exp_f32 v167, v167
  v_exp_f32 v168, v168
  v_exp_f32 v169, v169
  v_cvt_pk_bf16_f32 v218, v162, v163
  v_cvt_pk_bf16_f32 v219, v164, v165
  v_exp_f32 v170, v170
  v_exp_f32 v171, v171
  v_exp_f32 v172, v172
  v_exp_f32 v173, v173
  v_cvt_pk_bf16_f32 v220, v166, v167
  v_cvt_pk_bf16_f32 v221, v168, v169
  v_mfma_f32_32x32x16_bf16 v[48:63], a[68:71], v[214:217], v[48:63]
  v_exp_f32 v174, v174
  v_exp_f32 v175, v175
  v_exp_f32 v176, v176
  v_exp_f32 v177, v177
  v_cvt_pk_bf16_f32 v222, v170, v171
  v_cvt_pk_bf16_f32 v223, v172, v173
  s_waitcnt vmcnt(23)
  v_mfma_f32_32x32x16_bf16 v[48:63], a[72:75], v[218:221], v[48:63]
  v_cvt_pk_bf16_f32 v224, v174, v175
  v_cvt_pk_bf16_f32 v225, v176, v177
  s_waitcnt vmcnt(22)
  s_nop 0
  v_mfma_f32_32x32x16_bf16 v[48:63], a[76:79], v[222:225], v[48:63]
  s_nop 10
  s_branch Lattn_done
Lav_44:
  s_mov_b32 s18, s66
  s_barrier
  buffer_load_dwordx4 v[124:127], v2, s[12:15], s53 offen sc1
  buffer_load_dwordx4 v[128:131], v2, s[12:15], s53 offen offset:1024 sc1
  buffer_load_dwordx4 v[64:67], v2, s[16:19], s64 offen sc1
  buffer_load_dwordx4 v[68:71], v2, s[16:19], s64 offen offset:1024 sc1
  buffer_load_dwordx4 v[132:135], v3, s[12:15], s53 offen offset:2048 sc1
  buffer_load_dwordx4 v[72:75], v3, s[16:19], s64 offen offset:2048 sc1
  s_mov_b64 exec, s[88:89]
  buffer_load_dwordx4 a[0:3], v4, s[16:19], s65 offen sc1
  s_mov_b64 exec, -1
  s_mov_b64 exec, s[88:89]
  buffer_load_dwordx4 a[4:7], v9, s[16:19], s65 offen sc1
  s_mov_b64 exec, -1
  s_mov_b64 exec, s[88:89]
  buffer_load_dwordx4 a[8:11], v10, s[16:19], s65 offen sc1
  s_mov_b64 exec, -1
  s_mov_b64 exec, s[88:89]
  buffer_load_dwordx4 a[12:15], v11, s[16:19], s65 offen sc1
  s_mov_b64 exec, -1
  s_mov_b32 s18, s69
  buffer_load_dwordx4 v[76:79], v2, s[16:19], s67 offen sc1
  buffer_load_dwordx4 v[80:83], v2, s[16:19], s67 offen offset:1024 sc1
  buffer_load_dwordx4 v[84:87], v3, s[16:19], s67 offen offset:2048 sc1
  s_waitcnt vmcnt(11)
  v_swap_b32 v126, v128
  v_swap_b32 v127, v129
  s_waitcnt vmcnt(8)
  v_cndmask_b32 v138, v132, 0, s[44:45]
  v_cndmask_b32 v139, v133, 0, s[44:45]
  v_cndmask_b32 v142, v134, 0, s[44:45]
  v_cndmask_b32 v143, v135, 0, s[44:45]
  v_swap_b32 v66, v68
  v_swap_b32 v67, v69
  s_nop 1
  v_mfma_f32_32x32x16_bf16 v[146:161], v[64:67], v[124:127], v[178:193]
  s_waitcnt vmcnt(7)
  v_mfma_f32_32x32x16_bf16 v[146:161], v[72:75], v[138:141], v[146:161]
  s_mov_b64 exec, s[88:89]
  buffer_load_dwordx4 a[16:19], v4, s[16:19], s68 offen sc1
  s_mov_b64 exec, -1
  s_mov_b64 exec, s[88:89]
  buffer_load_dwordx4 a[20:23], v9, s[16:19], s68 offen sc1
  s_mov_b64 exec, -1
  s_nop 5
  v_exp_f32 v146, v146
  v_exp_f32 v147, v147
  v_exp_f32 v148, v148
  v_exp_f32 v149, v149
  s_mov_b64 exec, s[88:89]
  v_mfma_f32_32x32x16_bf16 v[162:177], v[68:71], v[124:127], 0
  buffer_load_dwordx4 a[24:27], v10, s[16:19], s68 offen sc1
  s_mov_b64 exec, -1
  v_exp_f32 v150, v150
  v_exp_f32 v151, v151
  v_exp_f32 v152, v152
  v_exp_f32 v153, v153
  v_cvt_pk_bf16_f32 v210, v146, v147
  v_cvt_pk_bf16_f32 v211, v148, v149
  s_mov_b64 exec, s[88:89]
  v_mfma_f32_32x32x16_bf16 v[162:177], v[72:75], v[136:139], v[162:177]
  buffer_load_dwordx4 a[28:31], v11, s[16:19], s68 offen sc1
  s_mov_b64 exec, -1
  v_exp_f32 v154, v154
  v_exp_f32 v155, v155
  v_exp_f32 v156, v156
  v_exp_f32 v157, v157
  v_cvt_pk_bf16_f32 v212, v150, v151
  v_cvt_pk_bf16_f32 v213, v152, v153
  v_exp_f32 v158, v158
  v_exp_f32 v159, v159
  v_exp_f32 v160, v160
  v_exp_f32 v161, v161
  v_cvt_pk_bf16_f32 v214, v154, v155
  v_cvt_pk_bf16_f32 v215, v156, v157
  s_waitcnt vmcnt(10)
  v_mfma_f32_32x32x16_bf16 v[32:47], a[0:3], v[210:213], 0
  v_cvt_pk_bf16_f32 v216, v158, v159
  v_cvt_pk_bf16_f32 v217, v160, v161
  v_exp_f32 v162, v162
  v_exp_f32 v163, v163
  v_exp_f32 v164, v164
  v_exp_f32 v165, v165
  s_mov_b32 s18, s72
  v_mfma_f32_32x32x16_bf16 v[146:161], v[68:71], v[128:131], v[178:193]
  buffer_load_dwordx4 v[88:91], v2, s[16:19], s70 offen sc1
  v_exp_f32 v166, v166
  v_exp_f32 v167, v167
  v_exp_f32 v168, v168
  v_exp_f32 v169, v169
  v_cvt_pk_bf16_f32 v218, v162, v163
  v_cvt_pk_bf16_f32 v219, v164, v165
  v_mfma_f32_32x32x16_bf16 v[146:161], v[72:75], v[140:143], v[146:161]
  buffer_load_dwordx4 v[92:95], v2, s[16:19], s70 offen offset:1024 sc1
  v_exp_f32 v170, v170
  v_exp_f32 v171, v171
  v_exp_f32 v172, v172
  v_exp_f32 v173, v173
  v_cvt_pk_bf16_f32 v220, v166, v167
  v_cvt_pk_bf16_f32 v221, v168, v169
  s_waitcnt vmcnt(11)
  v_mfma_f32_32x32x16_bf16 v[32:47], a[4:7], v[214:217], v[32:47]
  v_exp_f32 v174, v174
  v_exp_f32 v175, v175
  v_exp_f32 v176, v176
  v_exp_f32 v177, v177
  v_cvt_pk_bf16_f32 v222, v170, v171
  v_cvt_pk_bf16_f32 v223, v172, v173
  s_waitcnt vmcnt(10)
  v_mfma_f32_32x32x16_bf16 v[32:47], a[8:11], v[218:221], v[32:47]
  buffer_load_dwordx4 v[96:99], v3, s[16:19], s70 offen offset:2048 sc1
  v_cvt_pk_bf16_f32 v224, v174, v175
  v_cvt_pk_bf16_f32 v225, v176, v177
  s_waitcnt vmcnt(8)
  v_swap_b32 v78, v80
  v_swap_b32 v79, v81
  v_exp_f32 v146, v146
  v_exp_f32 v147, v147
  v_exp_f32 v148, v148
  v_exp_f32 v149, v149
  s_mov_b64 exec, s[88:89]
  v_mfma_f32_32x32x16_bf16 v[162:177], v[76:79], v[124:127], 0
  buffer_load_dwordx4 a[32:35], v4, s[16:19], s71 offen sc1
  s_mov_b64 exec, -1
  v_exp_f32 v150, v150
  v_exp_f32 v151, v151
  v_exp_f32 v152, v152
  v_exp_f32 v153, v153
  v_cvt_pk_bf16_f32 v210, v146, v147
  v_cvt_pk_bf16_f32 v211, v148, v149
  s_waitcnt vmcnt(8)
  v_mfma_f32_32x32x16_bf16 v[162:177], v[84:87], v[138:141], v[162:177]
  buffer_load_dword v6, v5, s[12:15], s94 offen sc1
  v_exp_f32 v154, v154
  v_exp_f32 v155, v155
  v_exp_f32 v156, v156
  v_exp_f32 v157, v157
  v_cvt_pk_bf16_f32 v212, v150, v151
  v_cvt_pk_bf16_f32 v213, v152, v153
  s_mov_b64 exec, s[88:89]
  v_mfma_f32_32x32x16_bf16 v[32:47], a[12:15], v[222:225], v[32:47]
  buffer_load_dwordx4 a[36:39], v9, s[16:19], s71 offen sc1
  s_mov_b64 exec, -1
  v_exp_f32 v158, v158
  v_exp_f32 v159, v159
  v_exp_f32 v160, v160
  v_exp_f32 v161, v161
  v_cvt_pk_bf16_f32 v214, v154, v155
  v_cvt_pk_bf16_f32 v215, v156, v157
  s_mov_b64 exec, s[88:89]
  v_mfma_f32_32x32x16_bf16 v[48:63], a[8:11], v[210:213], 0
  buffer_load_dwordx4 a[40:43], v10, s[16:19], s71 offen sc1
  s_mov_b64 exec, -1
  v_cvt_pk_bf16_f32 v216, v158, v159
  v_cvt_pk_bf16_f32 v217, v160, v161
  v_exp_f32 v162, v162
  v_exp_f32 v163, v163
  v_exp_f32 v164, v164
  v_exp_f32 v165, v165
  v_mfma_f32_32x32x16_bf16 v[146:161], v[76:79], v[128:131], 0
  v_exp_f32 v166, v166
  v_exp_f32 v167, v167
  v_exp_f32 v168, v168
  v_exp_f32 v169, v169
  v_cvt_pk_bf16_f32 v218, v162, v163
  v_cvt_pk_bf16_f32 v219, v164, v165
  s_mov_b64 exec, s[88:89]
  v_mfma_f32_32x32x16_bf16 v[146:161], v[84:87], v[142:145], v[146:161]
  buffer_load_dwordx4 a[44:47], v11, s[16:19], s71 offen sc1
  s_mov_b64 exec, -1
  v_exp_f32 v170, v170
  v_exp_f32 v171, v171
  v_exp_f32 v172, v172
  v_exp_f32 v173, v173
  v_cvt_pk_bf16_f32 v220, v166, v167
  v_cvt_pk_bf16_f32 v221, v168, v169
  s_mov_b32 s18, s75
  v_mfma_f32_32x32x16_bf16 v[48:63], a[12:15], v[214:217], v[48:63]
  buffer_load_dwordx4 v[100:103], v2, s[16:19], s73 offen sc1
  v_exp_f32 v174, v174
  v_exp_f32 v175, v175
  v_exp_f32 v176, v176
  v_exp_f32 v177, v177
  v_cvt_pk_bf16_f32 v222, v170, v171
  v_cvt_pk_bf16_f32 v223, v172, v173
  s_waitcnt vmcnt(12)
  v_mfma_f32_32x32x16_bf16 v[32:47], a[16:19], v[218:221], v[32:47]
  v_cvt_pk_bf16_f32 v224, v174, v175
  v_cvt_pk_bf16_f32 v225, v176, v177
  v_exp_f32 v146, v146
  v_exp_f32 v147, v147
  v_exp_f32 v148, v148
  v_exp_f32 v149, v149
  v_mfma_f32_32x32x16_bf16 v[162:177], v[80:83], v[124:127], 0
  buffer_load_dwordx4 v[104:107], v2, s[16:19], s73 offen offset:1024 sc1
  v_exp_f32 v150, v150
  v_exp_f32 v151, v151
  v_exp_f32 v152, v152
  v_exp_f32 v153, v153
  v_cvt_pk_bf16_f32 v210, v146, v147
  v_cvt_pk_bf16_f32 v211, v148, v149
  v_mfma_f32_32x32x16_bf16 v[162:177], v[84:87], v[136:139], v[162:177]
  buffer_load_dwordx4 v[108:111], v3, s[16:19], s73 offen offset:2048 sc1
  v_exp_f32 v154, v154
  v_exp_f32 v155, v155
  v_exp_f32 v156, v156
  v_exp_f32 v157, v157
  v_cvt_pk_bf16_f32 v212, v150, v151
  v_cvt_pk_bf16_f32 v213, v152, v153
  s_waitcnt vmcnt(13)
  v_mfma_f32_32x32x16_bf16 v[32:47], a[20:23], v[222:225], v[32:47]
  v_exp_f32 v158, v158
  v_exp_f32 v159, v159
  v_exp_f32 v160, v160
  v_exp_f32 v161, v161
  v_cvt_pk_bf16_f32 v214, v154, v155
  v_cvt_pk_bf16_f32 v215, v156, v157
  s_mov_b64 exec, s[88:89]
  v_mfma_f32_32x32x16_bf16 v[48:63], a[16:19], v[210:213], v[48:63]
  buffer_load_dwordx4 a[48:51], v4, s[16:19], s74 offen sc1
  s_mov_b64 exec, -1
  v_cvt_pk_bf16_f32 v216, v158, v159
  v_cvt_pk_bf16_f32 v217, v160, v161
  v_exp_f32 v162, v162
  v_exp_f32 v163, v163
  v_exp_f32 v164, v164
  v_exp_f32 v165, v165
  s_mov_b64 exec, s[88:89]
  v_mfma_f32_32x32x16_bf16 v[146:161], v[80:83], v[128:131], 0
  buffer_load_dwordx4 a[52:55], v9, s[16:19], s74 offen sc1
  s_mov_b64 exec, -1
  v_exp_f32 v166, v166
  v_exp_f32 v167, v167
  v_exp_f32 v168, v168
  v_exp_f32 v169, v169
  v_cvt_pk_bf16_f32 v218, v162, v163
  v_cvt_pk_bf16_f32 v219, v164, v165
  v_mfma_f32_32x32x16_bf16 v[146:161], v[84:87], v[140:143], v[146:161]
  v_exp_f32 v170, v170
  v_exp_f32 v171, v171
  v_exp_f32 v172, v172
  v_exp_f32 v173, v173
  v_cvt_pk_bf16_f32 v220, v166, v167
  v_cvt_pk_bf16_f32 v221, v168, v169
  s_mov_b64 exec, s[88:89]
  v_mfma_f32_32x32x16_bf16 v[48:63], a[20:23], v[214:217], v[48:63]
  buffer_load_dwordx4 a[56:59], v10, s[16:19], s74 offen sc1
  s_mov_b64 exec, -1
  v_exp_f32 v174, v174
  v_exp_f32 v175, v175
  v_exp_f32 v176, v176
  v_exp_f32 v177, v177
  v_cvt_pk_bf16_f32 v222, v170, v171
  v_cvt_pk_bf16_f32 v223, v172, v173
  s_mov_b64 exec, s[88:89]
  s_waitcnt vmcnt(15)
  v_mfma_f32_32x32x16_bf16 v[32:47], a[24:27], v[218:221], v[32:47]
  buffer_load_dwordx4 a[60:63], v11, s[16:19], s74 offen sc1
  s_mov_b64 exec, -1
  v_cvt_pk_bf16_f32 v224, v174, v175
  v_cvt_pk_bf16_f32 v225, v176, v177
  s_waitcnt vmcnt(13)
  v_swap_b32 v90, v92
  v_swap_b32 v91, v93
  v_exp_f32 v146, v146
  v_exp_f32 v147, v147
  v_exp_f32 v148, v148
  v_exp_f32 v149, v149
  v_mfma_f32_32x32x16_bf16 v[162:177], v[88:91], v[124:127], 0
  v_exp_f32 v150, v150
  v_exp_f32 v151, v151
  v_exp_f32 v152, v152
  v_exp_f32 v153, v153
  v_cvt_pk_bf16_f32 v210, v146, v147
  v_cvt_pk_bf16_f32 v211, v148, v149
  s_mov_b32 s18, s78
  s_waitcnt vmcnt(12)
  v_mfma_f32_32x32x16_bf16 v[162:177], v[96:99], v[138:141], v[162:177]
  buffer_load_dwordx4 v[112:115], v2, s[16:19], s76 offen sc1
  v_exp_f32 v154, v154
  v_exp_f32 v155, v155
  v_exp_f32 v156, v156
  v_exp_f32 v157, v157
  v_cvt_pk_bf16_f32 v212, v150, v151
  v_cvt_pk_bf16_f32 v213, v152, v153
  v_mfma_f32_32x32x16_bf16 v[32:47], a[28:31], v[222:225], v[32:47]
  buffer_load_dwordx4 v[116:119], v2, s[16:19], s76 offen offset:1024 sc1
  v_exp_f32 v158, v158
  v_exp_f32 v159, v159
  v_exp_f32 v160, v160
  v_exp_f32 v161, v161
  v_cvt_pk_bf16_f32 v214, v154, v155
  v_cvt_pk_bf16_f32 v215, v156, v157
  v_mfma_f32_32x32x16_bf16 v[48:63], a[24:27], v[210:213], v[48:63]
  v_cvt_pk_bf16_f32 v216, v158, v159
  v_cvt_pk_bf16_f32 v217, v160, v161
  v_exp_f32 v162, v162
  v_exp_f32 v163, v163
  v_exp_f32 v164, v164
  v_exp_f32 v165, v165
  v_mfma_f32_32x32x16_bf16 v[146:161], v[88:91], v[128:131], 0
  buffer_load_dwordx4 v[120:123], v3, s[16:19], s76 offen offset:2048 sc1
  v_exp_f32 v166, v166
  v_exp_f32 v167, v167
  v_exp_f32 v168, v168
  v_exp_f32 v169, v169
  v_cvt_pk_bf16_f32 v218, v162, v163
  v_cvt_pk_bf16_f32 v219, v164, v165
  s_mov_b64 exec, s[88:89]
  v_mfma_f32_32x32x16_bf16 v[146:161], v[96:99], v[142:145], v[146:161]
  buffer_load_dwordx4 a[64:67], v4, s[16:19], s77 offen sc1
  s_mov_b64 exec, -1
  v_exp_f32 v170, v170
  v_exp_f32 v171, v171
  v_exp_f32 v172, v172
  v_exp_f32 v173, v173
  v_cvt_pk_bf16_f32 v220, v166, v167
  v_cvt_pk_bf16_f32 v221, v168, v169
  v_mfma_f32_32x32x16_bf16 v[48:63], a[28:31], v[214:217], v[48:63]
  v_exp_f32 v174, v174
  v_exp_f32 v175, v175
  v_exp_f32 v176, v176
  v_exp_f32 v177, v177
  v_cvt_pk_bf16_f32 v222, v170, v171
  v_cvt_pk_bf16_f32 v223, v172, v173
  s_mov_b64 exec, s[88:89]
  s_waitcnt vmcnt(15)
  v_mfma_f32_32x32x16_bf16 v[32:47], a[32:35], v[218:221], v[32:47]
  buffer_load_dwordx4 a[68:71], v9, s[16:19], s77 offen sc1
  s_mov_b64 exec, -1
  v_cvt_pk_bf16_f32 v224, v174, v175
  v_cvt_pk_bf16_f32 v225, v176, v177
  v_exp_f32 v146, v146
  v_exp_f32 v147, v147
  v_exp_f32 v148, v148
  v_exp_f32 v149, v149
  s_mov_b64 exec, s[88:89]
  v_mfma_f32_32x32x16_bf16 v[162:177], v[92:95], v[124:127], 0
  buffer_load_dwordx4 a[72:75], v10, s[16:19], s77 offen sc1
  s_mov_b64 exec, -1
  v_exp_f32 v150, v150
  v_exp_f32 v151, v151
  v_exp_f32 v152, v152
  v_exp_f32 v153, v153
  v_cvt_pk_bf16_f32 v210, v146, v147
  v_cvt_pk_bf16_f32 v211, v148, v149
  v_mfma_f32_32x32x16_bf16 v[162:177], v[96:99], v[136:139], v[162:177]
  v_exp_f32 v154, v154
  v_exp_f32 v155, v155
  v_exp_f32 v156, v156
  v_exp_f32 v157, v157
  v_cvt_pk_bf16_f32 v212, v150, v151
  v_cvt_pk_bf16_f32 v213, v152, v153
  s_mov_b64 exec, s[88:89]
  s_waitcnt vmcnt(15)
  v_mfma_f32_32x32x16_bf16 v[32:47], a[36:39], v[222:225], v[32:47]
  buffer_load_dwordx4 a[76:79], v11, s[16:19], s77 offen sc1
  s_mov_b64 exec, -1
  v_exp_f32 v158, v158
  v_exp_f32 v159, v159
  v_exp_f32 v160, v160
  v_exp_f32 v161, v161
  v_cvt_pk_bf16_f32 v214, v154, v155
  v_cvt_pk_bf16_f32 v215, v156, v157
  v_mfma_f32_32x32x16_bf16 v[48:63], a[32:35], v[210:213], v[48:63]
  v_cvt_pk_bf16_f32 v216, v158, v159
  v_cvt_pk_bf16_f32 v217, v160, v161
  v_exp_f32 v162, v162
  v_exp_f32 v163, v163
  v_exp_f32 v164, v164
  v_exp_f32 v165, v165
  v_mfma_f32_32x32x16_bf16 v[146:161], v[92:95], v[128:131], 0
  buffer_load_dword v15, v14, s[12:15], s94 offen sc1
  v_exp_f32 v166, v166
  v_exp_f32 v167, v167
  v_exp_f32 v168, v168
  v_exp_f32 v169, v169
  v_cvt_pk_bf16_f32 v218, v162, v163
  v_cvt_pk_bf16_f32 v219, v164, v165
  v_mfma_f32_32x32x16_bf16 v[146:161], v[96:99], v[140:143], v[146:161]
  global_load_dword v249, v245, s[30:31]
  v_exp_f32 v170, v170
  v_exp_f32 v171, v171
  v_exp_f32 v172, v172
  v_exp_f32 v173, v173
  v_cvt_pk_bf16_f32 v220, v166, v167
  v_cvt_pk_bf16_f32 v221, v168, v169
  s_add_u32 m0, s95, 32768
  v_mfma_f32_32x32x16_bf16 v[48:63], a[36:39], v[214:217], v[48:63]
  buffer_load_dwordx4 v226, s[4:7], s51 offen offset:0 lds
  v_exp_f32 v174, v174
  v_exp_f32 v175, v175
  v_exp_f32 v176, v176
  v_exp_f32 v177, v177
  v_cvt_pk_bf16_f32 v222, v170, v171
  v_cvt_pk_bf16_f32 v223, v172, v173
  s_waitcnt vmcnt(18)
  v_mfma_f32_32x32x16_bf16 v[32:47], a[40:43], v[218:221], v[32:47]
  buffer_load_dwordx4 v227, s[4:7], s51 offen offset:1024 lds
  v_cvt_pk_bf16_f32 v224, v174, v175
  v_cvt_pk_bf16_f32 v225, v176, v177
  s_waitcnt vmcnt(16)
  v_swap_b32 v102, v104
  v_swap_b32 v103, v105
  v_exp_f32 v146, v146
  v_exp_f32 v147, v147
  v_exp_f32 v148, v148
  v_exp_f32 v149, v149
  v_mfma_f32_32x32x16_bf16 v[162:177], v[100:103], v[124:127], 0
  buffer_load_dwordx4 v228, s[4:7], s51 offen offset:2048 lds
  v_exp_f32 v150, v150
  v_exp_f32 v151, v151
  v_exp_f32 v152, v152
  v_exp_f32 v153, v153
  v_cvt_pk_bf16_f32 v210, v146, v147
  v_cvt_pk_bf16_f32 v211, v148, v149
  s_waitcnt vmcnt(16)
  v_mfma_f32_32x32x16_bf16 v[162:177], v[108:111], v[138:141], v[162:177]
  buffer_store_dwordx4 v[16:19], v2, s[12:15], s79 offen offset:0 sc1
  v_exp_f32 v154, v154
  v_exp_f32 v155, v155
  v_exp_f32 v156, v156
  v_exp_f32 v157, v157
  v_cvt_pk_bf16_f32 v212, v150, v151
  v_cvt_pk_bf16_f32 v213, v152, v153
  v_mfma_f32_32x32x16_bf16 v[32:47], a[44:47], v[222:225], v[32:47]
  v_exp_f32 v158, v158
  v_exp_f32 v159, v159
  v_exp_f32 v160, v160
  v_exp_f32 v161, v161
  v_cvt_pk_bf16_f32 v214, v154, v155
  v_cvt_pk_bf16_f32 v215, v156, v157
  v_mfma_f32_32x32x16_bf16 v[48:63], a[40:43], v[210:213], v[48:63]
  buffer_store_dwordx4 v[16:19], v2, s[12:15], s79 offen offset:1024 sc1
  v_cvt_pk_bf16_f32 v216, v158, v159
  v_cvt_pk_bf16_f32 v217, v160, v161
  v_exp_f32 v162, v162
  v_exp_f32 v163, v163
  v_exp_f32 v164, v164
  v_exp_f32 v165, v165
  v_mfma_f32_32x32x16_bf16 v[146:161], v[100:103], v[128:131], 0
  v_exp_f32 v166, v166
  v_exp_f32 v167, v167
  v_exp_f32 v168, v168
  v_exp_f32 v169, v169
  v_cvt_pk_bf16_f32 v218, v162, v163
  v_cvt_pk_bf16_f32 v219, v164, v165
  v_mfma_f32_32x32x16_bf16 v[146:161], v[108:111], v[142:145], v[146:161]
  buffer_store_dwordx2 v[16:17], v20, s[12:15], s79 offen offset:2048 sc1
  v_exp_f32 v170, v170
  v_exp_f32 v171, v171
  v_exp_f32 v172, v172
  v_exp_f32 v173, v173
  v_cvt_pk_bf16_f32 v220, v166, v167
  v_cvt_pk_bf16_f32 v221, v168, v169
  v_mfma_f32_32x32x16_bf16 v[48:63], a[44:47], v[214:217], v[48:63]
  v_exp_f32 v174, v174
  v_exp_f32 v175, v175
  v_exp_f32 v176, v176
  v_exp_f32 v177, v177
  v_cvt_pk_bf16_f32 v222, v170, v171
  v_cvt_pk_bf16_f32 v223, v172, v173
  s_waitcnt vmcnt(18)
  v_mfma_f32_32x32x16_bf16 v[32:47], a[48:51], v[218:221], v[32:47]
  v_cvt_pk_bf16_f32 v224, v174, v175
  v_cvt_pk_bf16_f32 v225, v176, v177
  v_exp_f32 v146, v146
  v_exp_f32 v147, v147
  v_exp_f32 v148, v148
  v_exp_f32 v149, v149
  v_mfma_f32_32x32x16_bf16 v[162:177], v[104:107], v[124:127], 0
  v_exp_f32 v150, v150
  v_exp_f32 v151, v151
  v_exp_f32 v152, v152
  v_exp_f32 v153, v153
  v_cvt_pk_bf16_f32 v210, v146, v147
  v_cvt_pk_bf16_f32 v211, v148, v149
  v_mfma_f32_32x32x16_bf16 v[162:177], v[108:111], v[136:139], v[162:177]
  v_exp_f32 v154, v154
  v_exp_f32 v155, v155
  v_exp_f32 v156, v156
  v_exp_f32 v157, v157
  v_cvt_pk_bf16_f32 v212, v150, v151
  v_cvt_pk_bf16_f32 v213, v152, v153
  s_waitcnt vmcnt(17)
  v_mfma_f32_32x32x16_bf16 v[32:47], a[52:55], v[222:225], v[32:47]
  v_exp_f32 v158, v158
  v_exp_f32 v159, v159
  v_exp_f32 v160, v160
  v_exp_f32 v161, v161
  v_cvt_pk_bf16_f32 v214, v154, v155
  v_cvt_pk_bf16_f32 v215, v156, v157
  v_mfma_f32_32x32x16_bf16 v[48:63], a[48:51], v[210:213], v[48:63]
  v_subrev_u32 v253, s37, v6
  v_cmp_le_u32 vcc, 16, v253
  s_nop 3
  s_cbranch_vccnz Lfs_57
Lfb_58:
  s_add_u32 s49, s37, s87
  v_cmp_ne_u32 vcc, s49, v6
  s_nop 0
  s_andn2_b64 vcc, vcc, s[44:45]
  s_cselect_b32 s86, 0, 1
  v_cvt_pk_bf16_f32 v216, v158, v159
  v_cvt_pk_bf16_f32 v217, v160, v161
  v_exp_f32 v162, v162
  v_exp_f32 v163, v163
  v_exp_f32 v164, v164
  v_exp_f32 v165, v165
  s_add_u32 m0, s95, 0
  v_add_u32 v251, s91, v2
  v_mfma_f32_32x32x16_bf16 v[146:161], v[104:107], v[128:131], 0
  global_load_lds_dwordx4 v251, s[12:13] offset:0 sc1
  v_exp_f32 v166, v166
  v_exp_f32 v167, v167
  v_exp_f32 v168, v168
  v_exp_f32 v169, v169
  v_cvt_pk_bf16_f32 v218, v162, v163
  v_cvt_pk_bf16_f32 v219, v164, v165
  v_mfma_f32_32x32x16_bf16 v[146:161], v[108:111], v[140:143], v[146:161]
  global_load_lds_dwordx4 v251, s[12:13] offset:1024 sc1
  v_exp_f32 v170, v170
  v_exp_f32 v171, v171
  v_exp_f32 v172, v172
  v_exp_f32 v173, v173
  v_cvt_pk_bf16_f32 v220, v166, v167
  v_cvt_pk_bf16_f32 v221, v168, v169
  v_mfma_f32_32x32x16_bf16 v[48:63], a[52:55], v[214:217], v[48:63]
  global_load_lds_dwordx4 v251, s[12:13] offset:2048 sc1
  v_exp_f32 v174, v174
  v_exp_f32 v175, v175
  v_exp_f32 v176, v176
  v_exp_f32 v177, v177
  v_cvt_pk_bf16_f32 v222, v170, v171
  v_cvt_pk_bf16_f32 v223, v172, v173
  s_waitcnt vmcnt(19)
  v_mfma_f32_32x32x16_bf16 v[32:47], a[56:59], v[218:221], v[32:47]
  global_load_lds_dwordx4 v251, s[12:13] offset:3072 sc1
  v_cvt_pk_bf16_f32 v224, v174, v175
  v_cvt_pk_bf16_f32 v225, v176, v177
  s_waitcnt vmcnt(17)
  v_swap_b32 v114, v116
  v_swap_b32 v115, v117
  v_exp_f32 v146, v146
  v_exp_f32 v147, v147
  v_exp_f32 v148, v148
  v_exp_f32 v149, v149
  s_add_u32 m0, s95, 4096
  v_add_u32 v251, 4096, v251
  v_mfma_f32_32x32x16_bf16 v[162:177], v[112:115], v[124:127], v[194:209]
  global_load_lds_dwordx4 v251, s[12:13] offset:0 sc1
  v_exp_f32 v150, v150
  v_exp_f32 v151, v151
  v_exp_f32 v152, v152
  v_exp_f32 v153, v153
  v_cvt_pk_bf16_f32 v210, v146, v147
  v_cvt_pk_bf16_f32 v211, v148, v149
  s_waitcnt vmcnt(17)
  v_mfma_f32_32x32x16_bf16 v[162:177], v[120:123], v[138:141], v[162:177]
  global_load_lds_dwordx4 v251, s[12:13] offset:1024 sc1
  v_exp_f32 v154, v154
  v_exp_f32 v155, v155
  v_exp_f32 v156, v156
  v_exp_f32 v157, v157
  v_cvt_pk_bf16_f32 v212, v150, v151
  v_cvt_pk_bf16_f32 v213, v152, v153
  v_mfma_f32_32x32x16_bf16 v[32:47], a[60:63], v[222:225], v[32:47]
  global_load_lds_dwordx4 v251, s[12:13] offset:2048 sc1
  v_exp_f32 v158, v158
  v_exp_f32 v159, v159
  v_exp_f32 v160, v160
  v_exp_f32 v161, v161
  v_cvt_pk_bf16_f32 v214, v154, v155
  v_cvt_pk_bf16_f32 v215, v156, v157
  v_mfma_f32_32x32x16_bf16 v[48:63], a[56:59], v[210:213], v[48:63]
  global_load_lds_dwordx4 v251, s[12:13] offset:3072 sc1
  v_cvt_pk_bf16_f32 v216, v158, v159
  v_cvt_pk_bf16_f32 v217, v160, v161
  v_exp_f32 v162, v162
  v_exp_f32 v163, v163
  v_exp_f32 v164, v164
  v_exp_f32 v165, v165
  s_add_u32 m0, s95, 8192
  v_add_u32 v251, 4096, v251
  v_mfma_f32_32x32x16_bf16 v[146:161], v[112:115], v[128:131], 0
  global_load_lds_dwordx4 v251, s[12:13] offset:0 sc1
  v_exp_f32 v166, v166
  v_exp_f32 v167, v167
  v_exp_f32 v168, v168
  v_exp_f32 v169, v169
  v_cvt_pk_bf16_f32 v218, v162, v163
  v_cvt_pk_bf16_f32 v219, v164, v165
  v_mfma_f32_32x32x16_bf16 v[146:161], v[120:123], v[142:145], v[146:161]
  global_load_lds_dwordx4 v251, s[12:13] offset:1024 sc1
  v_exp_f32 v170, v170
  v_exp_f32 v171, v171
  v_exp_f32 v172, v172
  v_exp_f32 v173, v173
  v_cvt_pk_bf16_f32 v220, v166, v167
  v_cvt_pk_bf16_f32 v221, v168, v169
  v_mfma_f32_32x32x16_bf16 v[48:63], a[60:63], v[214:217], v[48:63]
  global_load_lds_dwordx4 v251, s[12:13] offset:2048 sc1
  v_exp_f32 v174, v174
  v_exp_f32 v175, v175
  v_exp_f32 v176, v176
  v_exp_f32 v177, v177
  v_cvt_pk_bf16_f32 v222, v170, v171
  v_cvt_pk_bf16_f32 v223, v172, v173
  s_waitcnt vmcnt(22)
  v_mfma_f32_32x32x16_bf16 v[32:47], a[64:67], v[218:221], v[32:47]
  global_load_lds_dwordx4 v251, s[12:13] offset:3072 sc1
  v_cvt_pk_bf16_f32 v224, v174, v175
  v_cvt_pk_bf16_f32 v225, v176, v177
  v_exp_f32 v146, v146
  v_exp_f32 v147, v147
  v_exp_f32 v148, v148
  v_exp_f32 v149, v149
  s_add_u32 m0, s95, 12288
  v_add_u32 v251, 4096, v251
  v_mfma_f32_32x32x16_bf16 v[162:177], v[116:119], v[128:131], v[194:209]
  global_load_lds_dwordx4 v251, s[12:13] offset:0 sc1
  v_exp_f32 v150, v150
  v_exp_f32 v151, v151
  v_exp_f32 v152, v152
  v_exp_f32 v153, v153
  v_cvt_pk_bf16_f32 v210, v146, v147
  v_cvt_pk_bf16_f32 v211, v148, v149
  v_mfma_f32_32x32x16_bf16 v[162:177], v[120:123], v[140:143], v[162:177]
  global_load_lds_dwordx4 v251, s[12:13] offset:1024 sc1
  v_exp_f32 v154, v154
  v_exp_f32 v155, v155
  v_exp_f32 v156, v156
  v_exp_f32 v157, v157
  v_cvt_pk_bf16_f32 v212, v150, v151
  v_cvt_pk_bf16_f32 v213, v152, v153
  s_waitcnt vmcnt(24)
  v_mfma_f32_32x32x16_bf16 v[32:47], a[68:71], v[222:225], v[32:47]
  v_exp_f32 v158, v158
  v_exp_f32 v159, v159
  v_exp_f32 v160, v160
  v_exp_f32 v161, v161
  v_cvt_pk_bf16_f32 v214, v154, v155
  v_cvt_pk_bf16_f32 v215, v156, v157
  v_mfma_f32_32x32x16_bf16 v[48:63], a[64:67], v[210:213], v[48:63]
  v_cvt_pk_bf16_f32 v216, v158, v159
  v_cvt_pk_bf16_f32 v217, v160, v161
  v_exp_f32 v162, v162
  v_exp_f32 v163, v163
  v_exp_f32 v164, v164
  v_exp_f32 v165, v165
  v_exp_f32 v166, v166
  v_exp_f32 v167, v167
  v_exp_f32 v168, v168
  v_exp_f32 v169, v169
  v_cvt_pk_bf16_f32 v218, v162, v163
  v_cvt_pk_bf16_f32 v219, v164, v165
  v_exp_f32 v170, v170
  v_exp_f32 v171, v171
  v_exp_f32 v172, v172
  v_exp_f32 v173, v173
  v_cvt_pk_bf16_f32 v220, v166, v167
  v_cvt_pk_bf16_f32 v221, v168, v169
  v_mfma_f32_32x32x16_bf16 v[48:63], a[68:71], v[214:217], v[48:63]
  v_exp_f32 v174, v174
  v_exp_f32 v175, v175
  v_exp_f32 v176, v176
  v_exp_f32 v177, v177
  v_cvt_pk_bf16_f32 v222, v170, v171
  v_cvt_pk_bf16_f32 v223, v172, v173
  s_waitcnt vmcnt(23)
  v_mfma_f32_32x32x16_bf16 v[48:63], a[72:75], v[218:221], v[48:63]
  v_cvt_pk_bf16_f32 v224, v174, v175
  v_cvt_pk_bf16_f32 v225, v176, v177
  s_waitcnt vmcnt(22)
  s_nop 0
  v_mfma_f32_32x32x16_bf16 v[48:63], a[76:79], v[222:225], v[48:63]
  s_nop 11
Lattn_done:
  v_subrev_u32 v8, 0x2b800000, v44
  v_subrev_u32 v9, 0x2b800000, v60
  v_max_u32 v8, v8, v9
  v_cmp_lt_u32 vcc, 0x28000000, v8
  s_nop 3
  s_cbranch_vccnz Lattn_slow
Lattn_fin:
  v_rcp_f32 v8, v44
  v_rcp_f32 v9, v60
  s_nop 0
  v_pk_mul_f32 v[32:33], v[32:33], v[8:9] op_sel_hi:[1,0]
  v_pk_mul_f32 v[34:35], v[34:35], v[8:9] op_sel_hi:[1,0]
  v_pk_mul_f32 v[36:37], v[36:37], v[8:9] op_sel_hi:[1,0]
  v_pk_mul_f32 v[38:39], v[38:39], v[8:9] op_sel_hi:[1,0]
  v_pk_mul_f32 v[40:41], v[40:41], v[8:9] op_sel_hi:[1,0]
  v_pk_mul_f32 v[42:43], v[42:43], v[8:9] op_sel_hi:[1,0]
  v_cvt_pk_bf16_f32 v16, v32, v33
  v_cvt_pk_bf16_f32 v17, v34, v35
  v_cvt_pk_bf16_f32 v18, v36, v37
  v_cvt_pk_bf16_f32 v19, v38, v39
  v_cvt_pk_bf16_f32 v24, v40, v41
  v_cvt_pk_bf16_f32 v25, v42, v43
  v_pk_mul_f32 v[48:49], v[48:49], v[8:9] op_sel:[0,1] op_sel_hi:[1,1]
  v_pk_mul_f32 v[50:51], v[50:51], v[8:9] op_sel:[0,1] op_sel_hi:[1,1]
  v_pk_mul_f32 v[52:53], v[52:53], v[8:9] op_sel:[0,1] op_sel_hi:[1,1]
  v_pk_mul_f32 v[54:55], v[54:55], v[8:9] op_sel:[0,1] op_sel_hi:[1,1]
  v_pk_mul_f32 v[56:57], v[56:57], v[8:9] op_sel:[0,1] op_sel_hi:[1,1]
  v_pk_mul_f32 v[58:59], v[58:59], v[8:9] op_sel:[0,1] op_sel_hi:[1,1]
  v_cvt_pk_bf16_f32 v20, v48, v49
  v_cvt_pk_bf16_f32 v21, v50, v51
  v_cvt_pk_bf16_f32 v22, v52, v53
  v_cvt_pk_bf16_f32 v23, v54, v55
  v_cvt_pk_bf16_f32 v26, v56, v57
  v_cvt_pk_bf16_f32 v27, v58, v59
  s_cmp_eq_u32 s86, 0
  s_cbranch_scc1 Lfar_61
  buffer_store_dwordx4 v[16:19], v12, s[12:15], s53 offen offset:0
  buffer_store_dwordx4 v[20:23], v12, s[12:15], s53 offen offset:1024
  s_not_b64 exec, s[44:45]
  buffer_store_dwordx4 v[24:27], v2, s[12:15], s53 offen offset:2048
Lnear_62:
  s_mov_b64 exec, -1
  s_nop 0
  s_lshl_b32 s61, s40, 7
  s_lshl_b32 s51, s36, 5
  s_add_u32 s51, s51, s61
  s_add_u32 s51, s51, 4096
  s_lshl2_add_u32 s61, s47, s61
  s_add_u32 s61, s61, 29102080
  v_and_b32 v7, 7, v1
  v_lshl_add_u32 v7, v7, 2, s51
  s_mul_i32 s48, s40, 163840
  s_mul_i32 s54, s36, 20480
  s_add_u32 s48, s48, s54
  s_xor_b32 s53, s36, 1
  s_xor_b32 s56, s93, 1
  s_lshl_b32 s56, s56, 9
  s_add_u32 s56, s56, s48
  s_mul_i32 s53, s53, 5120
  s_add_u32 s53, s53, 143360
  v_add_u32 v34, s53, v2
  s_xor_b32 s53, s36, 2
  s_xor_b32 s57, s93, 2
  s_lshl_b32 s57, s57, 9
  s_add_u32 s57, s57, s48
  s_mul_i32 s53, s53, 35840
  s_add_u32 s53, s53, 25600
  v_add_u32 v35, s53, v2
  s_xor_b32 s53, s36, 3
  s_xor_b32 s58, s93, 3
  s_lshl_b32 s58, s58, 9
  s_add_u32 s58, s58, s48
  s_mul_i32 s53, s53, 35840
  s_add_u32 s53, s53, 30720
  v_add_u32 v36, s53, v2
  s_xor_b32 s53, s36, 0
  s_xor_b32 s59, s93, 0
  s_lshl_b32 s59, s59, 9
  s_add_u32 s59, s59, s48
  s_mul_i32 s53, s53, 5120
  s_add_u32 s53, s53, 143360
  v_add_u32 v37, s53, v2
  v_lshrrev_b32 v32, 5, v1
  v_lshl_add_u32 v45, v32, 11, v2
  v_add_u32 v46, 5120, v45
  v_add_u32 v47, 10240, v45
  v_add_u32 v48, 15360, v45
  s_and_b32 s55, s93, 1
  s_lshl_b32 s55, s55, 8
  s_xor_b32 s54, s55, 256
  s_add_u32 s54, s54, s48
  s_add_u32 s55, s55, s48
  s_lshr_b32 s53, s93, 1
  s_cselect_b64 s[62:63], -1, 0
  s_mul_i32 s53, s53, 2560
  s_sub_u32 s52, 2560, s53
  v_lshrrev_b32 v32, 4, v1
  v_mul_u32_u24 v32, 4864, v32
  v_add3_u32 v33, v32, v2, s52
  v_add3_u32 v32, v32, v2, s53
  s_add_u32 s53, s95, 25600
  v_add_u32 v44, s53, v2
  v_and_b32 v38, 15, v1
  v_mul_u32_u24 v38, 160, v38
  v_add_u32 v38, s53, v38
  v_lshrrev_b32 v39, 4, v1
  v_lshl_add_u32 v40, v39, 4, v38
  v_lshl_add_u32 v39, v39, 3, v38
  s_waitcnt vmcnt(20)
  ds_read_b128 v[226:229], v40 offset:7168
  ds_read_b128 v[230:233], v40 offset:7232
  ds_read_b64 v[234:235], v39 offset:7296
  s_waitcnt vmcnt(0)
  v_mov_b32 v254, s37
  s_cmp_eq_u32 s86, 0
  s_mov_b64 exec, 1
  s_cbranch_scc1 Lfar_68
  buffer_store_dword v254, off, s[12:15], s61
Lnear_69:
  s_mov_b64 exec, -1
  s_waitcnt lgkmcnt(0)
  s_barrier
  s_mov_b32 s60, 200000
Lpl_70:
  buffer_load_dword v254, v7, s[12:15], s94 offen sc1
  s_sub_u32 s60, s60, 1
  s_cbranch_scc1 Lpd_71
  s_waitcnt vmcnt(0)
  v_cmp_ne_u32 vcc, s37, v254
  s_nop 3
  s_cbranch_vccnz Lpl_70
Lpd_71:
  s_waitcnt vmcnt(0)
  buffer_load_dwordx4 v[64:67], v45, s[12:15], s56 offen sc1
  buffer_load_dwordx4 v[68:71], v46, s[12:15], s56 offen sc1
  buffer_load_dwordx4 v[72:75], v47, s[12:15], s56 offen sc1
  buffer_load_dwordx4 v[76:79], v48, s[12:15], s56 offen sc1
  buffer_load_dwordx4 v[128:131], v32, s[12:15], s54 offen offset:2048 sc1
  buffer_load_dwordx4 v[132:135], v33, s[12:15], s54 offen offset:2048 sc1
  s_lshl2_add_u32 s48, s40, s93
  s_mul_i32 s49, s48, 20480
  s_mul_i32 s50, s41, 2560
  s_add_u32 s49, s49, s50
  s_add_u32 s49, s49, 10485760
  s_lshl3_add_u32 s50, s48, s41
  s_lshl_b32 s50, s50, 7
  s_add_u32 s61, s50, 29392896
  s_lshl3_add_u32 s61, s40, s41
  s_lshl_b32 s61, s61, 7
  s_add_u32 s61, s61, 29392896
  s_add_u32 s50, s50, 13107200
  v_and_b32 v38, 15, v1
  v_lshrrev_b32 v39, 5, v1
  v_lshl_add_u32 v38, v39, 4, v38
  v_lshlrev_b32 v39, 4, v38
  v_lshlrev_b32 v38, 2, v38
  s_mov_b32 s52, 0xffff
  s_mov_b32 s53, 0xffff
  v_lshlrev_b32 v204, 16, v226
  v_and_b32 v205, s46, v226
  v_lshlrev_b32 v206, 16, v227
  v_and_b32 v207, s46, v227
  v_lshlrev_b32 v208, 16, v228
  v_and_b32 v209, s46, v228
  v_lshlrev_b32 v210, 16, v229
  v_and_b32 v211, s46, v229
  v_lshlrev_b32 v212, 16, v230
  v_and_b32 v213, s46, v230
  v_lshlrev_b32 v214, 16, v231
  v_and_b32 v215, s46, v231
  v_lshlrev_b32 v216, 16, v232
  v_and_b32 v217, s46, v232
  v_lshlrev_b32 v218, 16, v233
  v_and_b32 v219, s46, v233
  v_lshlrev_b32 v220, 16, v234
  v_and_b32 v221, s46, v234
  v_lshlrev_b32 v222, 16, v235
  v_and_b32 v223, s46, v235
  s_waitcnt vmcnt(5)
  v_mfma_f32_16x16x32_bf16 v[144:147], a[156:159], v[64:67], 0
  buffer_load_dwordx4 v[80:83], v45, s[12:15], s57 offen sc1
  v_mfma_f32_16x16x32_bf16 v[148:151], a[160:163], v[64:67], 0
  v_mfma_f32_16x16x32_bf16 v[152:155], a[164:167], v[64:67], 0
  v_mfma_f32_16x16x32_bf16 v[156:159], a[168:171], v[64:67], 0
  v_mfma_f32_16x16x32_bf16 v[160:163], a[172:175], v[64:67], 0
  buffer_load_dwordx4 v[84:87], v46, s[12:15], s57 offen sc1
  s_waitcnt vmcnt(6)
  v_mfma_f32_16x16x32_bf16 v[144:147], a[176:179], v[68:71], v[144:147]
  v_mfma_f32_16x16x32_bf16 v[148:151], a[180:183], v[68:71], v[148:151]
  v_mfma_f32_16x16x32_bf16 v[152:155], a[184:187], v[68:71], v[152:155]
  v_mfma_f32_16x16x32_bf16 v[156:159], a[188:191], v[68:71], v[156:159]
  buffer_load_dwordx4 v[88:91], v47, s[12:15], s57 offen sc1
  v_mfma_f32_16x16x32_bf16 v[160:163], a[192:195], v[68:71], v[160:163]
  s_waitcnt vmcnt(6)
  v_mfma_f32_16x16x32_bf16 v[144:147], a[196:199], v[72:75], v[144:147]
  v_mfma_f32_16x16x32_bf16 v[148:151], a[200:203], v[72:75], v[148:151]
  v_mfma_f32_16x16x32_bf16 v[152:155], a[204:207], v[72:75], v[152:155]
  buffer_load_dwordx4 v[92:95], v48, s[12:15], s57 offen sc1
  v_mfma_f32_16x16x32_bf16 v[156:159], a[208:211], v[72:75], v[156:159]
  v_mfma_f32_16x16x32_bf16 v[160:163], a[212:215], v[72:75], v[160:163]
  s_waitcnt vmcnt(6)
  v_mfma_f32_16x16x32_bf16 v[144:147], a[216:219], v[76:79], v[144:147]
  v_mfma_f32_16x16x32_bf16 v[148:151], a[220:223], v[76:79], v[148:151]
  buffer_load_dwordx4 v[136:139], v32, s[12:15], s55 offen offset:2048 sc1
  v_mfma_f32_16x16x32_bf16 v[152:155], a[224:227], v[76:79], v[152:155]
  s_not_b64 exec, s[62:63]
  s_waitcnt vmcnt(5)
  v_swap_b32 v130, v132
  v_swap_b32 v131, v133
  s_mov_b64 exec, s[62:63]
  v_swap_b32 v128, v134
  v_swap_b32 v129, v135
  s_mov_b64 exec, -1
  v_mfma_f32_16x16x32_bf16 v[156:159], a[228:231], v[76:79], v[156:159]
  v_mfma_f32_16x16x32_bf16 v[160:163], a[232:235], v[76:79], v[160:163]
  v_mfma_f32_16x16x32_bf16 v[144:147], a[236:239], v[128:131], v[144:147]
  buffer_load_dwordx4 v[140:143], v33, s[12:15], s55 offen offset:2048 sc1
  v_mfma_f32_16x16x32_bf16 v[148:151], a[240:243], v[128:131], v[148:151]
  v_mfma_f32_16x16x32_bf16 v[152:155], a[244:247], v[128:131], v[152:155]
  v_mfma_f32_16x16x32_bf16 v[156:159], a[248:251], v[128:131], v[156:159]
  v_mfma_f32_16x16x32_bf16 v[160:163], a[252:255], v[128:131], v[160:163]
  buffer_load_dwordx4 v[96:99], v45, s[12:15], s58 offen sc1
  s_waitcnt vmcnt(6)
  v_mfma_f32_16x16x32_bf16 v[164:167], a[156:159], v[80:83], 0
  v_mfma_f32_16x16x32_bf16 v[168:171], a[160:163], v[80:83], 0
  v_mfma_f32_16x16x32_bf16 v[172:175], a[164:167], v[80:83], 0
  v_mfma_f32_16x16x32_bf16 v[176:179], a[168:171], v[80:83], 0
  buffer_load_dwordx4 v[100:103], v46, s[12:15], s58 offen sc1
  ds_write_b128 v34, v[144:147] offset:0
  v_mfma_f32_16x16x32_bf16 v[180:183], a[172:175], v[80:83], 0
  s_waitcnt vmcnt(6)
  v_mfma_f32_16x16x32_bf16 v[164:167], a[176:179], v[84:87], v[164:167]
  v_mfma_f32_16x16x32_bf16 v[168:171], a[180:183], v[84:87], v[168:171]
  v_mfma_f32_16x16x32_bf16 v[172:175], a[184:187], v[84:87], v[172:175]
  buffer_load_dwordx4 v[104:107], v47, s[12:15], s58 offen sc1
  ds_write_b128 v34, v[148:151] offset:1024
  v_mfma_f32_16x16x32_bf16 v[176:179], a[188:191], v[84:87], v[176:179]
  v_mfma_f32_16x16x32_bf16 v[180:183], a[192:195], v[84:87], v[180:183]
  s_waitcnt vmcnt(6)
  v_mfma_f32_16x16x32_bf16 v[164:167], a[196:199], v[88:91], v[164:167]
  v_mfma_f32_16x16x32_bf16 v[168:171], a[200:203], v[88:91], v[168:171]
  buffer_load_dwordx4 v[108:111], v48, s[12:15], s58 offen sc1
  ds_write_b128 v34, v[152:155] offset:2048
  v_mfma_f32_16x16x32_bf16 v[172:175], a[204:207], v[88:91], v[172:175]
  v_mfma_f32_16x16x32_bf16 v[176:179], a[208:211], v[88:91], v[176:179]
  v_mfma_f32_16x16x32_bf16 v[180:183], a[212:215], v[88:91], v[180:183]
  s_waitcnt vmcnt(6)
  v_mfma_f32_16x16x32_bf16 v[164:167], a[216:219], v[92:95], v[164:167]
  buffer_load_dwordx4 v[112:115], v45, s[12:15], s59 offen sc1
  ds_write_b128 v34, v[156:159] offset:3072
  v_mfma_f32_16x16x32_bf16 v[168:171], a[220:223], v[92:95], v[168:171]
  v_mfma_f32_16x16x32_bf16 v[172:175], a[224:227], v[92:95], v[172:175]
  s_not_b64 exec, s[62:63]
  s_waitcnt vmcnt(5)
  v_swap_b32 v138, v140
  v_swap_b32 v139, v141
  s_mov_b64 exec, s[62:63]
  v_swap_b32 v136, v142
  v_swap_b32 v137, v143
  s_mov_b64 exec, -1
  v_mfma_f32_16x16x32_bf16 v[176:179], a[228:231], v[92:95], v[176:179]
  v_mfma_f32_16x16x32_bf16 v[180:183], a[232:235], v[92:95], v[180:183]
  buffer_load_dwordx4 v[116:119], v46, s[12:15], s59 offen sc1
  ds_write_b128 v34, v[160:163] offset:4096
  v_mfma_f32_16x16x32_bf16 v[164:167], a[236:239], v[140:143], v[164:167]
  v_mfma_f32_16x16x32_bf16 v[168:171], a[240:243], v[140:143], v[168:171]
  v_mfma_f32_16x16x32_bf16 v[172:175], a[244:247], v[140:143], v[172:175]
  v_mfma_f32_16x16x32_bf16 v[176:179], a[248:251], v[140:143], v[176:179]
  buffer_load_dwordx4 v[120:123], v47, s[12:15], s59 offen sc1
  v_mfma_f32_16x16x32_bf16 v[180:183], a[252:255], v[140:143], v[180:183]
  s_waitcnt vmcnt(6)
  v_mfma_f32_16x16x32_bf16 v[144:147], a[156:159], v[96:99], 0
  v_mfma_f32_16x16x32_bf16 v[148:151], a[160:163], v[96:99], 0
  v_mfma_f32_16x16x32_bf16 v[152:155], a[164:167], v[96:99], 0
  buffer_load_dwordx4 v[124:127], v48, s[12:15], s59 offen sc1
  v_mfma_f32_16x16x32_bf16 v[156:159], a[168:171], v[96:99], 0
  ds_write_b128 v35, v[164:167] offset:0
  v_mfma_f32_16x16x32_bf16 v[160:163], a[172:175], v[96:99], 0
  s_waitcnt vmcnt(6)
  v_mfma_f32_16x16x32_bf16 v[144:147], a[176:179], v[100:103], v[144:147]
  v_mfma_f32_16x16x32_bf16 v[148:151], a[180:183], v[100:103], v[148:151]
  s_add_u32 m0, s95, 12288
  s_nop 0
  global_load_lds_dwordx4 v251, s[12:13] offset:2048 sc1
  v_mfma_f32_16x16x32_bf16 v[152:155], a[184:187], v[100:103], v[152:155]
  ds_write_b128 v35, v[168:171] offset:1024
  v_mfma_f32_16x16x32_bf16 v[156:159], a[188:191], v[100:103], v[156:159]
  v_mfma_f32_16x16x32_bf16 v[160:163], a[192:195], v[100:103], v[160:163]
  s_waitcnt vmcnt(6)
  v_mfma_f32_16x16x32_bf16 v[144:147], a[196:199], v[104:107], v[144:147]
  global_load_lds_dwordx4 v251, s[12:13] offset:3072 sc1
  v_mfma_f32_16x16x32_bf16 v[148:151], a[200:203], v[104:107], v[148:151]
  ds_write_b128 v35, v[172:175] offset:2048
  v_mfma_f32_16x16x32_bf16 v[152:155], a[204:207], v[104:107], v[152:155]
  v_mfma_f32_16x16x32_bf16 v[156:159], a[208:211], v[104:107], v[156:159]
  v_mfma_f32_16x16x32_bf16 v[160:163], a[212:215], v[104:107], v[160:163]
  s_add_u32 m0, s95, 16384
  v_add_u32 v251, 4096, v251
  global_load_lds_dwordx4 v251, s[12:13] offset:0 sc1
  s_waitcnt vmcnt(7)
  v_mfma_f32_16x16x32_bf16 v[144:147], a[216:219], v[108:111], v[144:147]
  ds_write_b128 v35, v[176:179] offset:3072
  v_mfma_f32_16x16x32_bf16 v[148:151], a[220:223], v[108:111], v[148:151]
  v_mfma_f32_16x16x32_bf16 v[152:155], a[224:227], v[108:111], v[152:155]
  v_mfma_f32_16x16x32_bf16 v[156:159], a[228:231], v[108:111], v[156:159]
  global_load_lds_dwordx4 v251, s[12:13] offset:1024 sc1
  v_mfma_f32_16x16x32_bf16 v[160:163], a[232:235], v[108:111], v[160:163]
  ds_write_b128 v35, v[180:183] offset:4096
  v_mfma_f32_16x16x32_bf16 v[144:147], a[236:239], v[132:135], v[144:147]
  v_mfma_f32_16x16x32_bf16 v[148:151], a[240:243], v[132:135], v[148:151]
  v_mfma_f32_16x16x32_bf16 v[152:155], a[244:247], v[132:135], v[152:155]
  global_load_lds_dwordx4 v251, s[12:13] offset:2048 sc1
  v_mfma_f32_16x16x32_bf16 v[156:159], a[248:251], v[132:135], v[156:159]
  v_mfma_f32_16x16x32_bf16 v[160:163], a[252:255], v[132:135], v[160:163]
  s_waitcnt vmcnt(8)
  v_mfma_f32_16x16x32_bf16 v[204:207], a[156:159], v[112:115], v[204:207]
  v_mfma_f32_16x16x32_bf16 v[208:211], a[160:163], v[112:115], v[208:211]
  global_load_lds_dwordx4 v251, s[12:13] offset:3072 sc1
  v_mfma_f32_16x16x32_bf16 v[212:215], a[164:167], v[112:115], v[212:215]
  v_mfma_f32_16x16x32_bf16 v[216:219], a[168:171], v[112:115], v[216:219]
  ds_write_b128 v36, v[144:147] offset:0
  v_mfma_f32_16x16x32_bf16 v[220:223], a[172:175], v[112:115], v[220:223]
  s_waitcnt vmcnt(8)
  v_mfma_f32_16x16x32_bf16 v[204:207], a[176:179], v[116:119], v[204:207]
  s_add_u32 m0, s95, 20480
  v_add_u32 v251, 4096, v251
  global_load_lds_dwordx4 v251, s[12:13] offset:0 sc1
  ds_write_b128 v36, v[148:151] offset:1024
  v_mfma_f32_16x16x32_bf16 v[208:211], a[180:183], v[116:119], v[208:211]
  v_mfma_f32_16x16x32_bf16 v[212:215], a[184:187], v[116:119], v[212:215]
  ds_write_b128 v36, v[152:155] offset:2048
  v_mfma_f32_16x16x32_bf16 v[216:219], a[188:191], v[116:119], v[216:219]
  v_mfma_f32_16x16x32_bf16 v[220:223], a[192:195], v[116:119], v[220:223]
  global_load_lds_dwordx4 v251, s[12:13] offset:1024 sc1
  ds_write_b128 v36, v[156:159] offset:3072
  s_waitcnt vmcnt(9)
  v_mfma_f32_16x16x32_bf16 v[204:207], a[196:199], v[120:123], v[204:207]
  v_mfma_f32_16x16x32_bf16 v[208:211], a[200:203], v[120:123], v[208:211]
  ds_write_b128 v36, v[160:163] offset:4096
  v_mfma_f32_16x16x32_bf16 v[212:215], a[204:207], v[120:123], v[212:215]
  v_mfma_f32_16x16x32_bf16 v[216:219], a[208:211], v[120:123], v[216:219]
  global_load_lds_dwordx4 v251, s[12:13] offset:2048 sc1
  v_mfma_f32_16x16x32_bf16 v[220:223], a[212:215], v[120:123], v[220:223]
  s_waitcnt lgkmcnt(0)
  s_barrier
  s_waitcnt vmcnt(9)
  v_mfma_f32_16x16x32_bf16 v[204:207], a[216:219], v[124:127], v[204:207]
  ds_read_b128 v[184:187], v37 offset:0
  ds_read_b128 v[188:191], v37 offset:1024
  v_mfma_f32_16x16x32_bf16 v[208:211], a[220:223], v[124:127], v[208:211]
  ds_read_b128 v[192:195], v37 offset:2048
  v_mfma_f32_16x16x32_bf16 v[212:215], a[224:227], v[124:127], v[212:215]
  global_load_lds_dwordx4 v251, s[12:13] offset:3072 sc1
  ds_read_b128 v[196:199], v37 offset:3072
  ds_read_b128 v[200:203], v37 offset:4096
  v_mfma_f32_16x16x32_bf16 v[216:219], a[228:231], v[124:127], v[216:219]
  ds_read_b128 v[64:67], v44 offset:0
  v_mfma_f32_16x16x32_bf16 v[220:223], a[232:235], v[124:127], v[220:223]
  ds_read_b128 v[68:71], v44 offset:1024
  ds_read_b128 v[72:75], v44 offset:2048
  v_mfma_f32_16x16x32_bf16 v[204:207], a[236:239], v[136:139], v[204:207]
  ds_read_b128 v[76:79], v44 offset:3072
  v_mfma_f32_16x16x32_bf16 v[208:211], a[240:243], v[136:139], v[208:211]
  s_add_u32 m0, s95, 24576
  v_add_u32 v251, 4096, v251
  global_load_lds_dwordx4 v251, s[12:13] offset:0 sc1
  ds_read_b128 v[80:83], v44 offset:4096
  ds_read_b128 v[84:87], v44 offset:5120
  v_mfma_f32_16x16x32_bf16 v[212:215], a[244:247], v[136:139], v[212:215]
  ds_read_b128 v[88:91], v44 offset:6144
  v_mfma_f32_16x16x32_bf16 v[216:219], a[248:251], v[136:139], v[216:219]
  ds_read_b128 v[92:95], v44 offset:7168
  ds_read_b128 v[96:99], v44 offset:8192
  v_mfma_f32_16x16x32_bf16 v[220:223], a[252:255], v[136:139], v[220:223]
  ds_read_b128 v[100:103], v44 offset:9216
  s_waitcnt lgkmcnt(9)
  v_pk_add_f32 v[64:65], v[184:185], v[64:65]
  v_pk_add_f32 v[66:67], v[186:187], v[66:67]
  s_waitcnt lgkmcnt(8)
  v_pk_add_f32 v[68:69], v[188:189], v[68:69]
  v_pk_add_f32 v[70:71], v[190:191], v[70:71]
  s_waitcnt lgkmcnt(7)
  v_pk_add_f32 v[72:73], v[192:193], v[72:73]
  v_pk_add_f32 v[74:75], v[194:195], v[74:75]
  s_waitcnt lgkmcnt(6)
  v_pk_add_f32 v[76:77], v[196:197], v[76:77]
  v_pk_add_f32 v[78:79], v[198:199], v[78:79]
  s_waitcnt lgkmcnt(5)
  v_pk_add_f32 v[80:81], v[200:201], v[80:81]
  v_pk_add_f32 v[82:83], v[202:203], v[82:83]
  v_pk_add_f32 v[204:205], v[204:205], v[64:65]
  v_pk_add_f32 v[206:207], v[206:207], v[66:67]
  v_pk_add_f32 v[208:209], v[208:209], v[68:69]
  v_pk_add_f32 v[210:211], v[210:211], v[70:71]
  s_waitcnt lgkmcnt(4)
  v_pk_add_f32 v[204:205], v[204:205], v[84:85]
  v_pk_add_f32 v[206:207], v[206:207], v[86:87]
  s_waitcnt lgkmcnt(3)
  v_pk_add_f32 v[208:209], v[208:209], v[88:89]
  v_pk_add_f32 v[210:211], v[210:211], v[90:91]
  v_cvt_pk_bf16_f32 v236, v204, v205
  v_cvt_pk_bf16_f32 v237, v206, v207
  v_cvt_pk_bf16_f32 v238, v208, v209
  v_cvt_pk_bf16_f32 v239, v210, v211
  buffer_store_dwordx4 v[236:239], v2, s[12:15], s49 offen offset:0 sc1
  v_pk_add_f32 v[212:213], v[212:213], v[72:73]
  v_pk_add_f32 v[214:215], v[214:215], v[74:75]
  v_pk_add_f32 v[216:217], v[216:217], v[76:77]
  v_pk_add_f32 v[218:219], v[218:219], v[78:79]
  s_waitcnt lgkmcnt(2)
  v_pk_add_f32 v[212:213], v[212:213], v[92:93]
  v_pk_add_f32 v[214:215], v[214:215], v[94:95]
  s_waitcnt lgkmcnt(1)
  v_pk_add_f32 v[216:217], v[216:217], v[96:97]
  v_pk_add_f32 v[218:219], v[218:219], v[98:99]
  v_cvt_pk_bf16_f32 v240, v212, v213
  v_cvt_pk_bf16_f32 v241, v214, v215
  v_cvt_pk_bf16_f32 v242, v216, v217
  v_cvt_pk_bf16_f32 v243, v218, v219
  buffer_store_dwordx4 v[240:243], v2, s[12:15], s49 offen offset:1024 sc1
  v_pk_add_f32 v[220:221], v[220:221], v[80:81]
  v_pk_add_f32 v[222:223], v[222:223], v[82:83]
  s_waitcnt lgkmcnt(0)
  v_pk_add_f32 v[220:221], v[220:221], v[100:101]
  v_pk_add_f32 v[222:223], v[222:223], v[102:103]
  v_cvt_pk_bf16_f32 v244, v220, v221
  v_cvt_pk_bf16_f32 v245, v222, v223
  v_mov_b32 v184, v244
  v_mov_b32 v185, v245
  v_mov_b32 v186, v244
  v_mov_b32 v187, v245
  v_pk_add_f32 v[40:41], v[204:205], v[206:207]
  v_pk_mul_f32 v[42:43], v[204:205], v[204:205]
  v_permlane16_swap_b32 v184, v186
  v_permlane16_swap_b32 v185, v187
  s_mov_b64 exec, s[52:53]
  buffer_store_dwordx4 v[184:187], v39, s[12:15], s49 offen offset:2048 sc1
  s_mov_b64 exec, -1
  v_pk_fma_f32 v[42:43], v[206:207], v[206:207], v[42:43]
  v_pk_add_f32 v[40:41], v[40:41], v[208:209]
  v_pk_fma_f32 v[42:43], v[208:209], v[208:209], v[42:43]
  v_pk_add_f32 v[40:41], v[40:41], v[210:211]
  v_pk_fma_f32 v[42:43], v[210:211], v[210:211], v[42:43]
  v_pk_add_f32 v[40:41], v[40:41], v[212:213]
  v_pk_fma_f32 v[42:43], v[212:213], v[212:213], v[42:43]
  v_pk_add_f32 v[40:41], v[40:41], v[214:215]
  v_pk_fma_f32 v[42:43], v[214:215], v[214:215], v[42:43]
  v_pk_add_f32 v[40:41], v[40:41], v[216:217]
  v_pk_fma_f32 v[42:43], v[216:217], v[216:217], v[42:43]
  v_pk_add_f32 v[40:41], v[40:41], v[218:219]
  v_pk_fma_f32 v[42:43], v[218:219], v[218:219], v[42:43]
  v_pk_add_f32 v[40:41], v[40:41], v[220:221]
  v_pk_fma_f32 v[42:43], v[220:221], v[220:221], v[42:43]
  v_pk_add_f32 v[40:41], v[40:41], v[222:223]
  v_pk_fma_f32 v[42:43], v[222:223], v[222:223], v[42:43]
  v_add_f32 v40, v40, v41
  v_add_f32 v42, v42, v43
  s_nop 1
  v_permlane32_swap_b32 v40, v42
  v_add_f32 v40, v40, v42
  v_mov_b32 v42, v40
  s_nop 1
  v_permlane16_swap_b32 v40, v42
  v_add_f32 v40, v40, v42
  s_mov_b64 exec, s[52:53]
  buffer_store_dword v40, v38, s[12:15], s50 offen sc1
  s_mov_b64 exec, -1
  s_mov_b32 s48, s3
  s_mul_i32 s54, s48, 40960
  s_add_u32 s54, s54, 10489856
  v_add_u32 v232, s54, v2
  v_add_u32 v233, 20480, v232
  s_lshl_b32 s56, s48, 11
  s_add_u32 s56, s56, 13107200
  v_and_b32 v8, 31, v1
  v_lshrrev_b32 v9, 5, v1
  v_lshlrev_b32 v8, 2, v8
  v_lshl_add_u32 v8, v9, 10, v8
  v_add_u32 v10, 64512, v2
  v_add_u32 v11, 129024, v2
  v_and_b32 v12, 48, v1
  v_add_u32 v12, 143360, v12
  s_mul_i32 s57, s36, 5120
  v_add_u32 v13, s57, v12
  s_andn2_b32 s57, s40, 4
  s_lshl_b32 s57, s57, 10
  s_add_u32 s57, s57, 294912
  v_and_b32 v7, 8, v1
  v_mul_u32_u24 v7, 4, v7
  v_and_or_b32 v7, v1, 7, v7
  v_lshl_add_u32 v7, v7, 7, s57
  s_lshl_b32 s57, s36, 10
  v_add_u32 v52, s57, v2
  v_add_u32 v53, 64512, v52
  v_add_u32 v54, 129024, v52
  v_mov_b32 v56, 0x3f803f80
  v_mov_b32 v57, 0x3f803f80
  v_mov_b32 v58, 0x3f803f80
  v_mov_b32 v59, 0x3f803f80
  s_waitcnt vmcnt(0)
  s_waitcnt lgkmcnt(0)
  s_barrier
  s_cmp_ge_u32 s36, 3
  s_cbranch_scc0 Low_72
  v_mov_b32 v254, s37
  v_lshlrev_b32 v253, 2, v1
  s_not_b64 exec, s[44:45]
  buffer_store_dword v254, v253, s[12:15], s61 offen sc1
  s_mov_b64 exec, -1
Low_72:
  ds_read_b128 v[64:67], v52 offset:0
  ds_read_b128 v[68:71], v52 offset:4096
  ds_read_b128 v[72:75], v52 offset:7168
  ds_read_b128 v[76:79], v52 offset:11264
  ds_read_b128 v[80:83], v52 offset:14336
  ds_read_b128 v[84:87], v52 offset:18432
  ds_read_b128 v[88:91], v52 offset:35840
  ds_read_b128 v[92:95], v52 offset:39936
  ds_read_b128 v[96:99], v52 offset:43008
  ds_read_b128 v[100:103], v52 offset:47104
  s_waitcnt lgkmcnt(9)
  v_mfma_f32_16x16x32_bf16 v[24:27], v[64:67], v[56:59], 0
  ds_read_b128 v[104:107], v52 offset:50176
  s_waitcnt lgkmcnt(9)
  v_mfma_f32_16x16x32_bf16 v[28:31], v[68:71], v[56:59], 0
  s_add_u32 m0, s95, 24576
  s_nop 0
  global_load_lds_dwordx4 v251, s[12:13] offset:1024 sc1
  ds_read_b128 v[108:111], v52 offset:54272
  s_waitcnt lgkmcnt(9)
  v_mfma_f32_16x16x32_bf16 v[24:27], v[72:75], v[56:59], v[24:27]
  ds_read_b128 v[112:115], v53 offset:7168
  s_waitcnt lgkmcnt(9)
  v_mfma_f32_16x16x32_bf16 v[28:31], v[76:79], v[56:59], v[28:31]
  global_load_lds_dwordx4 v251, s[12:13] offset:2048 sc1
  ds_read_b128 v[116:119], v53 offset:11264
  s_waitcnt lgkmcnt(9)
  v_mfma_f32_16x16x32_bf16 v[24:27], v[80:83], v[56:59], v[24:27]
  ds_read_b128 v[64:67], v53 offset:14336
  s_waitcnt lgkmcnt(9)
  v_mfma_f32_16x16x32_bf16 v[28:31], v[84:87], v[56:59], v[28:31]
  global_load_lds_dwordx4 v251, s[12:13] offset:3072 sc1
  ds_read_b128 v[68:71], v53 offset:18432
  s_waitcnt lgkmcnt(9)
  v_mfma_f32_16x16x32_bf16 v[24:27], v[88:91], v[56:59], v[24:27]
  ds_read_b128 v[72:75], v53 offset:21504
  s_waitcnt lgkmcnt(9)
  v_mfma_f32_16x16x32_bf16 v[28:31], v[92:95], v[56:59], v[28:31]
  s_add_u32 m0, s95, 28672
  v_add_u32 v251, 4096, v251
  global_load_lds_dwordx4 v251, s[12:13] offset:0 sc1
  ds_read_b128 v[76:79], v53 offset:25600
  s_waitcnt lgkmcnt(9)
  v_mfma_f32_16x16x32_bf16 v[24:27], v[96:99], v[56:59], v[24:27]
  ds_read_b128 v[80:83], v53 offset:43008
  s_waitcnt lgkmcnt(9)
  v_mfma_f32_16x16x32_bf16 v[28:31], v[100:103], v[56:59], v[28:31]
  global_load_lds_dwordx4 v251, s[12:13] offset:1024 sc1
  ds_read_b128 v[84:87], v53 offset:47104
  s_waitcnt lgkmcnt(9)
  v_mfma_f32_16x16x32_bf16 v[24:27], v[104:107], v[56:59], v[24:27]
  ds_read_b128 v[88:91], v53 offset:50176
  s_waitcnt lgkmcnt(9)
  v_mfma_f32_16x16x32_bf16 v[28:31], v[108:111], v[56:59], v[28:31]
  global_load_lds_dwordx4 v251, s[12:13] offset:2048 sc1
  ds_read_b128 v[92:95], v53 offset:54272
  s_waitcnt lgkmcnt(9)
  v_mfma_f32_16x16x32_bf16 v[24:27], v[112:115], v[56:59], v[24:27]
  ds_read_b128 v[96:99], v53 offset:57344
  s_waitcnt lgkmcnt(9)
  v_mfma_f32_16x16x32_bf16 v[28:31], v[116:119], v[56:59], v[28:31]
  global_load_lds_dwordx4 v251, s[12:13] offset:3072 sc1
  ds_read_b128 v[100:103], v53 offset:61440
  s_waitcnt lgkmcnt(9)
  v_mfma_f32_16x16x32_bf16 v[24:27], v[64:67], v[56:59], v[24:27]
  ds_read_b128 v[120:123], v2 offset:0
  s_waitcnt lgkmcnt(9)
  v_mfma_f32_16x16x32_bf16 v[28:31], v[68:71], v[56:59], v[28:31]
  s_add_u32 m0, s95, 32768
  v_add_u32 v251, 4096, v251
  global_load_lds_dwordx4 v251, s[12:13] offset:0 sc1
  ds_read_b128 v[124:127], v2 offset:1024
  s_waitcnt lgkmcnt(9)
  v_mfma_f32_16x16x32_bf16 v[24:27], v[72:75], v[56:59], v[24:27]
  ds_read_b128 v[128:131], v2 offset:2048
  s_waitcnt lgkmcnt(9)
  v_mfma_f32_16x16x32_bf16 v[28:31], v[76:79], v[56:59], v[28:31]
  global_load_lds_dwordx4 v251, s[12:13] offset:1024 sc1
  ds_read_b128 v[132:135], v2 offset:3072
  global_load_lds_dwordx4 v251, s[12:13] offset:2048 sc1
  s_cmp_lg_u32 s36, 1
  s_nop 2
  s_cbranch_scc1 Lw3_73
  s_mov_b32 s60, 200000
Lpl_74:
  buffer_load_dword v254, v7, s[12:15], s94 offen sc1
  s_sub_u32 s60, s60, 1
  s_cbranch_scc1 Lpd_75
  s_waitcnt vmcnt(0)
  v_cmp_ne_u32 vcc, s37, v254
  s_nop 3
  s_cbranch_vccnz Lpl_74
Lpd_75:
  s_waitcnt vmcnt(0)
Lw3_73:
  s_waitcnt vmcnt(0)
  s_barrier
  global_load_dwordx4 a[156:159], v232, s[12:13] offset:-4096 sc1
  global_load_dwordx4 a[160:163], v233, s[12:13] offset:-4096 sc1
  global_load_dwordx4 a[164:167], v232, s[12:13] offset:-3072 sc1
  global_load_dwordx4 a[168:171], v233, s[12:13] offset:-3072 sc1
  ds_read_b128 v[104:107], v52 offset:21504
  ds_read_b128 v[108:111], v52 offset:25600
  ds_read_b128 v[112:115], v52 offset:28672
  ds_read_b128 v[116:119], v52 offset:32768
  s_waitcnt lgkmcnt(13)
  v_mfma_f32_16x16x32_bf16 v[24:27], v[80:83], v[56:59], v[24:27]
  ds_read_b128 v[64:67], v52 offset:57344
  s_waitcnt lgkmcnt(13)
  v_mfma_f32_16x16x32_bf16 v[28:31], v[84:87], v[56:59], v[28:31]
  global_load_dwordx4 a[172:175], v232, s[12:13] offset:-2048 sc1
  ds_read_b128 v[68:71], v52 offset:61440
  s_waitcnt lgkmcnt(13)
  v_mfma_f32_16x16x32_bf16 v[24:27], v[88:91], v[56:59], v[24:27]
  ds_read_b128 v[72:75], v53 offset:0
  s_waitcnt lgkmcnt(13)
  v_mfma_f32_16x16x32_bf16 v[28:31], v[92:95], v[56:59], v[28:31]
  global_load_dwordx4 a[176:179], v233, s[12:13] offset:-2048 sc1
  ds_read_b128 v[76:79], v53 offset:4096
  s_waitcnt lgkmcnt(13)
  v_mfma_f32_16x16x32_bf16 v[24:27], v[96:99], v[56:59], v[24:27]
  ds_read_b128 v[80:83], v53 offset:28672
  s_waitcnt lgkmcnt(13)
  v_mfma_f32_16x16x32_bf16 v[28:31], v[100:103], v[56:59], v[28:31]
  global_load_dwordx4 a[180:183], v232, s[12:13] offset:-1024 sc1
  ds_read_b128 v[84:87], v53 offset:32768
  s_waitcnt lgkmcnt(9)
  v_mfma_f32_16x16x32_bf16 v[24:27], v[104:107], v[56:59], v[24:27]
  ds_read_b128 v[88:91], v53 offset:35840
  s_waitcnt lgkmcnt(9)
  v_mfma_f32_16x16x32_bf16 v[28:31], v[108:111], v[56:59], v[28:31]
  global_load_dwordx4 a[184:187], v233, s[12:13] offset:-1024 sc1
  ds_read_b128 v[92:95], v53 offset:39936
  s_waitcnt lgkmcnt(9)
  v_mfma_f32_16x16x32_bf16 v[24:27], v[112:115], v[56:59], v[24:27]
  ds_read_b128 v[96:99], v54 offset:0
  s_waitcnt lgkmcnt(9)
  v_mfma_f32_16x16x32_bf16 v[28:31], v[116:119], v[56:59], v[28:31]
  global_load_dwordx4 a[188:191], v232, s[12:13] offset:0 sc1
  ds_read_b128 v[100:103], v54 offset:4096
  s_waitcnt lgkmcnt(9)
  v_mfma_f32_16x16x32_bf16 v[24:27], v[64:67], v[56:59], v[24:27]
  ds_read_b128 v[104:107], v54 offset:7168
  s_waitcnt lgkmcnt(9)
  v_mfma_f32_16x16x32_bf16 v[28:31], v[68:71], v[56:59], v[28:31]
  global_load_dwordx4 a[192:195], v233, s[12:13] offset:0 sc1
  ds_read_b128 v[108:111], v54 offset:11264
  s_waitcnt lgkmcnt(9)
  v_mfma_f32_16x16x32_bf16 v[24:27], v[72:75], v[56:59], v[24:27]
  ds_read_b128 v[136:139], v2 offset:4096
  s_waitcnt lgkmcnt(9)
  v_mfma_f32_16x16x32_bf16 v[28:31], v[76:79], v[56:59], v[28:31]
  global_load_dwordx4 a[196:199], v232, s[12:13] offset:1024 sc1
  ds_read_b128 v[140:143], v2 offset:5120
  s_waitcnt lgkmcnt(9)
  v_mfma_f32_16x16x32_bf16 v[24:27], v[80:83], v[56:59], v[24:27]
  ds_read_b128 v[144:147], v2 offset:6144
  s_waitcnt lgkmcnt(9)
  v_mfma_f32_16x16x32_bf16 v[28:31], v[84:87], v[56:59], v[28:31]
  global_load_dwordx4 a[200:203], v233, s[12:13] offset:1024 sc1
  s_waitcnt lgkmcnt(8)
  v_mfma_f32_16x16x32_bf16 v[24:27], v[88:91], v[56:59], v[24:27]
  s_waitcnt lgkmcnt(7)
  v_mfma_f32_16x16x32_bf16 v[28:31], v[92:95], v[56:59], v[28:31]
  buffer_load_dword v16, v8, s[12:15], s56 offen offset:0 sc1
  s_waitcnt lgkmcnt(6)
  v_mfma_f32_16x16x32_bf16 v[24:27], v[96:99], v[56:59], v[24:27]
  s_waitcnt lgkmcnt(5)
  v_mfma_f32_16x16x32_bf16 v[28:31], v[100:103], v[56:59], v[28:31]
  buffer_load_dword v17, v8, s[12:15], s56 offen offset:128 sc1
  s_waitcnt lgkmcnt(4)
  v_mfma_f32_16x16x32_bf16 v[24:27], v[104:107], v[56:59], v[24:27]
  s_waitcnt lgkmcnt(3)
  v_mfma_f32_16x16x32_bf16 v[28:31], v[108:111], v[56:59], v[28:31]
  buffer_load_dword v18, v8, s[12:15], s56 offen offset:256 sc1
  buffer_load_dword v19, v8, s[12:15], s56 offen offset:384 sc1
  buffer_load_dword v20, v8, s[12:15], s56 offen offset:512 sc1
  buffer_load_dword v21, v8, s[12:15], s56 offen offset:640 sc1
  buffer_load_dword v22, v8, s[12:15], s56 offen offset:768 sc1
  buffer_load_dword v23, v8, s[12:15], s56 offen offset:896 sc1
  s_waitcnt vmcnt(19)
  v_mfma_f32_16x16x32_bf16 v[64:67], v[120:123], a[156:159], 0
  ds_read_b128 v[148:151], v2 offset:7168
  s_waitcnt vmcnt(18)
  v_mfma_f32_16x16x32_bf16 v[92:95], v[120:123], a[160:163], 0
  global_load_dwordx4 a[204:207], v232, s[12:13] offset:2048 sc1
  v_mfma_f32_16x16x32_bf16 v[68:71], v[124:127], a[156:159], 0
  ds_read_b128 v[152:155], v2 offset:8192
  v_mfma_f32_16x16x32_bf16 v[96:99], v[124:127], a[160:163], 0
  v_mfma_f32_16x16x32_bf16 v[72:75], v[128:131], a[156:159], 0
  ds_read_b128 v[156:159], v2 offset:9216
  v_mfma_f32_16x16x32_bf16 v[100:103], v[128:131], a[160:163], 0
  global_load_dwordx4 a[208:211], v233, s[12:13] offset:2048 sc1
  ds_write_b128 v13, v[24:27]
  v_mfma_f32_16x16x32_bf16 v[76:79], v[132:135], a[156:159], 0
  ds_read_b128 v[160:163], v2 offset:10240
  v_mfma_f32_16x16x32_bf16 v[104:107], v[132:135], a[160:163], 0
  s_waitcnt lgkmcnt(4)
  v_mfma_f32_16x16x32_bf16 v[80:83], v[136:139], a[156:159], 0
  ds_read_b128 v[164:167], v2 offset:11264
  v_mfma_f32_16x16x32_bf16 v[108:111], v[136:139], a[160:163], 0
  global_load_dwordx4 a[212:215], v232, s[12:13] offset:3072 sc1
  ds_write_b128 v13, v[28:31] offset:64
  v_mfma_f32_16x16x32_bf16 v[84:87], v[140:143], a[156:159], 0
  ds_read_b128 v[168:171], v2 offset:12288
  v_mfma_f32_16x16x32_bf16 v[112:115], v[140:143], a[160:163], 0
  v_mfma_f32_16x16x32_bf16 v[88:91], v[144:147], a[156:159], 0
  ds_read_b128 v[172:175], v2 offset:13312
  v_mfma_f32_16x16x32_bf16 v[116:119], v[144:147], a[160:163], 0
  global_load_dwordx4 a[216:219], v233, s[12:13] offset:3072 sc1
  s_waitcnt vmcnt(21)
  v_mfma_f32_16x16x32_bf16 v[64:67], v[148:151], a[164:167], v[64:67]
  ds_read_b128 v[120:123], v2 offset:14336
  s_waitcnt vmcnt(20)
  v_mfma_f32_16x16x32_bf16 v[92:95], v[148:151], a[168:171], v[92:95]
  s_waitcnt lgkmcnt(4)
  v_mfma_f32_16x16x32_bf16 v[68:71], v[152:155], a[164:167], v[68:71]
  ds_read_b128 v[124:127], v2 offset:15360
  v_add_u32 v232, 8192, v232
  v_mfma_f32_16x16x32_bf16 v[96:99], v[152:155], a[168:171], v[96:99]
  global_load_dwordx4 a[220:223], v232, s[12:13] offset:-4096 sc1
  v_mfma_f32_16x16x32_bf16 v[72:75], v[156:159], a[164:167], v[72:75]
  ds_read_b128 v[128:131], v2 offset:16384
  v_mfma_f32_16x16x32_bf16 v[100:103], v[156:159], a[168:171], v[100:103]
  v_mfma_f32_16x16x32_bf16 v[76:79], v[160:163], a[164:167], v[76:79]
  ds_read_b128 v[132:135], v2 offset:17408
  v_mfma_f32_16x16x32_bf16 v[104:107], v[160:163], a[168:171], v[104:107]
  v_mfma_f32_16x16x32_bf16 v[80:83], v[164:167], a[164:167], v[80:83]
  ds_read_b128 v[136:139], v2 offset:18432
  v_add_u32 v233, 8192, v233
  v_mfma_f32_16x16x32_bf16 v[108:111], v[164:167], a[168:171], v[108:111]
  global_load_dwordx4 a[224:227], v233, s[12:13] offset:-4096 sc1
  s_waitcnt lgkmcnt(3)
  v_mfma_f32_16x16x32_bf16 v[84:87], v[168:171], a[164:167], v[84:87]
  ds_read_b128 v[140:143], v2 offset:19456
  v_mfma_f32_16x16x32_bf16 v[112:115], v[168:171], a[168:171], v[112:115]
  v_mfma_f32_16x16x32_bf16 v[88:91], v[172:175], a[164:167], v[88:91]
  ds_read_b128 v[144:147], v2 offset:20480
  v_mfma_f32_16x16x32_bf16 v[116:119], v[172:175], a[168:171], v[116:119]
  global_load_dwordx4 a[228:231], v232, s[12:13] offset:-3072 sc1
  s_waitcnt vmcnt(22)
  v_mfma_f32_16x16x32_bf16 v[64:67], v[120:123], a[172:175], v[64:67]
  ds_read_b128 v[148:151], v2 offset:21504
  s_waitcnt vmcnt(21)
  v_mfma_f32_16x16x32_bf16 v[92:95], v[120:123], a[176:179], v[92:95]
  v_mfma_f32_16x16x32_bf16 v[68:71], v[124:127], a[172:175], v[68:71]
  ds_read_b128 v[152:155], v2 offset:22528
  v_mfma_f32_16x16x32_bf16 v[96:99], v[124:127], a[176:179], v[96:99]
  global_load_dwordx4 a[232:235], v233, s[12:13] offset:-3072 sc1
  s_waitcnt lgkmcnt(3)
  v_mfma_f32_16x16x32_bf16 v[72:75], v[128:131], a[172:175], v[72:75]
  ds_read_b128 v[156:159], v2 offset:23552
  v_mfma_f32_16x16x32_bf16 v[100:103], v[128:131], a[176:179], v[100:103]
  v_mfma_f32_16x16x32_bf16 v[76:79], v[132:135], a[172:175], v[76:79]
  ds_read_b128 v[160:163], v2 offset:24576
  v_mfma_f32_16x16x32_bf16 v[104:107], v[132:135], a[176:179], v[104:107]
  global_load_dwordx4 a[236:239], v232, s[12:13] offset:-2048 sc1
  v_mfma_f32_16x16x32_bf16 v[80:83], v[136:139], a[172:175], v[80:83]
  ds_read_b128 v[164:167], v2 offset:25600
  v_mfma_f32_16x16x32_bf16 v[108:111], v[136:139], a[176:179], v[108:111]
  v_mfma_f32_16x16x32_bf16 v[84:87], v[140:143], a[172:175], v[84:87]
  ds_read_b128 v[168:171], v2 offset:26624
  v_mfma_f32_16x16x32_bf16 v[112:115], v[140:143], a[176:179], v[112:115]
  global_load_dwordx4 a[240:243], v233, s[12:13] offset:-2048 sc1
  s_waitcnt lgkmcnt(3)
  v_mfma_f32_16x16x32_bf16 v[88:91], v[144:147], a[172:175], v[88:91]
  ds_read_b128 v[172:175], v2 offset:27648
  v_mfma_f32_16x16x32_bf16 v[116:119], v[144:147], a[176:179], v[116:119]
  s_waitcnt vmcnt(23)
  v_mfma_f32_16x16x32_bf16 v[64:67], v[148:151], a[180:183], v[64:67]
  ds_read_b128 v[120:123], v2 offset:28672
  s_waitcnt vmcnt(16)
  v_add_f32 v16, v16, v17
  v_mfma_f32_16x16x32_bf16 v[92:95], v[148:151], a[184:187], v[92:95]
  global_load_dwordx4 a[244:247], v232, s[12:13] offset:-1024 sc1
  s_waitcnt vmcnt(16)
  v_add_f32 v16, v16, v18
  v_mfma_f32_16x16x32_bf16 v[68:71], v[152:155], a[180:183], v[68:71]
  ds_read_b128 v[124:127], v2 offset:29696
  s_waitcnt vmcnt(15)
  v_add_f32 v16, v16, v19
  v_mfma_f32_16x16x32_bf16 v[96:99], v[152:155], a[184:187], v[96:99]
  s_waitcnt vmcnt(14)
  v_add_f32 v16, v16, v20
  v_mfma_f32_16x16x32_bf16 v[72:75], v[156:159], a[180:183], v[72:75]
  ds_read_b128 v[128:131], v2 offset:30720
  s_waitcnt vmcnt(13)
  v_add_f32 v16, v16, v21
  v_mfma_f32_16x16x32_bf16 v[100:103], v[156:159], a[184:187], v[100:103]
  global_load_dwordx4 a[248:251], v233, s[12:13] offset:-1024 sc1
  s_waitcnt vmcnt(13)
  v_add_f32 v16, v16, v22
  s_waitcnt lgkmcnt(3)
  v_mfma_f32_16x16x32_bf16 v[76:79], v[160:163], a[180:183], v[76:79]
  ds_read_b128 v[132:135], v2 offset:31744
  s_waitcnt vmcnt(12)
  v_add_f32 v16, v16, v23
  v_mfma_f32_16x16x32_bf16 v[104:107], v[160:163], a[184:187], v[104:107]
  v_mov_b32 v17, v16
  v_mfma_f32_16x16x32_bf16 v[80:83], v[164:167], a[180:183], v[80:83]
  ds_read_b128 v[136:139], v2 offset:32768
  v_permlane16_swap_b32 v16, v17
  v_mfma_f32_16x16x32_bf16 v[108:111], v[164:167], a[184:187], v[108:111]
  global_load_dwordx4 a[104:107], v232, s[12:13] offset:0 sc1
  v_mul_f32 v16, 0xbacccccd, v16
  v_mfma_f32_16x16x32_bf16 v[84:87], v[168:171], a[180:183], v[84:87]
  ds_read_b128 v[140:143], v2 offset:33792
  v_mul_f32 v17, 0x3acccccd, v17
  v_mfma_f32_16x16x32_bf16 v[112:115], v[168:171], a[184:187], v[112:115]
  v_fma_f32 v17, -v16, v16, v17
  v_mfma_f32_16x16x32_bf16 v[88:91], v[172:175], a[180:183], v[88:91]
  ds_read_b128 v[144:147], v2 offset:34816
  v_max_f32 v17, 0, v17
  v_mfma_f32_16x16x32_bf16 v[116:119], v[172:175], a[184:187], v[116:119]
  global_load_dwordx4 a[108:111], v233, s[12:13] offset:0 sc1
  v_add_f32 v17, 0x3727c5ac, v17
  s_waitcnt lgkmcnt(3)
  v_mfma_f32_16x16x32_bf16 v[64:67], v[120:123], a[188:191], v[64:67]
  ds_read_b128 v[148:151], v2 offset:35840
  v_rsq_f32 v17, v17
  v_mfma_f32_16x16x32_bf16 v[92:95], v[120:123], a[192:195], v[92:95]
  s_barrier
  v_mov_b32 v20, 0xbfb8aa3b
  v_mfma_f32_16x16x32_bf16 v[68:71], v[124:127], a[188:191], v[68:71]
  ds_read_b128 v[152:155], v2 offset:36864
  v_mov_b32 v21, 0xbfb8aa3b
  v_mfma_f32_16x16x32_bf16 v[96:99], v[124:127], a[192:195], v[96:99]
  global_load_dwordx4 a[112:115], v232, s[12:13] offset:1024 sc1
  ds_read_b128 v[36:39], v12 offset:15360
  v_mul_f32 v17, v20, v17
  v_mfma_f32_16x16x32_bf16 v[72:75], v[128:131], a[188:191], v[72:75]
  ds_read_b128 v[156:159], v2 offset:37888
  v_mov_b32 v18, v16
  v_mfma_f32_16x16x32_bf16 v[100:103], v[128:131], a[192:195], v[100:103]
  ds_read_b128 v[40:43], v12 offset:64
  v_mov_b32 v19, v17
  v_mfma_f32_16x16x32_bf16 v[76:79], v[132:135], a[188:191], v[76:79]
  ds_read_b128 v[160:163], v2 offset:38912
  v_permlane32_swap_b32 v16, v18
  v_mfma_f32_16x16x32_bf16 v[104:107], v[132:135], a[192:195], v[104:107]
  ds_read_b128 v[44:47], v12 offset:5184
  v_permlane32_swap_b32 v17, v19
  s_waitcnt lgkmcnt(6)
  v_mfma_f32_16x16x32_bf16 v[80:83], v[136:139], a[188:191], v[80:83]
  ds_read_b128 v[164:167], v2 offset:39936
  s_mul_i32 s49, s48, 114688
  v_mfma_f32_16x16x32_bf16 v[108:111], v[136:139], a[192:195], v[108:111]
  global_load_dwordx4 a[116:119], v233, s[12:13] offset:1024 sc1
  ds_read_b128 v[48:51], v12 offset:10304
  s_mul_i32 s50, s43, 3584
  v_mfma_f32_16x16x32_bf16 v[84:87], v[140:143], a[188:191], v[84:87]
  ds_read_b128 v[168:171], v2 offset:40960
  s_add_u32 s49, s49, s50
  v_mfma_f32_16x16x32_bf16 v[112:115], v[140:143], a[192:195], v[112:115]
  ds_read_b128 v[24:27], v12 offset:0
  s_add_u32 s49, s49, 13238272
  v_mfma_f32_16x16x32_bf16 v[88:91], v[144:147], a[188:191], v[88:91]
  ds_read_b128 v[172:175], v2 offset:41984
  s_add_u32 s50, s49, 57344
  v_mfma_f32_16x16x32_bf16 v[116:119], v[144:147], a[192:195], v[116:119]
  global_load_dwordx4 v[204:207], v232, s[12:13] offset:2048 sc1
  ds_read_b128 v[28:31], v12 offset:5120
  v_bfe_u32 v14, v1, 4, 1
  v_mfma_f32_16x16x32_bf16 v[64:67], v[148:151], a[196:199], v[64:67]
  ds_read_b128 v[120:123], v2 offset:43008
  v_mul_u32_u24 v14, 57344, v14
  v_mfma_f32_16x16x32_bf16 v[92:95], v[148:151], a[200:203], v[92:95]
  ds_read_b128 v[32:35], v12 offset:10240
  v_and_b32 v15, 15, v1
  s_waitcnt lgkmcnt(7)
  v_mfma_f32_16x16x32_bf16 v[68:71], v[152:155], a[196:199], v[68:71]
  ds_read_b128 v[124:127], v2 offset:44032
  v_lshl_add_u32 v14, v15, 4, v14
  v_mfma_f32_16x16x32_bf16 v[96:99], v[152:155], a[200:203], v[96:99]
  global_load_dwordx4 v[208:211], v233, s[12:13] offset:2048 sc1
  v_lshl_add_u32 v14, v9, 8, v14
  v_mfma_f32_16x16x32_bf16 v[72:75], v[156:159], a[196:199], v[72:75]
  ds_read_b128 v[128:131], v2 offset:45056
  s_lshl_b32 s61, s40, 7
  v_mfma_f32_16x16x32_bf16 v[100:103], v[156:159], a[200:203], v[100:103]
  s_lshl2_add_u32 s61, s47, s61
  v_mfma_f32_16x16x32_bf16 v[76:79], v[160:163], a[196:199], v[76:79]
  ds_read_b128 v[132:135], v2 offset:46080
  s_add_u32 s61, s61, 29114368
  v_mfma_f32_16x16x32_bf16 v[104:107], v[160:163], a[200:203], v[104:107]
  global_load_dwordx4 v[212:215], v232, s[12:13] offset:3072 sc1
  v_mfma_f32_16x16x32_bf16 v[80:83], v[164:167], a[196:199], v[80:83]
  ds_read_b128 v[136:139], v2 offset:47104
  v_mfma_f32_16x16x32_bf16 v[108:111], v[164:167], a[200:203], v[108:111]
  s_waitcnt lgkmcnt(3)
  v_mfma_f32_16x16x32_bf16 v[84:87], v[168:171], a[196:199], v[84:87]
  ds_read_b128 v[140:143], v2 offset:48128
  v_mfma_f32_16x16x32_bf16 v[112:115], v[168:171], a[200:203], v[112:115]
  global_load_dwordx4 v[216:219], v233, s[12:13] offset:3072 sc1
  v_mfma_f32_16x16x32_bf16 v[88:91], v[172:175], a[196:199], v[88:91]
  ds_read_b128 v[144:147], v2 offset:49152
  v_mfma_f32_16x16x32_bf16 v[116:119], v[172:175], a[200:203], v[116:119]
  s_waitcnt vmcnt(19)
  v_mfma_f32_16x16x32_bf16 v[64:67], v[120:123], a[204:207], v[64:67]
  ds_read_b128 v[148:151], v2 offset:50176
  v_fmac_f32 v104, v36, v18
  v_add_u32 v232, 8192, v232
  s_waitcnt vmcnt(18)
  v_mfma_f32_16x16x32_bf16 v[92:95], v[120:123], a[208:211], v[92:95]
  global_load_dwordx4 v[220:223], v232, s[12:13] offset:-4096 sc1
  v_fmac_f32 v80, v40, v16
  v_mfma_f32_16x16x32_bf16 v[68:71], v[124:127], a[204:207], v[68:71]
  ds_read_b128 v[152:155], v2 offset:51200
  v_fmac_f32 v108, v40, v18
  v_mfma_f32_16x16x32_bf16 v[96:99], v[124:127], a[208:211], v[96:99]
  v_fmac_f32 v84, v44, v16
  s_waitcnt lgkmcnt(3)
  v_mfma_f32_16x16x32_bf16 v[72:75], v[128:131], a[204:207], v[72:75]
  ds_read_b128 v[156:159], v2 offset:52224
  v_fmac_f32 v112, v44, v18
  v_add_u32 v233, 8192, v233
  v_mfma_f32_16x16x32_bf16 v[100:103], v[128:131], a[208:211], v[100:103]
  global_load_dwordx4 v[224:227], v233, s[12:13] offset:-4096 sc1
  v_fmac_f32 v88, v48, v16
  v_mfma_f32_16x16x32_bf16 v[76:79], v[132:135], a[204:207], v[76:79]
  ds_read_b128 v[160:163], v2 offset:53248
  v_fmac_f32 v116, v48, v18
  v_mfma_f32_16x16x32_bf16 v[104:107], v[132:135], a[208:211], v[104:107]
  v_fmac_f32 v64, v24, v16
  v_mfma_f32_16x16x32_bf16 v[80:83], v[136:139], a[204:207], v[80:83]
  ds_read_b128 v[164:167], v2 offset:54272
  v_fmac_f32 v92, v24, v18
  v_mfma_f32_16x16x32_bf16 v[108:111], v[136:139], a[208:211], v[108:111]
  global_load_dwordx4 a[156:159], v232, s[12:13] offset:-3072 sc1
  v_fmac_f32 v68, v28, v16
  v_mfma_f32_16x16x32_bf16 v[84:87], v[140:143], a[204:207], v[84:87]
  ds_read_b128 v[168:171], v2 offset:55296
  v_fmac_f32 v96, v28, v18
  v_mfma_f32_16x16x32_bf16 v[112:115], v[140:143], a[208:211], v[112:115]
  v_fmac_f32 v72, v32, v16
  s_waitcnt lgkmcnt(3)
  v_mfma_f32_16x16x32_bf16 v[88:91], v[144:147], a[204:207], v[88:91]
  ds_read_b128 v[172:175], v2 offset:56320
  v_fmac_f32 v100, v32, v18
  v_mfma_f32_16x16x32_bf16 v[116:119], v[144:147], a[208:211], v[116:119]
  global_load_dwordx4 a[160:163], v233, s[12:13] offset:-3072 sc1
  v_fmac_f32 v76, v36, v16
  s_waitcnt vmcnt(21)
  v_mfma_f32_16x16x32_bf16 v[64:67], v[148:151], a[212:215], v[64:67]
  ds_read_b128 v[120:123], v2 offset:57344
  v_fmac_f32 v105, v37, v18
  s_waitcnt vmcnt(20)
  v_mfma_f32_16x16x32_bf16 v[92:95], v[148:151], a[216:219], v[92:95]
  v_fmac_f32 v81, v41, v16
  v_mfma_f32_16x16x32_bf16 v[68:71], v[152:155], a[212:215], v[68:71]
  ds_read_b128 v[124:127], v2 offset:58368
  v_fmac_f32 v109, v41, v18
  v_mfma_f32_16x16x32_bf16 v[96:99], v[152:155], a[216:219], v[96:99]
  global_load_dwordx4 a[164:167], v232, s[12:13] offset:-2048 sc1
  v_fmac_f32 v85, v45, v16
  v_mfma_f32_16x16x32_bf16 v[72:75], v[156:159], a[212:215], v[72:75]
  ds_read_b128 v[128:131], v2 offset:59392
  v_fmac_f32 v113, v45, v18
  v_mfma_f32_16x16x32_bf16 v[100:103], v[156:159], a[216:219], v[100:103]
  v_fmac_f32 v89, v49, v16
  s_waitcnt lgkmcnt(3)
  v_mfma_f32_16x16x32_bf16 v[76:79], v[160:163], a[212:215], v[76:79]
  ds_read_b128 v[132:135], v2 offset:60416
  v_fmac_f32 v117, v49, v18
  v_mfma_f32_16x16x32_bf16 v[104:107], v[160:163], a[216:219], v[104:107]
  v_fmac_f32 v65, v25, v16
  v_mfma_f32_16x16x32_bf16 v[80:83], v[164:167], a[212:215], v[80:83]
  ds_read_b128 v[136:139], v2 offset:61440
  v_fmac_f32 v93, v25, v18
  v_mfma_f32_16x16x32_bf16 v[108:111], v[164:167], a[216:219], v[108:111]
  global_load_dwordx4 a[168:171], v233, s[12:13] offset:-2048 sc1
  v_fmac_f32 v69, v29, v16
  v_mfma_f32_16x16x32_bf16 v[84:87], v[168:171], a[212:215], v[84:87]
  ds_read_b128 v[140:143], v2 offset:62464
  v_fmac_f32 v97, v29, v18
  v_mfma_f32_16x16x32_bf16 v[112:115], v[168:171], a[216:219], v[112:115]
  v_fmac_f32 v73, v33, v16
  v_mfma_f32_16x16x32_bf16 v[88:91], v[172:175], a[212:215], v[88:91]
  ds_read_b128 v[144:147], v2 offset:63488
  v_fmac_f32 v101, v33, v18
  v_mfma_f32_16x16x32_bf16 v[116:119], v[172:175], a[216:219], v[116:119]
  global_load_dwordx4 a[172:175], v232, s[12:13] offset:-1024 sc1
  v_fmac_f32 v77, v37, v16
  s_waitcnt vmcnt(22) lgkmcnt(3)
  v_mfma_f32_16x16x32_bf16 v[64:67], v[120:123], a[220:223], v[64:67]
  ds_read_b128 v[148:151], v10 offset:0
  v_fmac_f32 v106, v38, v18
  s_waitcnt vmcnt(21)
  v_mfma_f32_16x16x32_bf16 v[92:95], v[120:123], a[224:227], v[92:95]
  v_fmac_f32 v82, v42, v16
  v_mfma_f32_16x16x32_bf16 v[68:71], v[124:127], a[220:223], v[68:71]
  ds_read_b128 v[152:155], v10 offset:1024
  v_fmac_f32 v110, v42, v18
  v_mfma_f32_16x16x32_bf16 v[96:99], v[124:127], a[224:227], v[96:99]
  global_load_dwordx4 a[176:179], v233, s[12:13] offset:-1024 sc1
  v_fmac_f32 v86, v46, v16
  v_mfma_f32_16x16x32_bf16 v[72:75], v[128:131], a[220:223], v[72:75]
  ds_read_b128 v[156:159], v10 offset:2048
  v_fmac_f32 v114, v46, v18
  v_mfma_f32_16x16x32_bf16 v[100:103], v[128:131], a[224:227], v[100:103]
  v_fmac_f32 v90, v50, v16
  v_mfma_f32_16x16x32_bf16 v[76:79], v[132:135], a[220:223], v[76:79]
  ds_read_b128 v[160:163], v10 offset:3072
  v_fmac_f32 v118, v50, v18
  v_add_u32 v234, s92, v2
  v_mfma_f32_16x16x32_bf16 v[104:107], v[132:135], a[224:227], v[104:107]
  global_load_dwordx4 a[120:123], v234, s[12:13] offset:-4096 sc1
  v_fmac_f32 v66, v26, v16
  s_waitcnt lgkmcnt(3)
  v_mfma_f32_16x16x32_bf16 v[80:83], v[136:139], a[220:223], v[80:83]
  ds_read_b128 v[164:167], v10 offset:4096
  v_fmac_f32 v94, v26, v18
  v_mfma_f32_16x16x32_bf16 v[108:111], v[136:139], a[224:227], v[108:111]
  v_fmac_f32 v70, v30, v16
  v_mfma_f32_16x16x32_bf16 v[84:87], v[140:143], a[220:223], v[84:87]
  ds_read_b128 v[168:171], v10 offset:5120
  v_fmac_f32 v98, v30, v18
  v_mfma_f32_16x16x32_bf16 v[112:115], v[140:143], a[224:227], v[112:115]
  global_load_dwordx4 a[124:127], v234, s[12:13] offset:-3072 sc1
  v_fmac_f32 v74, v34, v16
  v_mfma_f32_16x16x32_bf16 v[88:91], v[144:147], a[220:223], v[88:91]
  ds_read_b128 v[172:175], v10 offset:6144
  v_fmac_f32 v102, v34, v18
  v_mfma_f32_16x16x32_bf16 v[116:119], v[144:147], a[224:227], v[116:119]
  v_fmac_f32 v78, v38, v16
  s_waitcnt vmcnt(23)
  v_mfma_f32_16x16x32_bf16 v[64:67], v[148:151], a[228:231], v[64:67]
  ds_read_b128 v[120:123], v10 offset:7168
  v_fmac_f32 v107, v39, v18
  s_waitcnt vmcnt(22)
  v_mfma_f32_16x16x32_bf16 v[92:95], v[148:151], a[232:235], v[92:95]
  global_load_dwordx4 a[128:131], v234, s[12:13] offset:-2048 sc1
  v_fmac_f32 v83, v43, v16
  s_waitcnt lgkmcnt(3)
  v_mfma_f32_16x16x32_bf16 v[68:71], v[152:155], a[228:231], v[68:71]
  ds_read_b128 v[124:127], v10 offset:8192
  v_fmac_f32 v111, v43, v18
  v_mfma_f32_16x16x32_bf16 v[96:99], v[152:155], a[232:235], v[96:99]
  v_fmac_f32 v87, v47, v16
  v_mfma_f32_16x16x32_bf16 v[72:75], v[156:159], a[228:231], v[72:75]
  ds_read_b128 v[128:131], v10 offset:14336
  v_fmac_f32 v115, v47, v18
  v_mfma_f32_16x16x32_bf16 v[100:103], v[156:159], a[232:235], v[100:103]
  global_load_dwordx4 a[132:135], v234, s[12:13] offset:-1024 sc1
  v_fmac_f32 v91, v51, v16
  v_mfma_f32_16x16x32_bf16 v[76:79], v[160:163], a[228:231], v[76:79]
  ds_read_b128 v[132:135], v10 offset:15360
  v_fmac_f32 v119, v51, v18
  v_mfma_f32_16x16x32_bf16 v[104:107], v[160:163], a[232:235], v[104:107]
  global_load_dwordx4 a[136:139], v234, s[12:13] offset:0 sc1
  v_fmac_f32 v67, v27, v16
  v_mfma_f32_16x16x32_bf16 v[80:83], v[164:167], a[228:231], v[80:83]
  ds_read_b128 v[136:139], v10 offset:21504
  v_fmac_f32 v95, v27, v18
  v_mfma_f32_16x16x32_bf16 v[108:111], v[164:167], a[232:235], v[108:111]
  v_fmac_f32 v71, v31, v16
  s_waitcnt lgkmcnt(3)
  v_mfma_f32_16x16x32_bf16 v[84:87], v[168:171], a[228:231], v[84:87]
  ds_read_b128 v[140:143], v10 offset:22528
  v_fmac_f32 v99, v31, v18
  v_mfma_f32_16x16x32_bf16 v[112:115], v[168:171], a[232:235], v[112:115]
  global_load_dwordx4 a[140:143], v234, s[12:13] offset:1024 sc1
  v_fmac_f32 v75, v35, v16
  v_mfma_f32_16x16x32_bf16 v[88:91], v[172:175], a[228:231], v[88:91]
  ds_read_b128 v[144:147], v10 offset:28672
  v_fmac_f32 v103, v35, v18
  v_mfma_f32_16x16x32_bf16 v[116:119], v[172:175], a[232:235], v[116:119]
  v_fmac_f32 v79, v39, v16
  s_waitcnt vmcnt(25)
  v_mfma_f32_16x16x32_bf16 v[64:67], v[120:123], a[236:239], v[64:67]
  ds_read_b128 v[148:151], v10 offset:29696
  s_waitcnt vmcnt(24)
  v_mfma_f32_16x16x32_bf16 v[92:95], v[120:123], a[240:243], v[92:95]
  global_load_dwordx4 a[144:147], v234, s[12:13] offset:2048 sc1
  v_mfma_f32_16x16x32_bf16 v[68:71], v[124:127], a[236:239], v[68:71]
  ds_read_b128 v[152:155], v10 offset:35840
  v_mfma_f32_16x16x32_bf16 v[96:99], v[124:127], a[240:243], v[96:99]
  s_waitcnt vmcnt(24) lgkmcnt(3)
  v_mfma_f32_16x16x32_bf16 v[64:67], v[128:131], a[244:247], v[64:67]
  ds_read_b128 v[156:159], v10 offset:36864
  s_waitcnt vmcnt(23)
  v_mfma_f32_16x16x32_bf16 v[92:95], v[128:131], a[248:251], v[92:95]
  global_load_dwordx4 a[148:151], v234, s[12:13] offset:3072 sc1
  v_mfma_f32_16x16x32_bf16 v[68:71], v[132:135], a[244:247], v[68:71]
  ds_read_b128 v[160:163], v10 offset:43008
  v_mfma_f32_16x16x32_bf16 v[96:99], v[132:135], a[248:251], v[96:99]
  s_waitcnt vmcnt(23)
  v_mfma_f32_16x16x32_bf16 v[64:67], v[136:139], a[104:107], v[64:67]
  ds_read_b128 v[164:167], v10 offset:44032
  v_add_u32 v234, 8192, v234
  s_waitcnt vmcnt(22)
  v_mfma_f32_16x16x32_bf16 v[92:95], v[136:139], a[108:111], v[92:95]
  global_load_dwordx4 a[152:155], v234, s[12:13] offset:-4096 sc1
  v_mfma_f32_16x16x32_bf16 v[68:71], v[140:143], a[104:107], v[68:71]
  ds_read_b128 v[168:171], v10 offset:50176
  v_mfma_f32_16x16x32_bf16 v[96:99], v[140:143], a[108:111], v[96:99]
  s_waitcnt vmcnt(22) lgkmcnt(3)
  v_mfma_f32_16x16x32_bf16 v[64:67], v[144:147], a[112:115], v[64:67]
  ds_read_b128 v[172:175], v10 offset:51200
  s_waitcnt vmcnt(21)
  v_mfma_f32_16x16x32_bf16 v[92:95], v[144:147], a[116:119], v[92:95]
  global_load_dwordx4 a[0:3], v234, s[12:13] offset:-3072 sc1
  v_mfma_f32_16x16x32_bf16 v[68:71], v[148:151], a[112:115], v[68:71]
  ds_read_b128 v[120:123], v10 offset:57344
  v_mfma_f32_16x16x32_bf16 v[96:99], v[148:151], a[116:119], v[96:99]
  s_waitcnt vmcnt(21)
  v_mfma_f32_16x16x32_bf16 v[64:67], v[152:155], v[204:207], v[64:67]
  ds_read_b128 v[124:127], v10 offset:58368
  s_waitcnt vmcnt(20)
  v_mfma_f32_16x16x32_bf16 v[92:95], v[152:155], v[208:211], v[92:95]
  global_load_dwordx4 a[4:7], v234, s[12:13] offset:-2048 sc1
  v_mfma_f32_16x16x32_bf16 v[68:71], v[156:159], v[204:207], v[68:71]
  ds_read_b128 v[128:131], v11 offset:0
  v_mfma_f32_16x16x32_bf16 v[96:99], v[156:159], v[208:211], v[96:99]
  s_waitcnt vmcnt(20) lgkmcnt(3)
  v_mfma_f32_16x16x32_bf16 v[64:67], v[160:163], v[212:215], v[64:67]
  ds_read_b128 v[132:135], v11 offset:1024
  s_waitcnt vmcnt(19)
  v_mfma_f32_16x16x32_bf16 v[92:95], v[160:163], v[216:219], v[92:95]
  global_load_dwordx4 a[8:11], v234, s[12:13] offset:-1024 sc1
  v_mfma_f32_16x16x32_bf16 v[68:71], v[164:167], v[212:215], v[68:71]
  ds_read_b128 v[136:139], v11 offset:7168
  v_mfma_f32_16x16x32_bf16 v[96:99], v[164:167], v[216:219], v[96:99]
  s_waitcnt vmcnt(19)
  v_mfma_f32_16x16x32_bf16 v[64:67], v[168:171], v[220:223], v[64:67]
  ds_read_b128 v[140:143], v11 offset:8192
  s_waitcnt vmcnt(18)
  v_mfma_f32_16x16x32_bf16 v[92:95], v[168:171], v[224:227], v[92:95]
  global_load_dwordx4 a[12:15], v234, s[12:13] offset:0 sc1
  v_mfma_f32_16x16x32_bf16 v[68:71], v[172:175], v[220:223], v[68:71]
  ds_read_b128 v[144:147], v10 offset:9216
  v_mfma_f32_16x16x32_bf16 v[96:99], v[172:175], v[224:227], v[96:99]
  s_waitcnt vmcnt(18) lgkmcnt(3)
  v_mfma_f32_16x16x32_bf16 v[64:67], v[120:123], a[156:159], v[64:67]
  ds_read_b128 v[148:151], v10 offset:10240
  s_waitcnt vmcnt(17)
  v_mfma_f32_16x16x32_bf16 v[92:95], v[120:123], a[160:163], v[92:95]
  global_load_dwordx4 a[16:19], v234, s[12:13] offset:1024 sc1
  v_mfma_f32_16x16x32_bf16 v[68:71], v[124:127], a[156:159], v[68:71]
  ds_read_b128 v[152:155], v10 offset:16384
  v_mfma_f32_16x16x32_bf16 v[96:99], v[124:127], a[160:163], v[96:99]
  global_load_dwordx4 a[20:23], v234, s[12:13] offset:2048 sc1
  s_waitcnt vmcnt(18)
  v_mfma_f32_16x16x32_bf16 v[64:67], v[128:131], a[164:167], v[64:67]
  ds_read_b128 v[156:159], v10 offset:17408
  s_waitcnt vmcnt(17)
  v_mfma_f32_16x16x32_bf16 v[92:95], v[128:131], a[168:171], v[92:95]
  v_mfma_f32_16x16x32_bf16 v[68:71], v[132:135], a[164:167], v[68:71]
  ds_read_b128 v[160:163], v10 offset:23552
  v_mfma_f32_16x16x32_bf16 v[96:99], v[132:135], a[168:171], v[96:99]
  global_load_dwordx4 a[24:27], v234, s[12:13] offset:3072 sc1
  s_waitcnt vmcnt(17) lgkmcnt(3)
  v_mfma_f32_16x16x32_bf16 v[64:67], v[136:139], a[172:175], v[64:67]
  ds_read_b128 v[164:167], v10 offset:24576
  s_waitcnt vmcnt(16)
  v_mfma_f32_16x16x32_bf16 v[92:95], v[136:139], a[176:179], v[92:95]
  v_mfma_f32_16x16x32_bf16 v[68:71], v[140:143], a[172:175], v[68:71]
  ds_read_b128 v[168:171], v10 offset:30720
  v_add_u32 v234, 8192, v234
  v_mfma_f32_16x16x32_bf16 v[96:99], v[140:143], a[176:179], v[96:99]
  global_load_dwordx4 a[28:31], v234, s[12:13] offset:-4096 sc1
  v_mfma_f32_16x16x32_bf16 v[72:75], v[144:147], a[236:239], v[72:75]
  ds_read_b128 v[172:175], v10 offset:31744
  v_mfma_f32_16x16x32_bf16 v[100:103], v[144:147], a[240:243], v[100:103]
  v_mfma_f32_16x16x32_bf16 v[76:79], v[148:151], a[236:239], v[76:79]
  ds_read_b128 v[120:123], v10 offset:37888
  v_mfma_f32_16x16x32_bf16 v[104:107], v[148:151], a[240:243], v[104:107]
  global_load_dwordx4 a[32:35], v234, s[12:13] offset:-3072 sc1
  v_mul_f32 v64, v64, v17
  v_mul_f32 v65, v65, v17
  v_mul_f32 v66, v66, v17
  v_mul_f32 v67, v67, v17
  s_waitcnt lgkmcnt(3)
  v_mfma_f32_16x16x32_bf16 v[72:75], v[152:155], a[244:247], v[72:75]
  ds_read_b128 v[124:127], v10 offset:38912
  v_mul_f32 v68, v68, v17
  v_mul_f32 v69, v69, v17
  v_mul_f32 v70, v70, v17
  v_mfma_f32_16x16x32_bf16 v[100:103], v[152:155], a[248:251], v[100:103]
  v_mul_f32 v71, v71, v17
  v_exp_f32 v52, v64
  v_mfma_f32_16x16x32_bf16 v[76:79], v[156:159], a[244:247], v[76:79]
  ds_read_b128 v[128:131], v10 offset:45056
  v_exp_f32 v53, v65
  v_exp_f32 v54, v66
  v_mfma_f32_16x16x32_bf16 v[104:107], v[156:159], a[248:251], v[104:107]
  global_load_dwordx4 a[36:39], v234, s[12:13] offset:-2048 sc1
  v_exp_f32 v55, v67
  v_exp_f32 v56, v68
  v_mfma_f32_16x16x32_bf16 v[72:75], v[160:163], a[104:107], v[72:75]
  ds_read_b128 v[132:135], v10 offset:46080
  v_exp_f32 v57, v69
  v_mfma_f32_16x16x32_bf16 v[100:103], v[160:163], a[108:111], v[100:103]
  v_exp_f32 v58, v70
  v_exp_f32 v59, v71
  v_mfma_f32_16x16x32_bf16 v[76:79], v[164:167], a[104:107], v[76:79]
  ds_read_b128 v[136:139], v10 offset:52224
  v_fma_f32 v52, v52, v20, v20
  v_fma_f32 v53, v53, v20, v20
  v_fma_f32 v54, v54, v20, v20
  v_mfma_f32_16x16x32_bf16 v[104:107], v[164:167], a[108:111], v[104:107]
  global_load_dwordx4 a[40:43], v234, s[12:13] offset:-1024 sc1
  v_fma_f32 v55, v55, v20, v20
  v_fma_f32 v56, v56, v20, v20
  v_fma_f32 v57, v57, v20, v20
  s_waitcnt lgkmcnt(3)
  v_mfma_f32_16x16x32_bf16 v[72:75], v[168:171], a[112:115], v[72:75]
  ds_read_b128 v[140:143], v10 offset:53248
  v_fma_f32 v58, v58, v20, v20
  v_fma_f32 v59, v59, v20, v20
  v_rcp_f32 v52, v52
  v_mfma_f32_16x16x32_bf16 v[100:103], v[168:171], a[116:119], v[100:103]
  v_rcp_f32 v53, v53
  v_rcp_f32 v54, v54
  v_mfma_f32_16x16x32_bf16 v[76:79], v[172:175], a[112:115], v[76:79]
  ds_read_b128 v[144:147], v10 offset:59392
  v_rcp_f32 v55, v55
  v_mfma_f32_16x16x32_bf16 v[104:107], v[172:175], a[116:119], v[104:107]
  global_load_dwordx4 a[44:47], v234, s[12:13] offset:0 sc1
  v_rcp_f32 v56, v56
  v_rcp_f32 v57, v57
  v_mfma_f32_16x16x32_bf16 v[72:75], v[120:123], v[204:207], v[72:75]
  ds_read_b128 v[148:151], v10 offset:60416
  v_rcp_f32 v58, v58
  v_rcp_f32 v59, v59
  v_mfma_f32_16x16x32_bf16 v[100:103], v[120:123], v[208:211], v[100:103]
  v_mul_f32 v64, v64, v52
  v_mul_f32 v65, v65, v53
  v_mfma_f32_16x16x32_bf16 v[76:79], v[124:127], v[204:207], v[76:79]
  ds_read_b128 v[152:155], v11 offset:2048
  v_mul_f32 v66, v66, v54
  v_mul_f32 v67, v67, v55
  v_mul_f32 v68, v68, v56
  v_mfma_f32_16x16x32_bf16 v[104:107], v[124:127], v[208:211], v[104:107]
  global_load_dwordx4 a[48:51], v234, s[12:13] offset:1024 sc1
  v_mul_f32 v69, v69, v57
  v_mul_f32 v70, v70, v58
  v_mul_f32 v71, v71, v59
  v_cvt_pk_bf16_f32 v176, v64, v65
  s_waitcnt lgkmcnt(3)
  v_mfma_f32_16x16x32_bf16 v[72:75], v[128:131], v[212:215], v[72:75]
  ds_read_b128 v[156:159], v11 offset:3072
  v_cvt_pk_bf16_f32 v177, v66, v67
  v_cvt_pk_bf16_f32 v178, v68, v69
  v_cvt_pk_bf16_f32 v179, v70, v71
  v_mfma_f32_16x16x32_bf16 v[100:103], v[128:131], v[216:219], v[100:103]
  buffer_store_dwordx4 v[176:179], v2, s[12:15], s49 offen offset:0 sc1
  v_mul_f32 v92, v92, v19
  v_mul_f32 v93, v93, v19
  v_mfma_f32_16x16x32_bf16 v[76:79], v[132:135], v[212:215], v[76:79]
  ds_read_b128 v[160:163], v11 offset:9216
  v_mul_f32 v94, v94, v19
  v_mul_f32 v95, v95, v19
  v_mul_f32 v96, v96, v19
  v_mfma_f32_16x16x32_bf16 v[104:107], v[132:135], v[216:219], v[104:107]
  global_load_dwordx4 a[52:55], v234, s[12:13] offset:2048 sc1
  v_mul_f32 v97, v97, v19
  v_mul_f32 v98, v98, v19
  v_mul_f32 v99, v99, v19
  v_exp_f32 v52, v92
  v_mfma_f32_16x16x32_bf16 v[72:75], v[136:139], v[220:223], v[72:75]
  ds_read_b128 v[164:167], v11 offset:10240
  v_exp_f32 v53, v93
  v_mfma_f32_16x16x32_bf16 v[100:103], v[136:139], v[224:227], v[100:103]
  v_exp_f32 v54, v94
  v_exp_f32 v55, v95
  v_mfma_f32_16x16x32_bf16 v[76:79], v[140:143], v[220:223], v[76:79]
  ds_read_b128 v[168:171], v10 offset:11264
  v_exp_f32 v56, v96
  v_exp_f32 v57, v97
  v_mfma_f32_16x16x32_bf16 v[104:107], v[140:143], v[224:227], v[104:107]
  global_load_dwordx4 a[56:59], v234, s[12:13] offset:3072 sc1
  v_exp_f32 v58, v98
  s_waitcnt lgkmcnt(3)
  v_mfma_f32_16x16x32_bf16 v[72:75], v[144:147], a[156:159], v[72:75]
  ds_read_b128 v[172:175], v10 offset:12288
  v_exp_f32 v59, v99
  v_fma_f32 v52, v52, v20, v20
  v_add_u32 v234, 8192, v234
  v_mfma_f32_16x16x32_bf16 v[100:103], v[144:147], a[160:163], v[100:103]
  global_load_dwordx4 a[60:63], v234, s[12:13] offset:-4096 sc1
  v_fma_f32 v53, v53, v20, v20
  v_fma_f32 v54, v54, v20, v20
  v_fma_f32 v55, v55, v20, v20
  v_fma_f32 v56, v56, v20, v20
  v_mfma_f32_16x16x32_bf16 v[76:79], v[148:151], a[156:159], v[76:79]
  ds_read_b128 v[120:123], v10 offset:18432
  v_fma_f32 v57, v57, v20, v20
  v_fma_f32 v58, v58, v20, v20
  v_fma_f32 v59, v59, v20, v20
  v_mfma_f32_16x16x32_bf16 v[104:107], v[148:151], a[160:163], v[104:107]
  v_rcp_f32 v52, v52
  v_rcp_f32 v53, v53
  v_mfma_f32_16x16x32_bf16 v[72:75], v[152:155], a[164:167], v[72:75]
  ds_read_b128 v[124:127], v10 offset:19456
  v_rcp_f32 v54, v54
  v_mfma_f32_16x16x32_bf16 v[100:103], v[152:155], a[168:171], v[100:103]
  global_load_dwordx4 a[64:67], v234, s[12:13] offset:-3072 sc1
  v_rcp_f32 v55, v55
  v_rcp_f32 v56, v56
  v_mfma_f32_16x16x32_bf16 v[76:79], v[156:159], a[164:167], v[76:79]
  ds_read_b128 v[128:131], v10 offset:25600
  v_rcp_f32 v57, v57
  v_rcp_f32 v58, v58
  v_mfma_f32_16x16x32_bf16 v[104:107], v[156:159], a[168:171], v[104:107]
  v_rcp_f32 v59, v59
  s_waitcnt lgkmcnt(3)
  v_mfma_f32_16x16x32_bf16 v[72:75], v[160:163], a[172:175], v[72:75]
  ds_read_b128 v[132:135], v10 offset:26624
  v_mul_f32 v92, v92, v52
  v_mul_f32 v93, v93, v53
  v_mul_f32 v94, v94, v54
  v_mul_f32 v95, v95, v55
  v_mfma_f32_16x16x32_bf16 v[100:103], v[160:163], a[176:179], v[100:103]
  global_load_dwordx4 a[68:71], v234, s[12:13] offset:-2048 sc1
  v_mul_f32 v96, v96, v56
  v_mul_f32 v97, v97, v57
  v_mul_f32 v98, v98, v58
  v_mfma_f32_16x16x32_bf16 v[76:79], v[164:167], a[172:175], v[76:79]
  ds_read_b128 v[136:139], v10 offset:32768
  v_mul_f32 v99, v99, v59
  v_cvt_pk_bf16_f32 v180, v92, v93
  v_cvt_pk_bf16_f32 v181, v94, v95
  v_mfma_f32_16x16x32_bf16 v[104:107], v[164:167], a[176:179], v[104:107]
  v_cvt_pk_bf16_f32 v182, v96, v97
  v_cvt_pk_bf16_f32 v183, v98, v99
  buffer_store_dwordx4 v[180:183], v2, s[12:15], s50 offen offset:0 sc1
  v_mfma_f32_16x16x32_bf16 v[80:83], v[168:171], a[236:239], v[80:83]
  ds_read_b128 v[140:143], v10 offset:33792
  v_mfma_f32_16x16x32_bf16 v[108:111], v[168:171], a[240:243], v[108:111]
  global_load_dwordx4 a[72:75], v234, s[12:13] offset:-1024 sc1
  v_mfma_f32_16x16x32_bf16 v[84:87], v[172:175], a[236:239], v[84:87]
  ds_read_b128 v[144:147], v10 offset:39936
  v_mfma_f32_16x16x32_bf16 v[112:115], v[172:175], a[240:243], v[112:115]
  v_mul_f32 v72, v72, v17
  v_mul_f32 v73, v73, v17
  v_mul_f32 v74, v74, v17
  v_mul_f32 v75, v75, v17
  s_waitcnt lgkmcnt(3)
  v_mfma_f32_16x16x32_bf16 v[80:83], v[120:123], a[244:247], v[80:83]
  ds_read_b128 v[148:151], v10 offset:40960
  v_mul_f32 v76, v76, v17
  v_mul_f32 v77, v77, v17
  v_mul_f32 v78, v78, v17
  v_mfma_f32_16x16x32_bf16 v[108:111], v[120:123], a[248:251], v[108:111]
  global_load_dwordx4 a[76:79], v234, s[12:13] offset:0 sc1
  v_mul_f32 v79, v79, v17
  v_exp_f32 v52, v72
  v_mfma_f32_16x16x32_bf16 v[84:87], v[124:127], a[244:247], v[84:87]
  ds_read_b128 v[152:155], v10 offset:47104
  v_exp_f32 v53, v73
  v_exp_f32 v54, v74
  v_mfma_f32_16x16x32_bf16 v[112:115], v[124:127], a[248:251], v[112:115]
  v_exp_f32 v55, v75
  v_exp_f32 v56, v76
  v_mfma_f32_16x16x32_bf16 v[80:83], v[128:131], a[104:107], v[80:83]
  ds_read_b128 v[156:159], v10 offset:48128
  v_exp_f32 v57, v77
  v_mfma_f32_16x16x32_bf16 v[108:111], v[128:131], a[108:111], v[108:111]
  global_load_dwordx4 a[80:83], v234, s[12:13] offset:1024 sc1
  v_exp_f32 v58, v78
  v_exp_f32 v59, v79
  v_mfma_f32_16x16x32_bf16 v[84:87], v[132:135], a[104:107], v[84:87]
  ds_read_b128 v[160:163], v10 offset:54272
  v_fma_f32 v52, v52, v20, v20
  v_fma_f32 v53, v53, v20, v20
  v_fma_f32 v54, v54, v20, v20
  v_mfma_f32_16x16x32_bf16 v[112:115], v[132:135], a[108:111], v[112:115]
  v_fma_f32 v55, v55, v20, v20
  v_fma_f32 v56, v56, v20, v20
  v_fma_f32 v57, v57, v20, v20
  s_waitcnt lgkmcnt(3)
  v_mfma_f32_16x16x32_bf16 v[80:83], v[136:139], a[112:115], v[80:83]
  ds_read_b128 v[164:167], v10 offset:55296
  v_fma_f32 v58, v58, v20, v20
  v_fma_f32 v59, v59, v20, v20
  v_rcp_f32 v52, v52
  v_mfma_f32_16x16x32_bf16 v[108:111], v[136:139], a[116:119], v[108:111]
  global_load_dwordx4 a[84:87], v234, s[12:13] offset:2048 sc1
  v_rcp_f32 v53, v53
  v_rcp_f32 v54, v54
  v_mfma_f32_16x16x32_bf16 v[84:87], v[140:143], a[112:115], v[84:87]
  ds_read_b128 v[168:171], v10 offset:61440
  v_rcp_f32 v55, v55
  v_mfma_f32_16x16x32_bf16 v[112:115], v[140:143], a[116:119], v[112:115]
  v_rcp_f32 v56, v56
  v_rcp_f32 v57, v57
  v_mfma_f32_16x16x32_bf16 v[80:83], v[144:147], v[204:207], v[80:83]
  ds_read_b128 v[172:175], v10 offset:62464
  v_rcp_f32 v58, v58
  v_rcp_f32 v59, v59
  v_mfma_f32_16x16x32_bf16 v[108:111], v[144:147], v[208:211], v[108:111]
  global_load_dwordx4 a[88:91], v234, s[12:13] offset:3072 sc1
  v_mul_f32 v72, v72, v52
  v_mul_f32 v73, v73, v53
  v_mfma_f32_16x16x32_bf16 v[84:87], v[148:151], v[204:207], v[84:87]
  ds_read_b128 v[120:123], v11 offset:4096
  v_mul_f32 v74, v74, v54
  v_mul_f32 v75, v75, v55
  v_mul_f32 v76, v76, v56
  v_mfma_f32_16x16x32_bf16 v[112:115], v[148:151], v[208:211], v[112:115]
  v_mul_f32 v77, v77, v57
  v_mul_f32 v78, v78, v58
  v_mul_f32 v79, v79, v59
  v_cvt_pk_bf16_f32 v184, v72, v73
  s_waitcnt lgkmcnt(3)
  v_mfma_f32_16x16x32_bf16 v[80:83], v[152:155], v[212:215], v[80:83]
  ds_read_b128 v[124:127], v11 offset:5120
  v_cvt_pk_bf16_f32 v185, v74, v75
  v_cvt_pk_bf16_f32 v186, v76, v77
  v_cvt_pk_bf16_f32 v187, v78, v79
  v_add_u32 v234, 8192, v234
  v_mfma_f32_16x16x32_bf16 v[108:111], v[152:155], v[216:219], v[108:111]
  global_load_dwordx4 a[92:95], v234, s[12:13] offset:-4096 sc1
  buffer_store_dwordx4 v[184:187], v2, s[12:15], s49 offen offset:1024 sc1
  v_mul_f32 v100, v100, v19
  v_mul_f32 v101, v101, v19
  v_mfma_f32_16x16x32_bf16 v[84:87], v[156:159], v[212:215], v[84:87]
  ds_read_b128 v[128:131], v11 offset:11264
  v_mul_f32 v102, v102, v19
  v_mul_f32 v103, v103, v19
  v_mul_f32 v104, v104, v19
  v_mfma_f32_16x16x32_bf16 v[112:115], v[156:159], v[216:219], v[112:115]
  v_mul_f32 v105, v105, v19
  v_mul_f32 v106, v106, v19
  v_mul_f32 v107, v107, v19
  v_exp_f32 v52, v100
  v_mfma_f32_16x16x32_bf16 v[80:83], v[160:163], v[220:223], v[80:83]
  ds_read_b128 v[132:135], v11 offset:12288
  v_exp_f32 v53, v101
  v_mfma_f32_16x16x32_bf16 v[108:111], v[160:163], v[224:227], v[108:111]
  global_load_dwordx4 a[96:99], v234, s[12:13] offset:-3072 sc1
  v_exp_f32 v54, v102
  v_exp_f32 v55, v103
  v_mfma_f32_16x16x32_bf16 v[84:87], v[164:167], v[220:223], v[84:87]
  ds_read_b128 v[136:139], v10 offset:13312
  v_exp_f32 v56, v104
  v_exp_f32 v57, v105
  v_mfma_f32_16x16x32_bf16 v[112:115], v[164:167], v[224:227], v[112:115]
  global_load_dwordx4 a[100:103], v234, s[12:13] offset:-2048 sc1
  v_exp_f32 v58, v106
  s_waitcnt lgkmcnt(3)
  v_mfma_f32_16x16x32_bf16 v[80:83], v[168:171], a[156:159], v[80:83]
  ds_read_b128 v[140:143], v10 offset:20480
  v_exp_f32 v59, v107
  v_fma_f32 v52, v52, v20, v20
  v_mfma_f32_16x16x32_bf16 v[108:111], v[168:171], a[160:163], v[108:111]
  v_fma_f32 v53, v53, v20, v20
  v_fma_f32 v54, v54, v20, v20
  v_fma_f32 v55, v55, v20, v20
  v_fma_f32 v56, v56, v20, v20
  v_mfma_f32_16x16x32_bf16 v[84:87], v[172:175], a[156:159], v[84:87]
  ds_read_b128 v[144:147], v10 offset:27648
  v_fma_f32 v57, v57, v20, v20
  v_fma_f32 v58, v58, v20, v20
  v_fma_f32 v59, v59, v20, v20
  v_mfma_f32_16x16x32_bf16 v[112:115], v[172:175], a[160:163], v[112:115]
  v_rcp_f32 v52, v52
  v_rcp_f32 v53, v53
  v_mfma_f32_16x16x32_bf16 v[80:83], v[120:123], a[164:167], v[80:83]
  ds_read_b128 v[148:151], v10 offset:34816
  v_rcp_f32 v54, v54
  v_mfma_f32_16x16x32_bf16 v[108:111], v[120:123], a[168:171], v[108:111]
  v_rcp_f32 v55, v55
  v_rcp_f32 v56, v56
  v_mfma_f32_16x16x32_bf16 v[84:87], v[124:127], a[164:167], v[84:87]
  ds_read_b128 v[152:155], v10 offset:41984
  v_rcp_f32 v57, v57
  v_rcp_f32 v58, v58
  v_mfma_f32_16x16x32_bf16 v[112:115], v[124:127], a[168:171], v[112:115]
  v_rcp_f32 v59, v59
  s_waitcnt lgkmcnt(3)
  v_mfma_f32_16x16x32_bf16 v[80:83], v[128:131], a[172:175], v[80:83]
  ds_read_b128 v[156:159], v10 offset:49152
  v_mul_f32 v100, v100, v52
  v_mul_f32 v101, v101, v53
  v_mul_f32 v102, v102, v54
  v_mul_f32 v103, v103, v55
  v_mfma_f32_16x16x32_bf16 v[108:111], v[128:131], a[176:179], v[108:111]
  v_mul_f32 v104, v104, v56
  v_mul_f32 v105, v105, v57
  v_mul_f32 v106, v106, v58
  v_mfma_f32_16x16x32_bf16 v[84:87], v[132:135], a[172:175], v[84:87]
  ds_read_b128 v[160:163], v10 offset:56320
  v_mul_f32 v107, v107, v59
  v_cvt_pk_bf16_f32 v188, v100, v101
  v_cvt_pk_bf16_f32 v189, v102, v103
  v_mfma_f32_16x16x32_bf16 v[112:115], v[132:135], a[176:179], v[112:115]
  v_cvt_pk_bf16_f32 v190, v104, v105
  v_cvt_pk_bf16_f32 v191, v106, v107
  buffer_store_dwordx4 v[188:191], v2, s[12:15], s50 offen offset:1024 sc1
  v_mfma_f32_16x16x32_bf16 v[88:91], v[136:139], a[236:239], v[88:91]
  ds_read_b128 v[164:167], v10 offset:63488
  v_mfma_f32_16x16x32_bf16 v[116:119], v[136:139], a[240:243], v[116:119]
  v_mfma_f32_16x16x32_bf16 v[88:91], v[140:143], a[244:247], v[88:91]
  ds_read_b128 v[168:171], v11 offset:6144
  v_mfma_f32_16x16x32_bf16 v[116:119], v[140:143], a[248:251], v[116:119]
  v_mul_f32 v80, v80, v17
  v_mul_f32 v81, v81, v17
  v_mul_f32 v82, v82, v17
  v_mul_f32 v83, v83, v17
  v_mul_f32 v84, v84, v17
  v_mul_f32 v85, v85, v17
  v_mul_f32 v86, v86, v17
  v_mul_f32 v87, v87, v17
  s_waitcnt lgkmcnt(3)
  v_mfma_f32_16x16x32_bf16 v[88:91], v[144:147], a[104:107], v[88:91]
  ds_read_b128 v[172:175], v11 offset:13312
  v_exp_f32 v52, v80
  v_exp_f32 v53, v81
  v_exp_f32 v54, v82
  v_exp_f32 v55, v83
  v_mfma_f32_16x16x32_bf16 v[116:119], v[144:147], a[108:111], v[116:119]
  v_exp_f32 v56, v84
  v_exp_f32 v57, v85
  v_exp_f32 v58, v86
  v_mfma_f32_16x16x32_bf16 v[88:91], v[148:151], a[112:115], v[88:91]
  v_exp_f32 v59, v87
  v_fma_f32 v52, v52, v20, v20
  v_fma_f32 v53, v53, v20, v20
  v_fma_f32 v54, v54, v20, v20
  v_fma_f32 v55, v55, v20, v20
  v_fma_f32 v56, v56, v20, v20
  v_mfma_f32_16x16x32_bf16 v[116:119], v[148:151], a[116:119], v[116:119]
  v_fma_f32 v57, v57, v20, v20
  v_fma_f32 v58, v58, v20, v20
  v_fma_f32 v59, v59, v20, v20
  v_rcp_f32 v52, v52
  v_rcp_f32 v53, v53
  v_mfma_f32_16x16x32_bf16 v[88:91], v[152:155], v[204:207], v[88:91]
  v_rcp_f32 v54, v54
  v_rcp_f32 v55, v55
  v_rcp_f32 v56, v56
  v_rcp_f32 v57, v57
  v_mfma_f32_16x16x32_bf16 v[116:119], v[152:155], v[208:211], v[116:119]
  v_rcp_f32 v58, v58
  v_rcp_f32 v59, v59
  v_mul_f32 v80, v80, v52
  v_mul_f32 v81, v81, v53
  v_mul_f32 v82, v82, v54
  v_mfma_f32_16x16x32_bf16 v[88:91], v[156:159], v[212:215], v[88:91]
  v_mul_f32 v83, v83, v55
  v_mul_f32 v84, v84, v56
  v_mul_f32 v85, v85, v57
  v_mul_f32 v86, v86, v58
  v_mul_f32 v87, v87, v59
  v_cvt_pk_bf16_f32 v192, v80, v81
  v_cvt_pk_bf16_f32 v193, v82, v83
  v_mfma_f32_16x16x32_bf16 v[116:119], v[156:159], v[216:219], v[116:119]
  v_cvt_pk_bf16_f32 v194, v84, v85
  v_cvt_pk_bf16_f32 v195, v86, v87
  buffer_store_dwordx4 v[192:195], v2, s[12:15], s49 offen offset:2048 sc1
  v_mul_f32 v108, v108, v19
  v_mul_f32 v109, v109, v19
  v_mul_f32 v110, v110, v19
  v_mul_f32 v111, v111, v19
  s_waitcnt lgkmcnt(0)
  v_mfma_f32_16x16x32_bf16 v[88:91], v[160:163], v[220:223], v[88:91]
  v_mul_f32 v112, v112, v19
  v_mul_f32 v113, v113, v19
  v_mul_f32 v114, v114, v19
  v_mul_f32 v115, v115, v19
  v_exp_f32 v52, v108
  v_exp_f32 v53, v109
  v_mfma_f32_16x16x32_bf16 v[116:119], v[160:163], v[224:227], v[116:119]
  v_exp_f32 v54, v110
  v_exp_f32 v55, v111
  v_exp_f32 v56, v112
  v_mfma_f32_16x16x32_bf16 v[88:91], v[164:167], a[156:159], v[88:91]
  v_exp_f32 v57, v113
  v_exp_f32 v58, v114
  v_exp_f32 v59, v115
  v_fma_f32 v52, v52, v20, v20
  v_fma_f32 v53, v53, v20, v20
  v_mfma_f32_16x16x32_bf16 v[116:119], v[164:167], a[160:163], v[116:119]
  v_fma_f32 v54, v54, v20, v20
  v_fma_f32 v55, v55, v20, v20
  v_fma_f32 v56, v56, v20, v20
  v_fma_f32 v57, v57, v20, v20
  v_fma_f32 v58, v58, v20, v20
  v_fma_f32 v59, v59, v20, v20
  v_rcp_f32 v52, v52
  v_mfma_f32_16x16x32_bf16 v[88:91], v[168:171], a[164:167], v[88:91]
  v_rcp_f32 v53, v53
  v_rcp_f32 v54, v54
  v_rcp_f32 v55, v55
  v_mfma_f32_16x16x32_bf16 v[116:119], v[168:171], a[168:171], v[116:119]
  v_rcp_f32 v56, v56
  v_rcp_f32 v57, v57
  v_rcp_f32 v58, v58
  v_rcp_f32 v59, v59
  v_mfma_f32_16x16x32_bf16 v[88:91], v[172:175], a[172:175], v[88:91]
  v_mul_f32 v108, v108, v52
  v_mul_f32 v109, v109, v53
  v_mul_f32 v110, v110, v54
  v_mul_f32 v111, v111, v55
  v_mul_f32 v112, v112, v56
  v_mul_f32 v113, v113, v57
  v_mfma_f32_16x16x32_bf16 v[116:119], v[172:175], a[176:179], v[116:119]
  v_mul_f32 v114, v114, v58
  v_mul_f32 v115, v115, v59
  v_cvt_pk_bf16_f32 v196, v108, v109
  v_cvt_pk_bf16_f32 v197, v110, v111
  v_cvt_pk_bf16_f32 v198, v112, v113
  v_cvt_pk_bf16_f32 v199, v114, v115
  buffer_store_dwordx4 v[196:199], v2, s[12:15], s50 offen offset:2048 sc1
  v_pk_mul_f32 v[88:89], v[88:89], v[16:17] op_sel:[0,1] op_sel_hi:[1,1]
  v_pk_mul_f32 v[90:91], v[90:91], v[16:17] op_sel:[0,1] op_sel_hi:[1,1]
  v_pk_mul_f32 v[116:117], v[116:117], v[18:19] op_sel:[0,1] op_sel_hi:[1,1]
  v_pk_mul_f32 v[118:119], v[118:119], v[18:19] op_sel:[0,1] op_sel_hi:[1,1]
  v_exp_f32 v52, v88
  v_exp_f32 v53, v89
  v_exp_f32 v54, v90
  v_exp_f32 v55, v91
  v_exp_f32 v56, v116
  v_exp_f32 v57, v117
  v_exp_f32 v58, v118
  v_exp_f32 v59, v119
  v_pk_fma_f32 v[52:53], v[52:53], v[20:21], v[20:21]
  v_pk_fma_f32 v[54:55], v[54:55], v[20:21], v[20:21]
  v_pk_fma_f32 v[56:57], v[56:57], v[20:21], v[20:21]
  v_pk_fma_f32 v[58:59], v[58:59], v[20:21], v[20:21]
  v_rcp_f32 v52, v52
  v_rcp_f32 v53, v53
  v_rcp_f32 v54, v54
  v_rcp_f32 v55, v55
  v_rcp_f32 v56, v56
  v_rcp_f32 v57, v57
  v_rcp_f32 v58, v58
  v_rcp_f32 v59, v59
  v_pk_mul_f32 v[88:89], v[88:89], v[52:53]
  v_pk_mul_f32 v[90:91], v[90:91], v[54:55]
  v_pk_mul_f32 v[116:117], v[116:117], v[56:57]
  v_pk_mul_f32 v[118:119], v[118:119], v[58:59]
  v_cvt_pk_bf16_f32 v200, v88, v89
  v_cvt_pk_bf16_f32 v201, v90, v91
  v_cvt_pk_bf16_f32 v202, v116, v117
  v_cvt_pk_bf16_f32 v203, v118, v119
  s_nop 0
  v_permlane16_swap_b32 v200, v202
  v_permlane16_swap_b32 v201, v203
  buffer_store_dwordx4 v[200:203], v14, s[12:15], s49 offen offset:3072 sc1
  s_mul_i32 s53, s85, 7168
  s_add_u32 s53, s53, 13241344
  v_mov_b32 v60, s53
  s_lshl2_add_u32 s55, s40, s93
  s_xor_b32 s54, s55, 17
  s_mul_i32 s54, s54, 57344
  v_add3_u32 v52, v2, s54, v60
  s_xor_b32 s54, s55, 18
  s_mul_i32 s54, s54, 57344
  v_add3_u32 v53, v2, s54, v60
  s_xor_b32 s54, s55, 19
  s_mul_i32 s54, s54, 57344
  v_add3_u32 v54, v2, s54, v60
  s_xor_b32 s54, s55, 16
  s_mul_i32 s54, s54, 57344
  v_add3_u32 v55, v2, s54, v60
  s_xor_b32 s54, s55, 1
  s_mul_i32 s54, s54, 57344
  v_add3_u32 v56, v2, s54, v60
  s_xor_b32 s54, s55, 2
  s_mul_i32 s54, s54, 57344
  v_add3_u32 v57, v2, s54, v60
  s_xor_b32 s54, s55, 3
  s_mul_i32 s54, s54, 57344
  v_add3_u32 v58, v2, s54, v60
  s_xor_b32 s54, s55, 0
  s_mul_i32 s54, s54, 57344
  v_add3_u32 v59, v2, s54, v60
  s_lshl2_add_u32 s51, s40, s36
  s_lshl_b32 s51, s51, 5
  s_add_u32 s51, s51, 16384
  v_and_b32 v7, 7, v1
  v_lshl_add_u32 v7, v7, 2, s51
  s_xor_b32 s54, s36, 1
  s_mul_i32 s54, s54, 30720
  v_add_u32 v22, s54, v2
  s_xor_b32 s54, s36, 2
  s_mul_i32 s54, s54, 30720
  s_add_u32 s54, s54, 5120
  v_add_u32 v23, s54, v2
  s_xor_b32 s54, s36, 3
  s_mul_i32 s54, s54, 30720
  s_add_u32 s54, s54, 10240
  v_add_u32 v24, s54, v2
  s_xor_b32 s54, s36, 0
  s_mul_i32 s54, s54, 30720
  v_add_u32 v25, s54, v2
  v_lshlrev_b32 v32, 16, v236
  v_and_b32 v33, s46, v236
  v_lshlrev_b32 v34, 16, v237
  v_and_b32 v35, s46, v237
  v_lshlrev_b32 v36, 16, v238
  v_and_b32 v37, s46, v238
  v_lshlrev_b32 v38, 16, v239
  v_and_b32 v39, s46, v239
  v_lshlrev_b32 v40, 16, v240
  v_and_b32 v41, s46, v240
  v_lshlrev_b32 v42, 16, v241
  v_and_b32 v43, s46, v241
  v_lshlrev_b32 v44, 16, v242
  v_and_b32 v45, s46, v242
  v_lshlrev_b32 v46, 16, v243
  v_and_b32 v47, s46, v243
  v_lshlrev_b32 v48, 16, v244
  v_and_b32 v49, s46, v244
  v_lshlrev_b32 v50, 16, v245
  v_and_b32 v51, s46, v245
  s_lshl_b32 s54, s40, 5
  s_add_u32 s54, s54, s47
  s_xor_b32 s55, s54, 128
  s_mul_i32 s52, s54, 2560
  s_add_u32 s52, s52, 25985024
  s_mul_i32 s53, s55, 2560
  s_add_u32 s53, s53, 25985024
  v_lshlrev_b32 v28, 3, v1
  s_lshl_b32 s54, s36, 12
  s_add_u32 s54, s54, 122880
  v_and_b32 v16, 15, v1
  v_mul_u32_u24 v16, 160, v16
  v_add_u32 v16, s54, v16
  v_lshrrev_b32 v17, 4, v1
  v_lshl_add_u32 v18, v17, 3, v16
  v_lshl_add_u32 v17, v17, 4, v16
  v_add_u32 v16, s54, v2
  v_add_u32 v26, 0, v1
  v_mul_u32_u24 v27, 6554, v26
  v_lshrrev_b32 v27, 16, v27
  v_mul_u32_u24 v27, 1120, v27
  v_lshl_add_u32 v19, v26, 4, v27
  v_add_u32 v26, 64, v1
  v_mul_u32_u24 v27, 6554, v26
  v_lshrrev_b32 v27, 16, v27
  v_mul_u32_u24 v27, 1120, v27
  v_lshl_add_u32 v20, v26, 4, v27
  v_add_u32 v26, 128, v1
  v_mul_u32_u24 v27, 6554, v26
  v_lshrrev_b32 v27, 16, v27
  v_mul_u32_u24 v27, 1120, v27
  v_lshl_add_u32 v21, v26, 4, v27
  s_lshl2_add_u32 s48, s40, s93
  s_mul_i32 s48, s48, 20480
  s_mul_i32 s49, s41, 160
  s_add_u32 s48, s48, s49
  s_waitcnt vmcnt(0)
  v_mov_b32 v254, s37
  s_cmp_eq_u32 s86, 0
  s_mov_b64 exec, 1
  s_cbranch_scc1 Lfar_76
  buffer_store_dword v254, off, s[12:15], s61
Lnear_77:
  s_mov_b64 exec, -1
  s_barrier
  s_mov_b32 s60, 200000
Lpl_78:
  buffer_load_dword v254, v7, s[12:15], s94 offen sc1
  s_sub_u32 s60, s60, 1
  s_cbranch_scc1 Lpd_79
  s_waitcnt vmcnt(0)
  v_cmp_ne_u32 vcc, s37, v254
  s_nop 3
  s_cbranch_vccnz Lpl_78
Lpd_79:
  s_waitcnt vmcnt(0)
  global_load_dwordx4 v[64:67], v52, s[12:13] offset:-3072 sc1
  global_load_dwordx4 v[68:71], v52, s[12:13] offset:-2048 sc1
  global_load_dwordx4 v[72:75], v52, s[12:13] offset:-1024 sc1
  global_load_dwordx4 v[76:79], v52, s[12:13] offset:0 sc1
  global_load_dwordx4 v[80:83], v52, s[12:13] offset:1024 sc1
  global_load_dwordx4 v[84:87], v52, s[12:13] offset:2048 sc1
  global_load_dwordx4 v[88:91], v52, s[12:13] offset:3072 sc1
  global_load_dwordx4 v[92:95], v53, s[12:13] offset:-3072 sc1
  s_waitcnt vmcnt(7)
  v_mfma_f32_16x16x32_bf16 v[144:147], a[120:123], v[64:67], 0
  global_load_dwordx4 v[96:99], v53, s[12:13] offset:-2048 sc1
  v_mfma_f32_16x16x32_bf16 v[148:151], a[124:127], v[64:67], 0
  v_mfma_f32_16x16x32_bf16 v[152:155], a[128:131], v[64:67], 0
  global_load_dwordx4 v[100:103], v53, s[12:13] offset:-1024 sc1
  v_mfma_f32_16x16x32_bf16 v[156:159], a[132:135], v[64:67], 0
  v_mfma_f32_16x16x32_bf16 v[160:163], a[136:139], v[64:67], 0
  s_waitcnt vmcnt(8)
  v_mfma_f32_16x16x32_bf16 v[144:147], a[140:143], v[68:71], v[144:147]
  global_load_dwordx4 v[104:107], v53, s[12:13] offset:0 sc1
  v_mfma_f32_16x16x32_bf16 v[148:151], a[144:147], v[68:71], v[148:151]
  v_mfma_f32_16x16x32_bf16 v[152:155], a[148:151], v[68:71], v[152:155]
  global_load_dwordx4 v[108:111], v53, s[12:13] offset:1024 sc1
  v_mfma_f32_16x16x32_bf16 v[156:159], a[152:155], v[68:71], v[156:159]
  v_mfma_f32_16x16x32_bf16 v[160:163], a[0:3], v[68:71], v[160:163]
  s_waitcnt vmcnt(9)
  v_mfma_f32_16x16x32_bf16 v[144:147], a[4:7], v[72:75], v[144:147]
  global_load_dwordx4 v[112:115], v53, s[12:13] offset:2048 sc1
  v_mfma_f32_16x16x32_bf16 v[148:151], a[8:11], v[72:75], v[148:151]
  v_mfma_f32_16x16x32_bf16 v[152:155], a[12:15], v[72:75], v[152:155]
  global_load_dwordx4 v[116:119], v53, s[12:13] offset:3072 sc1
  v_mfma_f32_16x16x32_bf16 v[156:159], a[16:19], v[72:75], v[156:159]
  v_mfma_f32_16x16x32_bf16 v[160:163], a[20:23], v[72:75], v[160:163]
  s_waitcnt vmcnt(10)
  v_mfma_f32_16x16x32_bf16 v[144:147], a[24:27], v[76:79], v[144:147]
  global_load_dwordx4 v[120:123], v54, s[12:13] offset:-3072 sc1
  v_mfma_f32_16x16x32_bf16 v[148:151], a[28:31], v[76:79], v[148:151]
  v_mfma_f32_16x16x32_bf16 v[152:155], a[32:35], v[76:79], v[152:155]
  global_load_dwordx4 v[124:127], v54, s[12:13] offset:-2048 sc1
  v_mfma_f32_16x16x32_bf16 v[156:159], a[36:39], v[76:79], v[156:159]
  v_mfma_f32_16x16x32_bf16 v[160:163], a[40:43], v[76:79], v[160:163]
  s_waitcnt vmcnt(11)
  v_mfma_f32_16x16x32_bf16 v[144:147], a[44:47], v[80:83], v[144:147]
  global_load_dwordx4 v[128:131], v54, s[12:13] offset:-1024 sc1
  v_mfma_f32_16x16x32_bf16 v[148:151], a[48:51], v[80:83], v[148:151]
  v_mfma_f32_16x16x32_bf16 v[152:155], a[52:55], v[80:83], v[152:155]
  v_mfma_f32_16x16x32_bf16 v[156:159], a[56:59], v[80:83], v[156:159]
  v_mfma_f32_16x16x32_bf16 v[160:163], a[60:63], v[80:83], v[160:163]
  s_waitcnt vmcnt(11)
  v_mfma_f32_16x16x32_bf16 v[144:147], a[64:67], v[84:87], v[144:147]
  global_load_dwordx4 v[132:135], v54, s[12:13] offset:0 sc1
  v_mfma_f32_16x16x32_bf16 v[148:151], a[68:71], v[84:87], v[148:151]
  v_mfma_f32_16x16x32_bf16 v[152:155], a[72:75], v[84:87], v[152:155]
  v_mfma_f32_16x16x32_bf16 v[156:159], a[76:79], v[84:87], v[156:159]
  v_mfma_f32_16x16x32_bf16 v[160:163], a[80:83], v[84:87], v[160:163]
  s_waitcnt vmcnt(11)
  v_mfma_f32_16x16x32_bf16 v[144:147], a[84:87], v[88:91], v[144:147]
  global_load_dwordx4 v[136:139], v54, s[12:13] offset:1024 sc1
  v_mfma_f32_16x16x32_bf16 v[148:151], a[88:91], v[88:91], v[148:151]
  v_mfma_f32_16x16x32_bf16 v[152:155], a[92:95], v[88:91], v[152:155]
  v_mfma_f32_16x16x32_bf16 v[156:159], a[96:99], v[88:91], v[156:159]
  v_mfma_f32_16x16x32_bf16 v[160:163], a[100:103], v[88:91], v[160:163]
  s_waitcnt vmcnt(11)
  v_mfma_f32_16x16x32_bf16 v[164:167], a[120:123], v[92:95], 0
  global_load_dwordx4 v[140:143], v54, s[12:13] offset:2048 sc1
  v_mfma_f32_16x16x32_bf16 v[168:171], a[124:127], v[92:95], 0
  v_mfma_f32_16x16x32_bf16 v[172:175], a[128:131], v[92:95], 0
  v_mfma_f32_16x16x32_bf16 v[176:179], a[132:135], v[92:95], 0
  ds_write_b128 v22, v[144:147] offset:0
  v_mfma_f32_16x16x32_bf16 v[180:183], a[136:139], v[92:95], 0
  s_waitcnt vmcnt(11)
  v_mfma_f32_16x16x32_bf16 v[164:167], a[140:143], v[96:99], v[164:167]
  global_load_dwordx4 v[64:67], v54, s[12:13] offset:3072 sc1
  v_mfma_f32_16x16x32_bf16 v[168:171], a[144:147], v[96:99], v[168:171]
  v_mfma_f32_16x16x32_bf16 v[172:175], a[148:151], v[96:99], v[172:175]
  v_mfma_f32_16x16x32_bf16 v[176:179], a[152:155], v[96:99], v[176:179]
  ds_write_b128 v22, v[148:151] offset:1024
  v_mfma_f32_16x16x32_bf16 v[180:183], a[0:3], v[96:99], v[180:183]
  s_waitcnt vmcnt(11)
  v_mfma_f32_16x16x32_bf16 v[164:167], a[4:7], v[100:103], v[164:167]
  global_load_dwordx4 v[68:71], v55, s[12:13] offset:-3072 sc1
  v_mfma_f32_16x16x32_bf16 v[168:171], a[8:11], v[100:103], v[168:171]
  v_mfma_f32_16x16x32_bf16 v[172:175], a[12:15], v[100:103], v[172:175]
  v_mfma_f32_16x16x32_bf16 v[176:179], a[16:19], v[100:103], v[176:179]
  ds_write_b128 v22, v[152:155] offset:2048
  v_mfma_f32_16x16x32_bf16 v[180:183], a[20:23], v[100:103], v[180:183]
  s_waitcnt vmcnt(11)
  v_mfma_f32_16x16x32_bf16 v[164:167], a[24:27], v[104:107], v[164:167]
  global_load_dwordx4 v[72:75], v55, s[12:13] offset:-2048 sc1
  v_mfma_f32_16x16x32_bf16 v[168:171], a[28:31], v[104:107], v[168:171]
  v_mfma_f32_16x16x32_bf16 v[172:175], a[32:35], v[104:107], v[172:175]
  v_mfma_f32_16x16x32_bf16 v[176:179], a[36:39], v[104:107], v[176:179]
  ds_write_b128 v22, v[156:159] offset:3072
  v_mfma_f32_16x16x32_bf16 v[180:183], a[40:43], v[104:107], v[180:183]
  s_waitcnt vmcnt(11)
  v_mfma_f32_16x16x32_bf16 v[164:167], a[44:47], v[108:111], v[164:167]
  global_load_dwordx4 v[76:79], v55, s[12:13] offset:-1024 sc1
  v_mfma_f32_16x16x32_bf16 v[168:171], a[48:51], v[108:111], v[168:171]
  v_mfma_f32_16x16x32_bf16 v[172:175], a[52:55], v[108:111], v[172:175]
  v_mfma_f32_16x16x32_bf16 v[176:179], a[56:59], v[108:111], v[176:179]
  ds_write_b128 v22, v[160:163] offset:4096
  v_mfma_f32_16x16x32_bf16 v[180:183], a[60:63], v[108:111], v[180:183]
  s_waitcnt vmcnt(11)
  v_mfma_f32_16x16x32_bf16 v[164:167], a[64:67], v[112:115], v[164:167]
  global_load_dwordx4 v[80:83], v55, s[12:13] offset:0 sc1
  v_mfma_f32_16x16x32_bf16 v[168:171], a[68:71], v[112:115], v[168:171]
  v_mfma_f32_16x16x32_bf16 v[172:175], a[72:75], v[112:115], v[172:175]
  v_mfma_f32_16x16x32_bf16 v[176:179], a[76:79], v[112:115], v[176:179]
  v_mfma_f32_16x16x32_bf16 v[180:183], a[80:83], v[112:115], v[180:183]
  s_waitcnt vmcnt(11)
  v_mfma_f32_16x16x32_bf16 v[164:167], a[84:87], v[116:119], v[164:167]
  global_load_dwordx4 v[84:87], v55, s[12:13] offset:1024 sc1
  v_mfma_f32_16x16x32_bf16 v[168:171], a[88:91], v[116:119], v[168:171]
  v_mfma_f32_16x16x32_bf16 v[172:175], a[92:95], v[116:119], v[172:175]
  v_mfma_f32_16x16x32_bf16 v[176:179], a[96:99], v[116:119], v[176:179]
  v_mfma_f32_16x16x32_bf16 v[180:183], a[100:103], v[116:119], v[180:183]
  s_waitcnt vmcnt(11)
  v_mfma_f32_16x16x32_bf16 v[144:147], a[120:123], v[120:123], 0
  global_load_dwordx4 v[88:91], v55, s[12:13] offset:2048 sc1
  v_mfma_f32_16x16x32_bf16 v[148:151], a[124:127], v[120:123], 0
  v_mfma_f32_16x16x32_bf16 v[152:155], a[128:131], v[120:123], 0
  v_mfma_f32_16x16x32_bf16 v[156:159], a[132:135], v[120:123], 0
  ds_write_b128 v23, v[164:167] offset:0
  v_mfma_f32_16x16x32_bf16 v[160:163], a[136:139], v[120:123], 0
  s_waitcnt vmcnt(11)
  v_mfma_f32_16x16x32_bf16 v[144:147], a[140:143], v[124:127], v[144:147]
  global_load_dwordx4 v[92:95], v55, s[12:13] offset:3072 sc1
  v_mfma_f32_16x16x32_bf16 v[148:151], a[144:147], v[124:127], v[148:151]
  ds_write_b128 v23, v[168:171] offset:1024
  v_mfma_f32_16x16x32_bf16 v[152:155], a[148:151], v[124:127], v[152:155]
  v_mfma_f32_16x16x32_bf16 v[156:159], a[152:155], v[124:127], v[156:159]
  ds_write_b128 v23, v[172:175] offset:2048
  v_mfma_f32_16x16x32_bf16 v[160:163], a[0:3], v[124:127], v[160:163]
  s_waitcnt vmcnt(11)
  v_mfma_f32_16x16x32_bf16 v[144:147], a[4:7], v[128:131], v[144:147]
  global_load_dwordx4 v[96:99], v56, s[12:13] offset:-3072 sc1
  v_mfma_f32_16x16x32_bf16 v[148:151], a[8:11], v[128:131], v[148:151]
  ds_write_b128 v23, v[176:179] offset:3072
  v_mfma_f32_16x16x32_bf16 v[152:155], a[12:15], v[128:131], v[152:155]
  v_mfma_f32_16x16x32_bf16 v[156:159], a[16:19], v[128:131], v[156:159]
  ds_write_b128 v23, v[180:183] offset:4096
  v_mfma_f32_16x16x32_bf16 v[160:163], a[20:23], v[128:131], v[160:163]
  s_waitcnt vmcnt(11)
  v_mfma_f32_16x16x32_bf16 v[144:147], a[24:27], v[132:135], v[144:147]
  global_load_dwordx4 v[100:103], v56, s[12:13] offset:-2048 sc1
  v_mfma_f32_16x16x32_bf16 v[148:151], a[28:31], v[132:135], v[148:151]
  v_mfma_f32_16x16x32_bf16 v[152:155], a[32:35], v[132:135], v[152:155]
  s_waitcnt lgkmcnt(0)
  s_barrier
  v_mfma_f32_16x16x32_bf16 v[156:159], a[36:39], v[132:135], v[156:159]
  ds_read_b128 v[184:187], v25 offset:0
  ds_read_b128 v[204:207], v25 offset:5120
  v_mfma_f32_16x16x32_bf16 v[160:163], a[40:43], v[132:135], v[160:163]
  ds_read_b128 v[188:191], v25 offset:1024
  s_waitcnt vmcnt(11)
  v_mfma_f32_16x16x32_bf16 v[144:147], a[44:47], v[136:139], v[144:147]
  global_load_dwordx4 v[104:107], v56, s[12:13] offset:-1024 sc1
  ds_read_b128 v[208:211], v25 offset:6144
  v_mfma_f32_16x16x32_bf16 v[148:151], a[48:51], v[136:139], v[148:151]
  ds_read_b128 v[192:195], v25 offset:2048
  ds_read_b128 v[212:215], v25 offset:7168
  v_mfma_f32_16x16x32_bf16 v[152:155], a[52:55], v[136:139], v[152:155]
  ds_read_b128 v[196:199], v25 offset:3072
  ds_read_b128 v[216:219], v25 offset:8192
  v_mfma_f32_16x16x32_bf16 v[156:159], a[56:59], v[136:139], v[156:159]
  ds_read_b128 v[200:203], v25 offset:4096
  ds_read_b128 v[220:223], v25 offset:9216
  v_mfma_f32_16x16x32_bf16 v[160:163], a[60:63], v[136:139], v[160:163]
  s_waitcnt vmcnt(11)
  v_mfma_f32_16x16x32_bf16 v[144:147], a[64:67], v[140:143], v[144:147]
  global_load_dwordx4 v[108:111], v56, s[12:13] offset:0 sc1
  v_mfma_f32_16x16x32_bf16 v[148:151], a[68:71], v[140:143], v[148:151]
  s_waitcnt lgkmcnt(4)
  v_add_f32 v184, v184, v204
  v_add_f32 v185, v185, v205
  v_add_f32 v186, v186, v206
  v_mfma_f32_16x16x32_bf16 v[152:155], a[72:75], v[140:143], v[152:155]
  v_add_f32 v187, v187, v207
  v_add_f32 v188, v188, v208
  v_add_f32 v189, v189, v209
  v_mfma_f32_16x16x32_bf16 v[156:159], a[76:79], v[140:143], v[156:159]
  v_add_f32 v190, v190, v210
  v_add_f32 v191, v191, v211
  v_add_f32 v192, v192, v212
  v_mfma_f32_16x16x32_bf16 v[160:163], a[80:83], v[140:143], v[160:163]
  v_add_f32 v193, v193, v213
  v_add_f32 v194, v194, v214
  s_waitcnt vmcnt(11)
  v_mfma_f32_16x16x32_bf16 v[144:147], a[84:87], v[64:67], v[144:147]
  global_load_dwordx4 v[112:115], v56, s[12:13] offset:1024 sc1
  v_add_f32 v195, v195, v215
  s_waitcnt lgkmcnt(0)
  v_add_f32 v196, v196, v216
  v_mfma_f32_16x16x32_bf16 v[148:151], a[88:91], v[64:67], v[148:151]
  v_add_f32 v197, v197, v217
  v_add_f32 v198, v198, v218
  v_add_f32 v199, v199, v219
  v_mfma_f32_16x16x32_bf16 v[152:155], a[92:95], v[64:67], v[152:155]
  v_add_f32 v200, v200, v220
  v_add_f32 v201, v201, v221
  v_add_f32 v202, v202, v222
  v_mfma_f32_16x16x32_bf16 v[156:159], a[96:99], v[64:67], v[156:159]
  v_add_f32 v203, v203, v223
  v_mfma_f32_16x16x32_bf16 v[160:163], a[100:103], v[64:67], v[160:163]
  s_waitcnt vmcnt(11)
  v_mfma_f32_16x16x32_bf16 v[184:187], a[120:123], v[68:71], v[184:187]
  global_load_dwordx4 v[116:119], v56, s[12:13] offset:2048 sc1
  v_mfma_f32_16x16x32_bf16 v[188:191], a[124:127], v[68:71], v[188:191]
  v_mfma_f32_16x16x32_bf16 v[192:195], a[128:131], v[68:71], v[192:195]
  v_mfma_f32_16x16x32_bf16 v[196:199], a[132:135], v[68:71], v[196:199]
  ds_write_b128 v24, v[144:147] offset:0
  v_mfma_f32_16x16x32_bf16 v[200:203], a[136:139], v[68:71], v[200:203]
  s_waitcnt vmcnt(11)
  v_mfma_f32_16x16x32_bf16 v[184:187], a[140:143], v[72:75], v[184:187]
  global_load_dwordx4 v[120:123], v56, s[12:13] offset:3072 sc1
  v_mfma_f32_16x16x32_bf16 v[188:191], a[144:147], v[72:75], v[188:191]
  v_mfma_f32_16x16x32_bf16 v[192:195], a[148:151], v[72:75], v[192:195]
  ds_write_b128 v24, v[148:151] offset:1024
  v_mfma_f32_16x16x32_bf16 v[196:199], a[152:155], v[72:75], v[196:199]
  v_mfma_f32_16x16x32_bf16 v[200:203], a[0:3], v[72:75], v[200:203]
  s_waitcnt vmcnt(11)
  v_mfma_f32_16x16x32_bf16 v[184:187], a[4:7], v[76:79], v[184:187]
  global_load_dwordx4 v[124:127], v57, s[12:13] offset:-3072 sc1
  v_mfma_f32_16x16x32_bf16 v[188:191], a[8:11], v[76:79], v[188:191]
  ds_write_b128 v24, v[152:155] offset:2048
  v_mfma_f32_16x16x32_bf16 v[192:195], a[12:15], v[76:79], v[192:195]
  v_mfma_f32_16x16x32_bf16 v[196:199], a[16:19], v[76:79], v[196:199]
  ds_write_b128 v24, v[156:159] offset:3072
  v_mfma_f32_16x16x32_bf16 v[200:203], a[20:23], v[76:79], v[200:203]
  s_waitcnt vmcnt(11)
  v_mfma_f32_16x16x32_bf16 v[184:187], a[24:27], v[80:83], v[184:187]
  global_load_dwordx4 v[128:131], v57, s[12:13] offset:-2048 sc1
  v_mfma_f32_16x16x32_bf16 v[188:191], a[28:31], v[80:83], v[188:191]
  v_mfma_f32_16x16x32_bf16 v[192:195], a[32:35], v[80:83], v[192:195]
  ds_write_b128 v24, v[160:163] offset:4096
  v_mfma_f32_16x16x32_bf16 v[196:199], a[36:39], v[80:83], v[196:199]
  v_mfma_f32_16x16x32_bf16 v[200:203], a[40:43], v[80:83], v[200:203]
  s_waitcnt vmcnt(11)
  v_mfma_f32_16x16x32_bf16 v[184:187], a[44:47], v[84:87], v[184:187]
  global_load_dwordx4 v[132:135], v57, s[12:13] offset:-1024 sc1
  v_mfma_f32_16x16x32_bf16 v[188:191], a[48:51], v[84:87], v[188:191]
  v_mfma_f32_16x16x32_bf16 v[192:195], a[52:55], v[84:87], v[192:195]
  s_waitcnt lgkmcnt(0)
  s_barrier
  v_mfma_f32_16x16x32_bf16 v[196:199], a[56:59], v[84:87], v[196:199]
  ds_read_b128 v[204:207], v25 offset:10240
  v_mfma_f32_16x16x32_bf16 v[200:203], a[60:63], v[84:87], v[200:203]
  s_waitcnt vmcnt(11)
  v_mfma_f32_16x16x32_bf16 v[184:187], a[64:67], v[88:91], v[184:187]
  global_load_dwordx4 v[136:139], v57, s[12:13] offset:0 sc1
  v_mfma_f32_16x16x32_bf16 v[188:191], a[68:71], v[88:91], v[188:191]
  ds_read_b128 v[208:211], v25 offset:11264
  v_mfma_f32_16x16x32_bf16 v[192:195], a[72:75], v[88:91], v[192:195]
  ds_read_b128 v[212:215], v25 offset:12288
  v_mfma_f32_16x16x32_bf16 v[196:199], a[76:79], v[88:91], v[196:199]
  ds_read_b128 v[216:219], v25 offset:13312
  v_mfma_f32_16x16x32_bf16 v[200:203], a[80:83], v[88:91], v[200:203]
  s_waitcnt vmcnt(11)
  v_mfma_f32_16x16x32_bf16 v[184:187], a[84:87], v[92:95], v[184:187]
  global_load_dwordx4 v[140:143], v57, s[12:13] offset:1024 sc1
  v_mfma_f32_16x16x32_bf16 v[188:191], a[88:91], v[92:95], v[188:191]
  ds_read_b128 v[220:223], v25 offset:14336
  v_mfma_f32_16x16x32_bf16 v[192:195], a[92:95], v[92:95], v[192:195]
  v_mfma_f32_16x16x32_bf16 v[196:199], a[96:99], v[92:95], v[196:199]
  v_mfma_f32_16x16x32_bf16 v[200:203], a[100:103], v[92:95], v[200:203]
  s_waitcnt vmcnt(11)
  v_mfma_f32_16x16x32_bf16 v[144:147], a[120:123], v[96:99], 0
  global_load_dwordx4 v[64:67], v57, s[12:13] offset:2048 sc1
  v_mfma_f32_16x16x32_bf16 v[148:151], a[124:127], v[96:99], 0
  v_mfma_f32_16x16x32_bf16 v[152:155], a[128:131], v[96:99], 0
  v_mfma_f32_16x16x32_bf16 v[156:159], a[132:135], v[96:99], 0
  s_waitcnt lgkmcnt(4)
  v_add_f32 v184, v184, v204
  v_add_f32 v185, v185, v205
  v_mfma_f32_16x16x32_bf16 v[160:163], a[136:139], v[96:99], 0
  v_add_f32 v186, v186, v206
  s_waitcnt vmcnt(11)
  v_mfma_f32_16x16x32_bf16 v[144:147], a[140:143], v[100:103], v[144:147]
  global_load_dwordx4 v[68:71], v57, s[12:13] offset:3072 sc1
  v_add_f32 v187, v187, v207
  v_mfma_f32_16x16x32_bf16 v[148:151], a[144:147], v[100:103], v[148:151]
  s_waitcnt lgkmcnt(3)
  v_add_f32 v188, v188, v208
  v_add_f32 v189, v189, v209
  v_mfma_f32_16x16x32_bf16 v[152:155], a[148:151], v[100:103], v[152:155]
  v_add_f32 v190, v190, v210
  v_add_f32 v191, v191, v211
  v_mfma_f32_16x16x32_bf16 v[156:159], a[152:155], v[100:103], v[156:159]
  v_cvt_pk_bf16_f32 v224, v184, v185
  v_cvt_pk_bf16_f32 v225, v186, v187
  v_mfma_f32_16x16x32_bf16 v[160:163], a[0:3], v[100:103], v[160:163]
  v_cvt_pk_bf16_f32 v226, v188, v189
  s_waitcnt vmcnt(11)
  v_mfma_f32_16x16x32_bf16 v[144:147], a[4:7], v[104:107], v[144:147]
  global_load_dwordx4 v[72:75], v58, s[12:13] offset:-3072 sc1
  v_cvt_pk_bf16_f32 v227, v190, v191
  v_mfma_f32_16x16x32_bf16 v[148:151], a[8:11], v[104:107], v[148:151]
  v_min_u32 v224, -2, v224
  v_min_u32 v225, -2, v225
  v_mfma_f32_16x16x32_bf16 v[152:155], a[12:15], v[104:107], v[152:155]
  v_min_u32 v226, -2, v226
  v_min_u32 v227, -2, v227
  v_mfma_f32_16x16x32_bf16 v[156:159], a[16:19], v[104:107], v[156:159]
  buffer_store_dwordx4 v[224:227], v2, s[12:15], s53 offen offset:0 sc1
  s_waitcnt lgkmcnt(2)
  v_add_f32 v192, v192, v212
  v_mfma_f32_16x16x32_bf16 v[160:163], a[20:23], v[104:107], v[160:163]
  v_add_f32 v193, v193, v213
  s_waitcnt vmcnt(12)
  v_mfma_f32_16x16x32_bf16 v[144:147], a[24:27], v[108:111], v[144:147]
  global_load_dwordx4 v[76:79], v58, s[12:13] offset:-2048 sc1
  v_add_f32 v194, v194, v214
  v_mfma_f32_16x16x32_bf16 v[148:151], a[28:31], v[108:111], v[148:151]
  v_add_f32 v195, v195, v215
  s_waitcnt lgkmcnt(1)
  v_add_f32 v196, v196, v216
  v_mfma_f32_16x16x32_bf16 v[152:155], a[32:35], v[108:111], v[152:155]
  v_add_f32 v197, v197, v217
  v_add_f32 v198, v198, v218
  v_mfma_f32_16x16x32_bf16 v[156:159], a[36:39], v[108:111], v[156:159]
  v_add_f32 v199, v199, v219
  v_cvt_pk_bf16_f32 v228, v192, v193
  v_mfma_f32_16x16x32_bf16 v[160:163], a[40:43], v[108:111], v[160:163]
  v_cvt_pk_bf16_f32 v229, v194, v195
  s_waitcnt vmcnt(12)
  v_mfma_f32_16x16x32_bf16 v[144:147], a[44:47], v[112:115], v[144:147]
  global_load_dwordx4 v[80:83], v58, s[12:13] offset:-1024 sc1
  v_cvt_pk_bf16_f32 v230, v196, v197
  v_mfma_f32_16x16x32_bf16 v[148:151], a[48:51], v[112:115], v[148:151]
  v_cvt_pk_bf16_f32 v231, v198, v199
  v_min_u32 v228, -2, v228
  v_mfma_f32_16x16x32_bf16 v[152:155], a[52:55], v[112:115], v[152:155]
  v_min_u32 v229, -2, v229
  v_min_u32 v230, -2, v230
  v_mfma_f32_16x16x32_bf16 v[156:159], a[56:59], v[112:115], v[156:159]
  v_min_u32 v231, -2, v231
  buffer_store_dwordx4 v[228:231], v2, s[12:15], s53 offen offset:1024 sc1
  v_mfma_f32_16x16x32_bf16 v[160:163], a[60:63], v[112:115], v[160:163]
  s_waitcnt lgkmcnt(0)
  v_add_f32 v200, v200, v220
  s_waitcnt vmcnt(13)
  v_mfma_f32_16x16x32_bf16 v[144:147], a[64:67], v[116:119], v[144:147]
  global_load_dwordx4 v[84:87], v58, s[12:13] offset:0 sc1
  v_add_f32 v201, v201, v221
  v_mfma_f32_16x16x32_bf16 v[148:151], a[68:71], v[116:119], v[148:151]
  v_add_f32 v202, v202, v222
  v_add_f32 v203, v203, v223
  v_mfma_f32_16x16x32_bf16 v[152:155], a[72:75], v[116:119], v[152:155]
  v_cvt_pk_bf16_f32 v232, v200, v201
  v_cvt_pk_bf16_f32 v233, v202, v203
  v_mfma_f32_16x16x32_bf16 v[156:159], a[76:79], v[116:119], v[156:159]
  v_min_u32 v232, -2, v232
  v_min_u32 v233, -2, v233
  v_mfma_f32_16x16x32_bf16 v[160:163], a[80:83], v[116:119], v[160:163]
  buffer_store_dwordx2 v[232:233], v28, s[12:15], s53 offen offset:2048 sc1
  s_waitcnt vmcnt(14)
  v_mfma_f32_16x16x32_bf16 v[144:147], a[84:87], v[120:123], v[144:147]
  global_load_dwordx4 v[88:91], v58, s[12:13] offset:1024 sc1
  v_mfma_f32_16x16x32_bf16 v[148:151], a[88:91], v[120:123], v[148:151]
  v_mfma_f32_16x16x32_bf16 v[152:155], a[92:95], v[120:123], v[152:155]
  v_mfma_f32_16x16x32_bf16 v[156:159], a[96:99], v[120:123], v[156:159]
  v_mfma_f32_16x16x32_bf16 v[160:163], a[100:103], v[120:123], v[160:163]
  s_waitcnt vmcnt(14)
  v_mfma_f32_16x16x32_bf16 v[164:167], a[120:123], v[124:127], 0
  global_load_dwordx4 v[92:95], v58, s[12:13] offset:2048 sc1
  v_mfma_f32_16x16x32_bf16 v[168:171], a[124:127], v[124:127], 0
  v_mfma_f32_16x16x32_bf16 v[172:175], a[128:131], v[124:127], 0
  v_mfma_f32_16x16x32_bf16 v[176:179], a[132:135], v[124:127], 0
  ds_write_b128 v22, v[144:147] offset:15360
  v_mfma_f32_16x16x32_bf16 v[180:183], a[136:139], v[124:127], 0
  s_waitcnt vmcnt(14)
  v_mfma_f32_16x16x32_bf16 v[164:167], a[140:143], v[128:131], v[164:167]
  global_load_dwordx4 v[96:99], v58, s[12:13] offset:3072 sc1
  v_mfma_f32_16x16x32_bf16 v[168:171], a[144:147], v[128:131], v[168:171]
  v_mfma_f32_16x16x32_bf16 v[172:175], a[148:151], v[128:131], v[172:175]
  v_mfma_f32_16x16x32_bf16 v[176:179], a[152:155], v[128:131], v[176:179]
  ds_write_b128 v22, v[148:151] offset:16384
  v_mfma_f32_16x16x32_bf16 v[180:183], a[0:3], v[128:131], v[180:183]
  s_waitcnt vmcnt(14)
  v_mfma_f32_16x16x32_bf16 v[164:167], a[4:7], v[132:135], v[164:167]
  global_load_dwordx4 v[100:103], v59, s[12:13] offset:-3072 sc1
  v_mfma_f32_16x16x32_bf16 v[168:171], a[8:11], v[132:135], v[168:171]
  v_mfma_f32_16x16x32_bf16 v[172:175], a[12:15], v[132:135], v[172:175]
  v_mfma_f32_16x16x32_bf16 v[176:179], a[16:19], v[132:135], v[176:179]
  ds_write_b128 v22, v[152:155] offset:17408
  v_mfma_f32_16x16x32_bf16 v[180:183], a[20:23], v[132:135], v[180:183]
  s_waitcnt vmcnt(14)
  v_mfma_f32_16x16x32_bf16 v[164:167], a[24:27], v[136:139], v[164:167]
  global_load_dwordx4 v[104:107], v59, s[12:13] offset:-2048 sc1
  v_mfma_f32_16x16x32_bf16 v[168:171], a[28:31], v[136:139], v[168:171]
  v_mfma_f32_16x16x32_bf16 v[172:175], a[32:35], v[136:139], v[172:175]
  v_mfma_f32_16x16x32_bf16 v[176:179], a[36:39], v[136:139], v[176:179]
  ds_write_b128 v22, v[156:159] offset:18432
  v_mfma_f32_16x16x32_bf16 v[180:183], a[40:43], v[136:139], v[180:183]
  s_waitcnt vmcnt(14)
  v_mfma_f32_16x16x32_bf16 v[164:167], a[44:47], v[140:143], v[164:167]
  global_load_dwordx4 v[108:111], v59, s[12:13] offset:-1024 sc1
  v_mfma_f32_16x16x32_bf16 v[168:171], a[48:51], v[140:143], v[168:171]
  v_mfma_f32_16x16x32_bf16 v[172:175], a[52:55], v[140:143], v[172:175]
  v_mfma_f32_16x16x32_bf16 v[176:179], a[56:59], v[140:143], v[176:179]
  ds_write_b128 v22, v[160:163] offset:19456
  v_mfma_f32_16x16x32_bf16 v[180:183], a[60:63], v[140:143], v[180:183]
  s_waitcnt vmcnt(14)
  v_mfma_f32_16x16x32_bf16 v[164:167], a[64:67], v[64:67], v[164:167]
  global_load_dwordx4 v[112:115], v59, s[12:13] offset:0 sc1
  v_mfma_f32_16x16x32_bf16 v[168:171], a[68:71], v[64:67], v[168:171]
  v_mfma_f32_16x16x32_bf16 v[172:175], a[72:75], v[64:67], v[172:175]
  v_mfma_f32_16x16x32_bf16 v[176:179], a[76:79], v[64:67], v[176:179]
  v_mfma_f32_16x16x32_bf16 v[180:183], a[80:83], v[64:67], v[180:183]
  s_waitcnt vmcnt(14)
  v_mfma_f32_16x16x32_bf16 v[164:167], a[84:87], v[68:71], v[164:167]
  global_load_dwordx4 v[116:119], v59, s[12:13] offset:1024 sc1
  v_mfma_f32_16x16x32_bf16 v[168:171], a[88:91], v[68:71], v[168:171]
  v_mfma_f32_16x16x32_bf16 v[172:175], a[92:95], v[68:71], v[172:175]
  v_mfma_f32_16x16x32_bf16 v[176:179], a[96:99], v[68:71], v[176:179]
  v_mfma_f32_16x16x32_bf16 v[180:183], a[100:103], v[68:71], v[180:183]
  s_waitcnt vmcnt(14)
  v_mfma_f32_16x16x32_bf16 v[144:147], a[120:123], v[72:75], 0
  global_load_dwordx4 v[120:123], v59, s[12:13] offset:2048 sc1
  v_mfma_f32_16x16x32_bf16 v[148:151], a[124:127], v[72:75], 0
  v_mfma_f32_16x16x32_bf16 v[152:155], a[128:131], v[72:75], 0
  v_mfma_f32_16x16x32_bf16 v[156:159], a[132:135], v[72:75], 0
  ds_write_b128 v23, v[164:167] offset:15360
  v_mfma_f32_16x16x32_bf16 v[160:163], a[136:139], v[72:75], 0
  s_waitcnt vmcnt(13)
  v_mfma_f32_16x16x32_bf16 v[144:147], a[140:143], v[76:79], v[144:147]
  global_load_dwordx4 v[124:127], v59, s[12:13] offset:3072 sc1
  v_mfma_f32_16x16x32_bf16 v[148:151], a[144:147], v[76:79], v[148:151]
  ds_write_b128 v23, v[168:171] offset:16384
  v_mfma_f32_16x16x32_bf16 v[152:155], a[148:151], v[76:79], v[152:155]
  v_mfma_f32_16x16x32_bf16 v[156:159], a[152:155], v[76:79], v[156:159]
  ds_write_b128 v23, v[172:175] offset:17408
  v_mfma_f32_16x16x32_bf16 v[160:163], a[0:3], v[76:79], v[160:163]
  s_waitcnt vmcnt(13)
  v_mfma_f32_16x16x32_bf16 v[144:147], a[4:7], v[80:83], v[144:147]
  v_mfma_f32_16x16x32_bf16 v[148:151], a[8:11], v[80:83], v[148:151]
  ds_write_b128 v23, v[176:179] offset:18432
  v_mfma_f32_16x16x32_bf16 v[152:155], a[12:15], v[80:83], v[152:155]
  v_mfma_f32_16x16x32_bf16 v[156:159], a[16:19], v[80:83], v[156:159]
  ds_write_b128 v23, v[180:183] offset:19456
  v_mfma_f32_16x16x32_bf16 v[160:163], a[20:23], v[80:83], v[160:163]
  s_waitcnt vmcnt(11)
  v_mfma_f32_16x16x32_bf16 v[144:147], a[24:27], v[84:87], v[144:147]
  v_mfma_f32_16x16x32_bf16 v[148:151], a[28:31], v[84:87], v[148:151]
  v_mfma_f32_16x16x32_bf16 v[152:155], a[32:35], v[84:87], v[152:155]
  s_waitcnt lgkmcnt(0)
  s_barrier
  v_mfma_f32_16x16x32_bf16 v[156:159], a[36:39], v[84:87], v[156:159]
  ds_read_b128 v[184:187], v25 offset:15360
  ds_read_b128 v[204:207], v25 offset:20480
  v_mfma_f32_16x16x32_bf16 v[160:163], a[40:43], v[84:87], v[160:163]
  ds_read_b128 v[188:191], v25 offset:16384
  s_waitcnt vmcnt(9)
  v_mfma_f32_16x16x32_bf16 v[144:147], a[44:47], v[88:91], v[144:147]
  buffer_load_dwordx4 v[224:227], v2, s[12:15], s52 offen offset:0 sc1
  ds_read_b128 v[208:211], v25 offset:21504
  ds_read_b128 v[192:195], v25 offset:17408
  v_mfma_f32_16x16x32_bf16 v[148:151], a[48:51], v[88:91], v[148:151]
  ds_read_b128 v[212:215], v25 offset:22528
  ds_read_b128 v[196:199], v25 offset:18432
  v_mfma_f32_16x16x32_bf16 v[152:155], a[52:55], v[88:91], v[152:155]
  buffer_load_dwordx4 v[228:231], v2, s[12:15], s52 offen offset:1024 sc1
  ds_read_b128 v[216:219], v25 offset:23552
  ds_read_b128 v[200:203], v25 offset:19456
  v_mfma_f32_16x16x32_bf16 v[156:159], a[56:59], v[88:91], v[156:159]
  ds_read_b128 v[220:223], v25 offset:24576
  v_mfma_f32_16x16x32_bf16 v[160:163], a[60:63], v[88:91], v[160:163]
  buffer_load_dwordx2 v[232:233], v28, s[12:15], s52 offen offset:2048 sc1
  s_waitcnt vmcnt(11)
  v_mfma_f32_16x16x32_bf16 v[144:147], a[64:67], v[92:95], v[144:147]
  v_mfma_f32_16x16x32_bf16 v[148:151], a[68:71], v[92:95], v[148:151]
  s_waitcnt lgkmcnt(4)
  v_add_f32 v184, v184, v204
  v_add_f32 v185, v185, v205
  v_add_f32 v186, v186, v206
  v_mfma_f32_16x16x32_bf16 v[152:155], a[72:75], v[92:95], v[152:155]
  v_add_f32 v187, v187, v207
  v_add_f32 v188, v188, v208
  v_add_f32 v189, v189, v209
  v_mfma_f32_16x16x32_bf16 v[156:159], a[76:79], v[92:95], v[156:159]
  v_add_f32 v190, v190, v210
  v_add_f32 v191, v191, v211
  v_add_f32 v192, v192, v212
  v_mfma_f32_16x16x32_bf16 v[160:163], a[80:83], v[92:95], v[160:163]
  v_add_f32 v193, v193, v213
  v_add_f32 v194, v194, v214
  s_waitcnt vmcnt(10)
  v_mfma_f32_16x16x32_bf16 v[144:147], a[84:87], v[96:99], v[144:147]
  v_add_f32 v195, v195, v215
  s_waitcnt lgkmcnt(0)
  v_add_f32 v196, v196, v216
  v_add_f32 v197, v197, v217
  v_mfma_f32_16x16x32_bf16 v[148:151], a[88:91], v[96:99], v[148:151]
  v_add_f32 v198, v198, v218
  v_add_f32 v199, v199, v219
  v_add_f32 v200, v200, v220
  v_mfma_f32_16x16x32_bf16 v[152:155], a[92:95], v[96:99], v[152:155]
  v_add_f32 v201, v201, v221
  v_add_f32 v202, v202, v222
  v_add_f32 v203, v203, v223
  v_mfma_f32_16x16x32_bf16 v[156:159], a[96:99], v[96:99], v[156:159]
  v_mfma_f32_16x16x32_bf16 v[160:163], a[100:103], v[96:99], v[160:163]
  s_waitcnt vmcnt(9)
  v_mfma_f32_16x16x32_bf16 v[184:187], a[120:123], v[100:103], v[184:187]
  v_mfma_f32_16x16x32_bf16 v[188:191], a[124:127], v[100:103], v[188:191]
  v_mfma_f32_16x16x32_bf16 v[192:195], a[128:131], v[100:103], v[192:195]
  v_mfma_f32_16x16x32_bf16 v[196:199], a[132:135], v[100:103], v[196:199]
  ds_write_b128 v24, v[144:147] offset:15360
  v_mfma_f32_16x16x32_bf16 v[200:203], a[136:139], v[100:103], v[200:203]
  s_waitcnt vmcnt(8)
  v_mfma_f32_16x16x32_bf16 v[184:187], a[140:143], v[104:107], v[184:187]
  v_mfma_f32_16x16x32_bf16 v[188:191], a[144:147], v[104:107], v[188:191]
  v_mfma_f32_16x16x32_bf16 v[192:195], a[148:151], v[104:107], v[192:195]
  ds_write_b128 v24, v[148:151] offset:16384
  v_mfma_f32_16x16x32_bf16 v[196:199], a[152:155], v[104:107], v[196:199]
  v_mfma_f32_16x16x32_bf16 v[200:203], a[0:3], v[104:107], v[200:203]
  s_waitcnt vmcnt(7)
  v_mfma_f32_16x16x32_bf16 v[184:187], a[4:7], v[108:111], v[184:187]
  v_mfma_f32_16x16x32_bf16 v[188:191], a[8:11], v[108:111], v[188:191]
  ds_write_b128 v24, v[152:155] offset:17408
  v_mfma_f32_16x16x32_bf16 v[192:195], a[12:15], v[108:111], v[192:195]
  v_mfma_f32_16x16x32_bf16 v[196:199], a[16:19], v[108:111], v[196:199]
  ds_write_b128 v24, v[156:159] offset:18432
  v_mfma_f32_16x16x32_bf16 v[200:203], a[20:23], v[108:111], v[200:203]
  s_waitcnt vmcnt(6)
  v_mfma_f32_16x16x32_bf16 v[184:187], a[24:27], v[112:115], v[184:187]
  v_mfma_f32_16x16x32_bf16 v[188:191], a[28:31], v[112:115], v[188:191]
  v_mfma_f32_16x16x32_bf16 v[192:195], a[32:35], v[112:115], v[192:195]
  ds_write_b128 v24, v[160:163] offset:19456
  v_mfma_f32_16x16x32_bf16 v[196:199], a[36:39], v[112:115], v[196:199]
  v_mfma_f32_16x16x32_bf16 v[200:203], a[40:43], v[112:115], v[200:203]
  s_waitcnt vmcnt(5)
  v_mfma_f32_16x16x32_bf16 v[184:187], a[44:47], v[116:119], v[184:187]
  v_mfma_f32_16x16x32_bf16 v[188:191], a[48:51], v[116:119], v[188:191]
  s_waitcnt vmcnt(0)
  v_max_u32 v29, v232, v233
  v_max3_u32 v29, v224, v225, v29
  v_max3_u32 v29, v226, v227, v29
  v_max3_u32 v29, v228, v229, v29
  v_mfma_f32_16x16x32_bf16 v[192:195], a[52:55], v[116:119], v[192:195]
  s_waitcnt lgkmcnt(0)
  s_barrier
  v_max3_u32 v29, v230, v231, v29
  v_cmp_eq_u32 vcc, -1, v29
  s_nop 3
  s_cbranch_vccnz Lss_80
Lsb_81:
  v_mfma_f32_16x16x32_bf16 v[196:199], a[56:59], v[116:119], v[196:199]
  ds_read_b128 v[204:207], v25 offset:25600
  v_lshlrev_b32 v30, 16, v224
  v_and_b32 v31, s46, v224
  v_add_f32 v32, v32, v30
  v_add_f32 v33, v33, v31
  v_mfma_f32_16x16x32_bf16 v[200:203], a[60:63], v[116:119], v[200:203]
  v_lshlrev_b32 v30, 16, v225
  v_and_b32 v31, s46, v225
  v_add_f32 v34, v34, v30
  v_mfma_f32_16x16x32_bf16 v[184:187], a[64:67], v[120:123], v[184:187]
  ds_read_b128 v[208:211], v25 offset:26624
  v_add_f32 v35, v35, v31
  v_lshlrev_b32 v30, 16, v226
  v_and_b32 v31, s46, v226
  v_mfma_f32_16x16x32_bf16 v[188:191], a[68:71], v[120:123], v[188:191]
  ds_read_b128 v[212:215], v25 offset:27648
  v_add_f32 v36, v36, v30
  v_add_f32 v37, v37, v31
  v_lshlrev_b32 v30, 16, v227
  v_and_b32 v31, s46, v227
  v_mfma_f32_16x16x32_bf16 v[192:195], a[72:75], v[120:123], v[192:195]
  ds_read_b128 v[216:219], v25 offset:28672
  v_add_f32 v38, v38, v30
  v_add_f32 v39, v39, v31
  v_lshlrev_b32 v30, 16, v228
  v_mfma_f32_16x16x32_bf16 v[196:199], a[76:79], v[120:123], v[196:199]
  ds_read_b128 v[220:223], v25 offset:29696
  v_and_b32 v31, s46, v228
  v_add_f32 v40, v40, v30
  v_add_f32 v41, v41, v31
  v_mfma_f32_16x16x32_bf16 v[200:203], a[80:83], v[120:123], v[200:203]
  v_lshlrev_b32 v30, 16, v229
  v_and_b32 v31, s46, v229
  v_add_f32 v42, v42, v30
  v_add_f32 v43, v43, v31
  v_mfma_f32_16x16x32_bf16 v[184:187], a[84:87], v[124:127], v[184:187]
  v_lshlrev_b32 v30, 16, v230
  v_and_b32 v31, s46, v230
  v_add_f32 v44, v44, v30
  v_mfma_f32_16x16x32_bf16 v[188:191], a[88:91], v[124:127], v[188:191]
  v_add_f32 v45, v45, v31
  v_lshlrev_b32 v30, 16, v231
  v_and_b32 v31, s46, v231
  v_mfma_f32_16x16x32_bf16 v[192:195], a[92:95], v[124:127], v[192:195]
  v_add_f32 v46, v46, v30
  v_add_f32 v47, v47, v31
  v_lshlrev_b32 v30, 16, v232
  v_and_b32 v31, s46, v232
  v_mfma_f32_16x16x32_bf16 v[196:199], a[96:99], v[124:127], v[196:199]
  v_add_f32 v48, v48, v30
  v_add_f32 v49, v49, v31
  v_lshlrev_b32 v30, 16, v233
  v_mfma_f32_16x16x32_bf16 v[200:203], a[100:103], v[124:127], v[200:203]
  v_and_b32 v31, s46, v233
  v_add_f32 v50, v50, v30
  v_add_f32 v51, v51, v31
  s_waitcnt lgkmcnt(4)
  v_pk_add_f32 v[32:33], v[32:33], v[204:205]
  v_pk_add_f32 v[34:35], v[34:35], v[206:207]
  s_waitcnt lgkmcnt(3)
  v_pk_add_f32 v[36:37], v[36:37], v[208:209]
  v_pk_add_f32 v[38:39], v[38:39], v[210:211]
  s_waitcnt lgkmcnt(2)
  v_pk_add_f32 v[40:41], v[40:41], v[212:213]
  v_pk_add_f32 v[42:43], v[42:43], v[214:215]
  s_waitcnt lgkmcnt(1)
  v_pk_add_f32 v[44:45], v[44:45], v[216:217]
  v_pk_add_f32 v[46:47], v[46:47], v[218:219]
  s_waitcnt lgkmcnt(0)
  v_pk_add_f32 v[48:49], v[48:49], v[220:221]
  v_pk_add_f32 v[50:51], v[50:51], v[222:223]
  v_pk_add_f32 v[32:33], v[32:33], v[184:185]
  v_pk_add_f32 v[34:35], v[34:35], v[186:187]
  v_pk_add_f32 v[36:37], v[36:37], v[188:189]
  v_pk_add_f32 v[38:39], v[38:39], v[190:191]
  v_cvt_pk_bf16_f32 v236, v32, v33
  v_cvt_pk_bf16_f32 v237, v34, v35
  v_cvt_pk_bf16_f32 v238, v36, v37
  v_cvt_pk_bf16_f32 v239, v38, v39
  ds_write_b128 v17, v[236:239] offset:0
  v_pk_add_f32 v[40:41], v[40:41], v[192:193]
  v_pk_add_f32 v[42:43], v[42:43], v[194:195]
  v_pk_add_f32 v[44:45], v[44:45], v[196:197]
  v_pk_add_f32 v[46:47], v[46:47], v[198:199]
  v_cvt_pk_bf16_f32 v240, v40, v41
  v_cvt_pk_bf16_f32 v241, v42, v43
  v_cvt_pk_bf16_f32 v242, v44, v45
  v_cvt_pk_bf16_f32 v243, v46, v47
  ds_write_b128 v17, v[240:243] offset:64
  v_pk_add_f32 v[48:49], v[48:49], v[200:201]
  v_pk_add_f32 v[50:51], v[50:51], v[202:203]
  v_cvt_pk_bf16_f32 v244, v48, v49
  v_cvt_pk_bf16_f32 v245, v50, v51
  ds_write_b64 v18, v[244:245] offset:128
  ds_read_b128 v[204:207], v16 offset:0
  ds_read_b128 v[208:211], v16 offset:1024
  ds_read_b128 v[212:215], v16 offset:2048
  s_waitcnt lgkmcnt(2)
  buffer_store_dwordx4 v[204:207], v19, s[20:23], s48 offen
  s_waitcnt lgkmcnt(1)
  buffer_store_dwordx4 v[208:211], v20, s[20:23], s48 offen
  s_not_b64 exec, s[44:45]
  s_waitcnt lgkmcnt(0)
  buffer_store_dwordx4 v[212:215], v21, s[20:23], s48 offen
  s_mov_b64 exec, -1
Lmain_end:
  s_endpgm
Lfs_1:
  s_nop 15
  s_mov_b32 s60, 200000
Lpl_3:
  buffer_load_dword v60, v59, s[12:15], s94 offen sc1
  s_sub_u32 s60, s60, 1
  s_cbranch_scc1 Lpd_4
  s_waitcnt vmcnt(0)
  v_cmp_ne_u32 vcc, s37, v60
  s_nop 3
  s_cbranch_vccz Lpd_4
  s_sleep 4
  s_branch Lpl_3
Lpd_4:
  s_waitcnt vmcnt(0)
  s_branch Lfb_2
Lss_5:
  s_nop 15
  s_mov_b32 s60, 200000
Lsl_7:
  buffer_load_dwordx4 v[192:195], v46, s[12:15], 0 offen offset:0 sc1
  buffer_load_dwordx4 v[196:199], v46, s[12:15], 0 offen offset:512 sc1
  buffer_load_dwordx4 v[200:203], v46, s[12:15], 0 offen offset:1024 sc1
  buffer_load_dwordx4 v[204:207], v46, s[12:15], 0 offen offset:1536 sc1
  buffer_load_dwordx4 v[208:211], v46, s[12:15], 0 offen offset:2048 sc1
  buffer_load_dwordx2 v[212:213], v47, s[12:15], 0 offen offset:0 sc1
  buffer_load_dwordx2 v[214:215], v47, s[12:15], 0 offen offset:256 sc1
  buffer_load_dwordx2 v[216:217], v47, s[12:15], 0 offen offset:512 sc1
  buffer_load_dwordx2 v[218:219], v47, s[12:15], 0 offen offset:768 sc1
  buffer_load_dwordx2 v[220:221], v47, s[12:15], 0 offen offset:1024 sc1
  s_waitcnt vmcnt(0)
  s_sub_u32 s60, s60, 1
  s_cbranch_scc1 Lsb_6
  v_xor_b32 v51, s37, v221
  v_bitop3_b32 v51, v193, s37, v51 bitop3:0xbe
  v_bitop3_b32 v51, v195, s37, v51 bitop3:0xbe
  v_bitop3_b32 v51, v197, s37, v51 bitop3:0xbe
  v_bitop3_b32 v51, v199, s37, v51 bitop3:0xbe
  v_bitop3_b32 v51, v201, s37, v51 bitop3:0xbe
  v_bitop3_b32 v51, v203, s37, v51 bitop3:0xbe
  v_bitop3_b32 v51, v205, s37, v51 bitop3:0xbe
  v_bitop3_b32 v51, v207, s37, v51 bitop3:0xbe
  v_bitop3_b32 v51, v209, s37, v51 bitop3:0xbe
  v_bitop3_b32 v51, v211, s37, v51 bitop3:0xbe
  v_bitop3_b32 v51, v213, s37, v51 bitop3:0xbe
  v_bitop3_b32 v51, v215, s37, v51 bitop3:0xbe
  v_bitop3_b32 v51, v217, s37, v51 bitop3:0xbe
  v_bitop3_b32 v51, v219, s37, v51 bitop3:0xbe
  v_cmp_ne_u32 vcc, 0, v51
  s_nop 3
  s_cbranch_vccz Lsb_6
  s_sleep 4
  s_branch Lsl_7
Lfs_13:
  s_nop 15
  s_mov_b32 s60, 200000
Lpl_15:
  buffer_load_dword v60, v59, s[12:15], s94 offen sc1
  s_sub_u32 s60, s60, 1
  s_cbranch_scc1 Lpd_16
  s_waitcnt vmcnt(0)
  v_cmp_ne_u32 vcc, s37, v60
  s_nop 3
  s_cbranch_vccz Lpd_16
  s_sleep 4
  s_branch Lpl_15
Lpd_16:
  s_waitcnt vmcnt(0)
  s_branch Lfb_14
Lss_17:
  s_nop 15
  s_mov_b32 s60, 200000
Lsl_19:
  buffer_load_dwordx4 v[192:195], v46, s[12:15], 0 offen offset:0 sc1
  buffer_load_dwordx4 v[196:199], v46, s[12:15], 0 offen offset:512 sc1
  buffer_load_dwordx4 v[200:203], v46, s[12:15], 0 offen offset:1024 sc1
  buffer_load_dwordx4 v[204:207], v46, s[12:15], 0 offen offset:1536 sc1
  buffer_load_dwordx4 v[208:211], v46, s[12:15], 0 offen offset:2048 sc1
  buffer_load_dwordx2 v[212:213], v47, s[12:15], 0 offen offset:0 sc1
  buffer_load_dwordx2 v[214:215], v47, s[12:15], 0 offen offset:256 sc1
  buffer_load_dwordx2 v[216:217], v47, s[12:15], 0 offen offset:512 sc1
  buffer_load_dwordx2 v[218:219], v47, s[12:15], 0 offen offset:768 sc1
  buffer_load_dwordx2 v[220:221], v47, s[12:15], 0 offen offset:1024 sc1
  s_waitcnt vmcnt(0)
  s_sub_u32 s60, s60, 1
  s_cbranch_scc1 Lsb_18
  v_xor_b32 v51, s37, v221
  v_bitop3_b32 v51, v193, s37, v51 bitop3:0xbe
  v_bitop3_b32 v51, v195, s37, v51 bitop3:0xbe
  v_bitop3_b32 v51, v197, s37, v51 bitop3:0xbe
  v_bitop3_b32 v51, v199, s37, v51 bitop3:0xbe
  v_bitop3_b32 v51, v201, s37, v51 bitop3:0xbe
  v_bitop3_b32 v51, v203, s37, v51 bitop3:0xbe
  v_bitop3_b32 v51, v205, s37, v51 bitop3:0xbe
  v_bitop3_b32 v51, v207, s37, v51 bitop3:0xbe
  v_bitop3_b32 v51, v209, s37, v51 bitop3:0xbe
  v_bitop3_b32 v51, v211, s37, v51 bitop3:0xbe
  v_bitop3_b32 v51, v213, s37, v51 bitop3:0xbe
  v_bitop3_b32 v51, v215, s37, v51 bitop3:0xbe
  v_bitop3_b32 v51, v217, s37, v51 bitop3:0xbe
  v_bitop3_b32 v51, v219, s37, v51 bitop3:0xbe
  v_cmp_ne_u32 vcc, 0, v51
  s_nop 3
  s_cbranch_vccz Lsb_18
  s_sleep 4
  s_branch Lsl_19
Lp1_idle:
  s_load_dwordx2 s[30:31], s[0:1], 16
  s_load_dwordx4 s[32:35], s[0:1], 32
  s_load_dwordx2 s[20:21], s[0:1], 48
  s_mov_b32 s10, 2457600
  s_lshl2_add_u32 s56, s38, s36
  s_mov_b32 s26, 819200
  s_mov_b32 s27, 0x20000
  v_add_u32 v28, 0, v1
  v_mul_u32_u24 v29, 6554, v28
  v_lshrrev_b32 v30, 16, v29
  v_mul_u32_u24 v30, 70, v30
  v_add_u32 v28, v28, v30
  v_lshrrev_b32 v30, 20, v29
  v_mul_u32_u24 v30, 320, v30
  v_add_lshl_u32 v52, v28, v30, 4
  v_lshrrev_b32 v30, 18, v29
  v_mul_u32_u24 v30, 1280, v30
  v_add_lshl_u32 v44, v28, v30, 4
  v_add_u32 v28, 64, v1
  v_mul_u32_u24 v29, 6554, v28
  v_lshrrev_b32 v30, 16, v29
  v_mul_u32_u24 v30, 70, v30
  v_add_u32 v28, v28, v30
  v_lshrrev_b32 v30, 20, v29
  v_mul_u32_u24 v30, 320, v30
  v_add_lshl_u32 v53, v28, v30, 4
  v_lshrrev_b32 v30, 18, v29
  v_mul_u32_u24 v30, 1280, v30
  v_add_lshl_u32 v45, v28, v30, 4
  v_add_u32 v28, 128, v1
  v_mul_u32_u24 v29, 6554, v28
  v_lshrrev_b32 v30, 16, v29
  v_mul_u32_u24 v30, 70, v30
  v_add_u32 v28, v28, v30
  v_lshrrev_b32 v30, 20, v29
  v_mul_u32_u24 v30, 320, v30
  v_add_lshl_u32 v54, v28, v30, 4
  v_lshrrev_b32 v30, 18, v29
  v_mul_u32_u24 v30, 1280, v30
  v_add_lshl_u32 v46, v28, v30, 4
  v_add_u32 v28, 192, v1
  v_mul_u32_u24 v29, 6554, v28
  v_lshrrev_b32 v30, 16, v29
  v_mul_u32_u24 v30, 70, v30
  v_add_u32 v28, v28, v30
  v_lshrrev_b32 v30, 20, v29
  v_mul_u32_u24 v30, 320, v30
  v_add_lshl_u32 v55, v28, v30, 4
  v_lshrrev_b32 v30, 18, v29
  v_mul_u32_u24 v30, 1280, v30
  v_add_lshl_u32 v47, v28, v30, 4
  v_add_u32 v28, 256, v1
  v_mul_u32_u24 v29, 6554, v28
  v_lshrrev_b32 v30, 16, v29
  v_mul_u32_u24 v30, 70, v30
  v_add_u32 v28, v28, v30
  v_lshrrev_b32 v30, 20, v29
  v_mul_u32_u24 v30, 320, v30
  v_add_lshl_u32 v56, v28, v30, 4
  v_lshrrev_b32 v30, 18, v29
  v_mul_u32_u24 v30, 1280, v30
  v_add_lshl_u32 v48, v28, v30, 4
  s_waitcnt lgkmcnt(0)
  s_mov_b32 s24, s30
  s_mov_b32 s25, s31
  s_add_u32 s96, s12, 29130752
  s_addc_u32 s97, s13, 0
  s_load_dword s37, s[96:97], 0
  s_and_b32 s48, s56, 7
  s_mul_i32 s48, s48, 160
  s_lshr_b32 s49, s56, 3
  s_mul_i32 s57, s49, 51200
  s_add_u32 s57, s57, s48
  s_mul_i32 s60, s36, 40960
  s_add_u32 m0, s60, 0
  s_nop 0
  buffer_load_dwordx4 v52, s[24:27], s57 offen  lds
  s_add_u32 m0, s60, 1024
  s_nop 0
  buffer_load_dwordx4 v53, s[24:27], s57 offen  lds
  s_add_u32 m0, s60, 2048
  s_nop 0
  buffer_load_dwordx4 v54, s[24:27], s57 offen  lds
  s_add_u32 m0, s60, 3072
  s_nop 0
  buffer_load_dwordx4 v55, s[24:27], s57 offen  lds
  s_add_u32 m0, s60, 4096
  s_nop 0
  buffer_load_dwordx4 v56, s[24:27], s57 offen  lds
  s_mul_i32 s57, s49, 51200
  s_add_u32 s57, s57, s48
  s_add_u32 s57, s57, 409600
  s_mul_i32 s60, s36, 40960
  s_add_u32 m0, s60, 5120
  s_nop 0
  buffer_load_dwordx4 v52, s[24:27], s57 offen  lds
  s_add_u32 m0, s60, 6144
  s_nop 0
  buffer_load_dwordx4 v53, s[24:27], s57 offen  lds
  s_add_u32 m0, s60, 7168
  s_nop 0
  buffer_load_dwordx4 v54, s[24:27], s57 offen  lds
  s_add_u32 m0, s60, 8192
  s_nop 0
  buffer_load_dwordx4 v55, s[24:27], s57 offen  lds
  s_add_u32 m0, s60, 9216
  s_nop 0
  buffer_load_dwordx4 v56, s[24:27], s57 offen  lds
  s_mul_i32 s57, s49, 204800
  s_add_u32 s57, s57, s48
  s_add_u32 s57, s57, 20480
  s_cmp_lt_u32 s56, 32
  s_cselect_b32 s26, s26, 0
  s_mul_i32 s60, s36, 40960
  s_add_u32 m0, s60, 10240
  s_nop 0
  buffer_load_dwordx4 v44, s[24:27], s57 offen  lds
  s_add_u32 m0, s60, 11264
  s_nop 0
  buffer_load_dwordx4 v45, s[24:27], s57 offen  lds
  s_add_u32 m0, s60, 12288
  s_nop 0
  buffer_load_dwordx4 v46, s[24:27], s57 offen  lds
  s_add_u32 m0, s60, 13312
  s_nop 0
  buffer_load_dwordx4 v47, s[24:27], s57 offen  lds
  s_add_u32 m0, s60, 14336
  s_nop 0
  buffer_load_dwordx4 v48, s[24:27], s57 offen  lds
  v_lshlrev_b32 v2, 4, v1
  s_mov_b32 s14, 29786112
  s_mov_b32 s15, 0x20000
  s_mov_b32 s22, 2621440
  s_mov_b32 s23, 0x20000
  s_mov_b32 s44, 0
  s_mov_b32 s45, -1
  s_mov_b32 s46, 0xffff0000
  s_mov_b32 s94, 29097984
  s_and_b32 s48, s2, 7
  s_lshr_b32 s49, s2, 3
  s_lshr_b32 s40, s49, 3
  s_lshl2_add_u32 s40, s48, s40
  s_and_b32 s41, s49, 7
  s_lshr_b32 s42, s40, 1
  s_and_b32 s85, s2, 1
  s_lshl3_add_u32 s43, s85, s41
  s_andn2_b32 s3, s40, 4
  s_and_b32 s48, s36, 2
  s_lshl1_add_u32 s3, s48, s3
  s_and_b32 s48, s36, 1
  s_lshl1_add_u32 s3, s3, s48
  s_lshl2_add_u32 s47, s41, s36
  s_and_b32 s93, s41, 0
  s_xor_b32 s93, s93, s36
  s_getreg_b32 s87, hwreg(HW_REG_XCC_ID, 0, 4)
  s_mul_i32 s90, s47, 25600
  s_add_u32 s90, s90, 20582400
  s_lshl2_add_u32 s91, s43, s36
  s_mul_i32 s91, s91, 35840
  s_add_u32 s91, s91, 21397504
  s_mul_i32 s95, s36, 35840
  s_lshl2_add_u32 s85, s85, s36
  s_lshl3_add_u32 s92, s41, s85
  s_mul_i32 s92, s92, 35840
  s_add_u32 s92, s92, 23695360
  s_mul_i32 s48, s36, 640
  s_lshl_b32 s49, s41, 12
  s_add_u32 s48, s48, s49
  s_add_u32 s48, s48, 262144
  v_min_u32 v59, 4, v1
  v_lshl_add_u32 v59, v59, 7, s48
  s_mov_b32 s16, s12
  s_mov_b32 s17, s13
  s_mov_b32 s19, 0x20000
  s_and_b32 s82, s56, 15
  s_lshr_b32 s83, s56, 4
  s_mul_i32 s83, s83, 5
  s_mul_i32 s98, s82, 20
  s_add_u32 s98, s98, s83
  s_mul_i32 s98, s98, 7168
  s_add_u32 s98, s98, 21397504
  s_lshl_b32 s99, s82, 5
  s_add_u32 s99, s99, s83
  s_lshl_b32 s99, s99, 7
  s_add_u32 s99, s99, 29163520
  s_mov_b32 s24, s32
  s_mov_b32 s25, s33
  s_mul_i32 s80, s82, 216
  s_and_b32 s80, s80, -16
  s_mul_i32 s83, s83, 110592
  s_add_u32 s80, s80, s83
  s_mov_b32 s26, 2211840
  v_add_u32 v16, 0, v1
  v_mul_u32_u24 v17, 4682, v16
  v_lshrrev_b32 v17, 16, v17
  v_mul_u32_u24 v17, 3232, v17
  v_lshl_add_u32 v16, v16, 4, s80
  v_add_u32 v52, v16, v17
  v_add_u32 v16, 64, v1
  v_mul_u32_u24 v17, 4682, v16
  v_lshrrev_b32 v17, 16, v17
  v_mul_u32_u24 v17, 3232, v17
  v_lshl_add_u32 v16, v16, 4, s80
  v_add_u32 v53, v16, v17
  v_add_u32 v16, 128, v1
  v_mul_u32_u24 v17, 4682, v16
  v_lshrrev_b32 v17, 16, v17
  v_mul_u32_u24 v17, 3232, v17
  v_lshl_add_u32 v16, v16, 4, s80
  v_add_u32 v54, v16, v17
  v_add_u32 v16, 192, v1
  v_mul_u32_u24 v17, 4682, v16
  v_lshrrev_b32 v17, 16, v17
  v_mul_u32_u24 v17, 3232, v17
  v_lshl_add_u32 v16, v16, 4, s80
  v_add_u32 v55, v16, v17
  v_add_u32 v16, 256, v1
  v_mul_u32_u24 v17, 4682, v16
  v_lshrrev_b32 v17, 16, v17
  v_mul_u32_u24 v17, 3232, v17
  v_lshl_add_u32 v16, v16, 4, s80
  v_add_u32 v56, v16, v17
  v_add_u32 v16, 320, v1
  v_mul_u32_u24 v17, 4682, v16
  v_lshrrev_b32 v17, 16, v17
  v_mul_u32_u24 v17, 3232, v17
  v_lshl_add_u32 v16, v16, 4, s80
  v_add_u32 v57, v16, v17
  v_add_u32 v16, 384, v1
  v_mul_u32_u24 v17, 4682, v16
  v_lshrrev_b32 v17, 16, v17
  v_mul_u32_u24 v17, 3232, v17
  v_lshl_add_u32 v16, v16, 4, s80
  v_add_u32 v58, v16, v17
  v_lshlrev_b32 v8, 7, v1
  s_waitcnt lgkmcnt(0)
  s_add_u32 s37, s37, 1564122216
  s_barrier
  s_lshl3_add_u32 s48, s40, s41
  s_lshl_b32 s48, s48, 7
  s_add_u32 s48, s48, 29229056
  s_add_u32 s49, s37, s87
  v_mov_b32 v61, s49
  v_lshrrev_b32 v62, 5, v0
  v_lshlrev_b32 v62, 27, v62
  v_lshl_add_u32 v62, v0, 2, v62
  buffer_store_dword v61, v62, s[12:15], s48 offen sc1
  v_mov_b32 v254, s37
  s_mul_i32 s49, s36, 40960
  s_add_u32 s49, s49, 0
  v_lshrrev_b32 v16, 4, v1
  v_bfe_u32 v17, v1, 2, 2
  v_lshl_add_u32 v16, v16, 3, v17
  v_mul_u32_u24 v16, 160, v16
  v_add_u32 v16, s49, v16
  v_and_b32 v17, 3, v1
  v_lshl_add_u32 v18, v17, 4, v16
  v_lshl_add_u32 v19, v17, 3, v16
  s_mul_i32 s49, s36, 40960
  s_and_b32 s50, s36, 1
  s_lshl3_add_u32 s49, s50, s49
  s_add_u32 s49, s49, 15360
  v_lshrrev_b32 v22, 4, v1
  v_bfe_u32 v23, v1, 2, 2
  v_lshl_add_u32 v22, v22, 3, v23
  v_mul_u32_u24 v22, 224, v22
  v_add_u32 v22, s49, v22
  v_and_b32 v23, 3, v1
  v_lshl_add_u32 v24, v23, 4, v22
  v_lshl_add_u32 v25, v23, 3, v22
  s_mov_b32 s57, 0
  s_mul_i32 s60, s36, 40960
  s_add_u32 m0, s60, 15360
  s_nop 0
  buffer_load_dwordx4 v52, s[24:27], s57 offen  lds
  s_add_u32 m0, s60, 16384
  s_nop 0
  buffer_load_dwordx4 v53, s[24:27], s57 offen  lds
  s_add_u32 m0, s60, 17408
  s_nop 0
  buffer_load_dwordx4 v54, s[24:27], s57 offen  lds
  s_add_u32 m0, s60, 18432
  s_nop 0
  buffer_load_dwordx4 v55, s[24:27], s57 offen  lds
  s_add_u32 m0, s60, 19456
  s_nop 0
  buffer_load_dwordx4 v56, s[24:27], s57 offen  lds
  s_add_u32 m0, s60, 20480
  s_nop 0
  buffer_load_dwordx4 v57, s[24:27], s57 offen  lds
  s_add_u32 m0, s60, 21504
  s_nop 0
  buffer_load_dwordx4 v58, s[24:27], s57 offen  lds
  s_lshr_b32 s62, s56, 3
  s_lshr_b32 s63, s62, 2
  s_add_u32 s62, s62, s63
  s_add_u32 s62, s62, 0
  s_mov_b32 s100, 1
  s_and_b32 s63, s56, 7
  s_mul_i32 s98, s63, 20
  s_add_u32 s98, s98, s62
  s_mul_i32 s98, s98, 5120
  s_add_u32 s98, s98, 20578304
  s_lshl_b32 s99, s63, 5
  s_add_u32 s99, s99, s62
  s_lshl_b32 s99, s99, 7
  s_add_u32 s99, s99, 29360128
  s_cmp_lg_u32 s100, 0
  s_cselect_b32 s18, 29786112, 0
  s_waitcnt vmcnt(18)
  ds_read_b64_tr_b16 v[64:65], v18 offset:0
  ds_read_b64_tr_b16 v[66:67], v18 offset:640
  ds_read_b64_tr_b16 v[68:69], v18 offset:8
  ds_read_b64_tr_b16 v[70:71], v18 offset:648
  ds_read_b64_tr_b16 v[72:73], v18 offset:64
  ds_read_b64_tr_b16 v[74:75], v18 offset:704
  ds_read_b64_tr_b16 v[76:77], v18 offset:72
  ds_read_b64_tr_b16 v[78:79], v18 offset:712
  ds_read_b64_tr_b16 v[80:81], v19 offset:128
  ds_read_b64_tr_b16 v[82:83], v19 offset:768
  s_waitcnt lgkmcnt(8)
  buffer_store_dwordx4 v[64:67], v2, s[16:19], s98 offen offset:0 sc1
  s_waitcnt lgkmcnt(6)
  buffer_store_dwordx4 v[68:71], v2, s[16:19], s98 offen offset:1024 sc1
  s_waitcnt lgkmcnt(4)
  buffer_store_dwordx4 v[72:75], v2, s[16:19], s98 offen offset:2048 sc1
  s_waitcnt lgkmcnt(2)
  buffer_store_dwordx4 v[76:79], v2, s[16:19], s98 offen offset:3072 sc1
  s_add_u32 s98, s98, 4096
  s_waitcnt lgkmcnt(0)
  buffer_store_dwordx4 v[80:83], v2, s[16:19], s98 offen offset:0 sc1
  s_lshr_b32 s62, s56, 3
  s_lshr_b32 s63, s62, 2
  s_add_u32 s62, s62, s63
  s_add_u32 s62, s62, 10
  s_mov_b32 s100, 1
  s_and_b32 s63, s56, 7
  s_mul_i32 s98, s63, 20
  s_add_u32 s98, s98, s62
  s_mul_i32 s98, s98, 5120
  s_add_u32 s98, s98, 20578304
  s_lshl_b32 s99, s63, 5
  s_add_u32 s99, s99, s62
  s_lshl_b32 s99, s99, 7
  s_add_u32 s99, s99, 29360128
  s_cmp_lg_u32 s100, 0
  s_cselect_b32 s18, 29786112, 0
  s_waitcnt vmcnt(18)
  ds_read_b64_tr_b16 v[84:85], v18 offset:5120
  ds_read_b64_tr_b16 v[86:87], v18 offset:5760
  ds_read_b64_tr_b16 v[88:89], v18 offset:5128
  ds_read_b64_tr_b16 v[90:91], v18 offset:5768
  ds_read_b64_tr_b16 v[92:93], v18 offset:5184
  ds_read_b64_tr_b16 v[94:95], v18 offset:5824
  ds_read_b64_tr_b16 v[96:97], v18 offset:5192
  ds_read_b64_tr_b16 v[98:99], v18 offset:5832
  ds_read_b64_tr_b16 v[100:101], v19 offset:5248
  ds_read_b64_tr_b16 v[102:103], v19 offset:5888
  s_waitcnt lgkmcnt(8)
  buffer_store_dwordx4 v[84:87], v2, s[16:19], s98 offen offset:0 sc1
  s_waitcnt lgkmcnt(6)
  buffer_store_dwordx4 v[88:91], v2, s[16:19], s98 offen offset:1024 sc1
  s_waitcnt lgkmcnt(4)
  buffer_store_dwordx4 v[92:95], v2, s[16:19], s98 offen offset:2048 sc1
  s_waitcnt lgkmcnt(2)
  buffer_store_dwordx4 v[96:99], v2, s[16:19], s98 offen offset:3072 sc1
  s_add_u32 s98, s98, 4096
  s_waitcnt lgkmcnt(0)
  buffer_store_dwordx4 v[100:103], v2, s[16:19], s98 offen offset:0 sc1
  s_lshr_b32 s62, s56, 3
  s_mul_i32 s62, s62, 5
  s_add_u32 s62, s62, 4
  s_cmp_lt_u32 s56, 32
  s_cselect_b32 s100, 1, 0
  s_and_b32 s63, s56, 7
  s_mul_i32 s98, s63, 20
  s_add_u32 s98, s98, s62
  s_mul_i32 s98, s98, 5120
  s_add_u32 s98, s98, 20578304
  s_lshl_b32 s99, s63, 5
  s_add_u32 s99, s99, s62
  s_lshl_b32 s99, s99, 7
  s_add_u32 s99, s99, 29360128
  s_cmp_lg_u32 s100, 0
  s_cselect_b32 s18, 29786112, 0
  s_waitcnt vmcnt(18)
  ds_read_b64_tr_b16 v[104:105], v18 offset:10240
  ds_read_b64_tr_b16 v[106:107], v18 offset:10880
  ds_read_b64_tr_b16 v[108:109], v18 offset:10248
  ds_read_b64_tr_b16 v[110:111], v18 offset:10888
  ds_read_b64_tr_b16 v[112:113], v18 offset:10304
  ds_read_b64_tr_b16 v[114:115], v18 offset:10944
  ds_read_b64_tr_b16 v[116:117], v18 offset:10312
  ds_read_b64_tr_b16 v[118:119], v18 offset:10952
  ds_read_b64_tr_b16 v[120:121], v19 offset:10368
  ds_read_b64_tr_b16 v[122:123], v19 offset:11008
  s_waitcnt lgkmcnt(8)
  buffer_store_dwordx4 v[104:107], v2, s[16:19], s98 offen offset:0 sc1
  s_waitcnt lgkmcnt(6)
  buffer_store_dwordx4 v[108:111], v2, s[16:19], s98 offen offset:1024 sc1
  s_waitcnt lgkmcnt(4)
  buffer_store_dwordx4 v[112:115], v2, s[16:19], s98 offen offset:2048 sc1
  s_waitcnt lgkmcnt(2)
  buffer_store_dwordx4 v[116:119], v2, s[16:19], s98 offen offset:3072 sc1
  s_add_u32 s98, s98, 4096
  s_waitcnt lgkmcnt(0)
  buffer_store_dwordx4 v[120:123], v2, s[16:19], s98 offen offset:0 sc1
  s_mov_b32 s57, 110592
  s_mul_i32 s60, s36, 40960
  s_add_u32 m0, s60, 22528
  s_nop 0
  buffer_load_dwordx4 v52, s[24:27], s57 offen  lds
  s_add_u32 m0, s60, 23552
  s_nop 0
  buffer_load_dwordx4 v53, s[24:27], s57 offen  lds
  s_add_u32 m0, s60, 24576
  s_nop 0
  buffer_load_dwordx4 v54, s[24:27], s57 offen  lds
  s_add_u32 m0, s60, 25600
  s_nop 0
  buffer_load_dwordx4 v55, s[24:27], s57 offen  lds
  s_add_u32 m0, s60, 26624
  s_nop 0
  buffer_load_dwordx4 v56, s[24:27], s57 offen  lds
  s_add_u32 m0, s60, 27648
  s_nop 0
  buffer_load_dwordx4 v57, s[24:27], s57 offen  lds
  s_add_u32 m0, s60, 28672
  s_nop 0
  buffer_load_dwordx4 v58, s[24:27], s57 offen  lds
  s_lshr_b32 s62, s56, 3
  s_lshr_b32 s63, s62, 2
  s_add_u32 s62, s62, s63
  s_add_u32 s62, s62, 0
  s_mov_b32 s100, 1
  s_and_b32 s63, s56, 7
  s_mul_i32 s98, s63, 20
  s_add_u32 s98, s98, s62
  s_mul_i32 s98, s98, 5120
  s_add_u32 s98, s98, 20578304
  s_lshl_b32 s99, s63, 5
  s_add_u32 s99, s99, s62
  s_lshl_b32 s99, s99, 7
  s_add_u32 s99, s99, 29360128
  s_cmp_lg_u32 s100, 0
  s_cselect_b32 s18, 29786112, 0
  s_waitcnt vmcnt(17)
  v_mov_b32 v254, s37
  v_lshlrev_b32 v253, 2, v1
  s_not_b64 exec, s[44:45]
  buffer_store_dword v254, v253, s[16:19], s99 offen sc1
  s_mov_b64 exec, -1
  s_lshr_b32 s62, s56, 3
  s_lshr_b32 s63, s62, 2
  s_add_u32 s62, s62, s63
  s_add_u32 s62, s62, 10
  s_mov_b32 s100, 1
  s_and_b32 s63, s56, 7
  s_mul_i32 s98, s63, 20
  s_add_u32 s98, s98, s62
  s_mul_i32 s98, s98, 5120
  s_add_u32 s98, s98, 20578304
  s_lshl_b32 s99, s63, 5
  s_add_u32 s99, s99, s62
  s_lshl_b32 s99, s99, 7
  s_add_u32 s99, s99, 29360128
  s_cmp_lg_u32 s100, 0
  s_cselect_b32 s18, 29786112, 0
  s_waitcnt vmcnt(13)
  v_mov_b32 v254, s37
  v_lshlrev_b32 v253, 2, v1
  s_not_b64 exec, s[44:45]
  buffer_store_dword v254, v253, s[16:19], s99 offen sc1
  s_mov_b64 exec, -1
  s_lshr_b32 s62, s56, 3
  s_mul_i32 s62, s62, 5
  s_add_u32 s62, s62, 4
  s_cmp_lt_u32 s56, 32
  s_cselect_b32 s100, 1, 0
  s_and_b32 s63, s56, 7
  s_mul_i32 s98, s63, 20
  s_add_u32 s98, s98, s62
  s_mul_i32 s98, s98, 5120
  s_add_u32 s98, s98, 20578304
  s_lshl_b32 s99, s63, 5
  s_add_u32 s99, s99, s62
  s_lshl_b32 s99, s99, 7
  s_add_u32 s99, s99, 29360128
  s_cmp_lg_u32 s100, 0
  s_cselect_b32 s18, 29786112, 0
  s_waitcnt vmcnt(9)
  v_mov_b32 v254, s37
  v_lshlrev_b32 v253, 2, v1
  s_not_b64 exec, s[44:45]
  buffer_store_dword v254, v253, s[16:19], s99 offen sc1
  s_mov_b64 exec, -1
  s_mov_b32 s18, 29786112
  s_lshr_b32 s83, s56, 4
  s_mul_i32 s83, s83, 5
  s_add_u32 s83, s83, 0
  s_mul_i32 s98, s82, 20
  s_add_u32 s98, s98, s83
  s_mul_i32 s98, s98, 7168
  s_add_u32 s98, s98, 21397504
  s_lshl_b32 s99, s82, 5
  s_add_u32 s99, s99, s83
  s_lshl_b32 s99, s99, 7
  s_add_u32 s99, s99, 29163520
  ds_read_b64_tr_b16 v[124:125], v24 offset:0
  ds_read_b64_tr_b16 v[126:127], v24 offset:896
  ds_read_b64_tr_b16 v[128:129], v24 offset:8
  ds_read_b64_tr_b16 v[130:131], v24 offset:904
  ds_read_b64_tr_b16 v[132:133], v24 offset:64
  ds_read_b64_tr_b16 v[134:135], v24 offset:960
  ds_read_b64_tr_b16 v[136:137], v24 offset:72
  ds_read_b64_tr_b16 v[138:139], v24 offset:968
  ds_read_b64_tr_b16 v[140:141], v24 offset:128
  ds_read_b64_tr_b16 v[142:143], v24 offset:1024
  ds_read_b64_tr_b16 v[144:145], v24 offset:136
  ds_read_b64_tr_b16 v[146:147], v24 offset:1032
  ds_read_b64_tr_b16 v[148:149], v25 offset:192
  ds_read_b64_tr_b16 v[150:151], v25 offset:1088
  s_waitcnt lgkmcnt(12)
  buffer_store_dwordx4 v[124:127], v2, s[16:19], s98 offen offset:0 sc1
  s_waitcnt lgkmcnt(10)
  buffer_store_dwordx4 v[128:131], v2, s[16:19], s98 offen offset:1024 sc1
  s_waitcnt lgkmcnt(8)
  buffer_store_dwordx4 v[132:135], v2, s[16:19], s98 offen offset:2048 sc1
  s_waitcnt lgkmcnt(6)
  buffer_store_dwordx4 v[136:139], v2, s[16:19], s98 offen offset:3072 sc1
  s_add_u32 s98, s98, 4096
  s_waitcnt lgkmcnt(4)
  buffer_store_dwordx4 v[140:143], v2, s[16:19], s98 offen offset:0 sc1
  s_waitcnt lgkmcnt(2)
  buffer_store_dwordx4 v[144:147], v2, s[16:19], s98 offen offset:1024 sc1
  v_and_b32 v22, 15, v1
  v_cmp_gt_u32 vcc, 12, v22
  s_waitcnt lgkmcnt(1)
  s_nop 0
  v_cndmask_b32 v148, 0, v148, vcc
  v_cndmask_b32 v149, 0, v149, vcc
  s_waitcnt lgkmcnt(0)
  v_cndmask_b32 v150, 0, v150, vcc
  v_cndmask_b32 v151, 0, v151, vcc
  buffer_store_dwordx4 v[148:151], v2, s[16:19], s98 offen offset:2048 sc1
  s_mov_b32 s18, 29786112
  s_lshr_b32 s83, s56, 4
  s_mul_i32 s83, s83, 5
  s_add_u32 s83, s83, 1
  s_mul_i32 s98, s82, 20
  s_add_u32 s98, s98, s83
  s_mul_i32 s98, s98, 7168
  s_add_u32 s98, s98, 21397504
  s_lshl_b32 s99, s82, 5
  s_add_u32 s99, s99, s83
  s_lshl_b32 s99, s99, 7
  s_add_u32 s99, s99, 29163520
  s_waitcnt vmcnt(10)
  ds_read_b64_tr_b16 v[152:153], v24 offset:7168
  ds_read_b64_tr_b16 v[154:155], v24 offset:8064
  ds_read_b64_tr_b16 v[156:157], v24 offset:7176
  ds_read_b64_tr_b16 v[158:159], v24 offset:8072
  ds_read_b64_tr_b16 v[160:161], v24 offset:7232
  ds_read_b64_tr_b16 v[162:163], v24 offset:8128
  ds_read_b64_tr_b16 v[164:165], v24 offset:7240
  ds_read_b64_tr_b16 v[166:167], v24 offset:8136
  ds_read_b64_tr_b16 v[168:169], v24 offset:7296
  ds_read_b64_tr_b16 v[170:171], v24 offset:8192
  ds_read_b64_tr_b16 v[172:173], v24 offset:7304
  ds_read_b64_tr_b16 v[174:175], v24 offset:8200
  ds_read_b64_tr_b16 v[176:177], v25 offset:7360
  ds_read_b64_tr_b16 v[178:179], v25 offset:8256
  s_waitcnt lgkmcnt(12)
  buffer_store_dwordx4 v[152:155], v2, s[16:19], s98 offen offset:0 sc1
  s_waitcnt lgkmcnt(10)
  buffer_store_dwordx4 v[156:159], v2, s[16:19], s98 offen offset:1024 sc1
  s_waitcnt lgkmcnt(8)
  buffer_store_dwordx4 v[160:163], v2, s[16:19], s98 offen offset:2048 sc1
  s_waitcnt lgkmcnt(6)
  buffer_store_dwordx4 v[164:167], v2, s[16:19], s98 offen offset:3072 sc1
  s_add_u32 s98, s98, 4096
  s_waitcnt lgkmcnt(4)
  buffer_store_dwordx4 v[168:171], v2, s[16:19], s98 offen offset:0 sc1
  s_waitcnt lgkmcnt(2)
  buffer_store_dwordx4 v[172:175], v2, s[16:19], s98 offen offset:1024 sc1
  v_and_b32 v22, 15, v1
  v_cmp_gt_u32 vcc, 12, v22
  s_waitcnt lgkmcnt(1)
  s_nop 0
  v_cndmask_b32 v176, 0, v176, vcc
  v_cndmask_b32 v177, 0, v177, vcc
  s_waitcnt lgkmcnt(0)
  v_cndmask_b32 v178, 0, v178, vcc
  v_cndmask_b32 v179, 0, v179, vcc
  buffer_store_dwordx4 v[176:179], v2, s[16:19], s98 offen offset:2048 sc1
  s_cmp_ge_u32 s40, 4
  s_cselect_b32 s81, 0x3f803f80, 0
  v_mov_b32 v63, s81
  v_accvgpr_write_b32 a0, v63
  v_accvgpr_write_b32 a1, v63
  v_accvgpr_write_b32 a2, v63
  v_accvgpr_write_b32 a3, v63
  v_accvgpr_write_b32 a4, v63
  v_accvgpr_write_b32 a5, v63
  v_accvgpr_write_b32 a6, v63
  v_accvgpr_write_b32 a7, v63
  v_accvgpr_write_b32 a8, v63
  v_accvgpr_write_b32 a9, v63
  v_accvgpr_write_b32 a10, v63
  v_accvgpr_write_b32 a11, v63
  v_accvgpr_write_b32 a12, v63
  v_accvgpr_write_b32 a13, v63
  v_accvgpr_write_b32 a14, v63
  v_accvgpr_write_b32 a15, v63
  s_cmp_ge_u32 s40, 3
  s_cselect_b32 s81, 0x3f803f80, 0
  v_mov_b32 v63, s81
  v_accvgpr_write_b32 a16, v63
  v_accvgpr_write_b32 a17, v63
  v_accvgpr_write_b32 a18, v63
  v_accvgpr_write_b32 a19, v63
  v_accvgpr_write_b32 a20, v63
  v_accvgpr_write_b32 a21, v63
  v_accvgpr_write_b32 a22, v63
  v_accvgpr_write_b32 a23, v63
  v_accvgpr_write_b32 a24, v63
  v_accvgpr_write_b32 a25, v63
  v_accvgpr_write_b32 a26, v63
  v_accvgpr_write_b32 a27, v63
  v_accvgpr_write_b32 a28, v63
  v_accvgpr_write_b32 a29, v63
  v_accvgpr_write_b32 a30, v63
  v_accvgpr_write_b32 a31, v63
  s_cmp_ge_u32 s40, 2
  s_cselect_b32 s81, 0x3f803f80, 0
  v_mov_b32 v63, s81
  v_accvgpr_write_b32 a32, v63
  v_accvgpr_write_b32 a33, v63
  v_accvgpr_write_b32 a34, v63
  v_accvgpr_write_b32 a35, v63
  v_accvgpr_write_b32 a36, v63
  v_accvgpr_write_b32 a37, v63
  v_accvgpr_write_b32 a38, v63
  v_accvgpr_write_b32 a39, v63
  v_accvgpr_write_b32 a40, v63
  v_accvgpr_write_b32 a41, v63
  v_accvgpr_write_b32 a42, v63
  v_accvgpr_write_b32 a43, v63
  v_accvgpr_write_b32 a44, v63
  v_accvgpr_write_b32 a45, v63
  v_accvgpr_write_b32 a46, v63
  v_accvgpr_write_b32 a47, v63
  s_cmp_ge_u32 s40, 1
  s_cselect_b32 s81, 0x3f803f80, 0
  v_mov_b32 v63, s81
  v_accvgpr_write_b32 a48, v63
  v_accvgpr_write_b32 a49, v63
  v_accvgpr_write_b32 a50, v63
  v_accvgpr_write_b32 a51, v63
  v_accvgpr_write_b32 a52, v63
  v_accvgpr_write_b32 a53, v63
  v_accvgpr_write_b32 a54, v63
  v_accvgpr_write_b32 a55, v63
  v_accvgpr_write_b32 a56, v63
  v_accvgpr_write_b32 a57, v63
  v_accvgpr_write_b32 a58, v63
  v_accvgpr_write_b32 a59, v63
  v_accvgpr_write_b32 a60, v63
  v_accvgpr_write_b32 a61, v63
  v_accvgpr_write_b32 a62, v63
  v_accvgpr_write_b32 a63, v63
  s_cmp_ge_u32 s40, 0
  s_cselect_b32 s81, 0x3f803f80, 0
  v_mov_b32 v63, s81
  v_accvgpr_write_b32 a64, v63
  v_accvgpr_write_b32 a65, v63
  v_accvgpr_write_b32 a66, v63
  v_accvgpr_write_b32 a67, v63
  v_accvgpr_write_b32 a68, v63
  v_accvgpr_write_b32 a69, v63
  v_accvgpr_write_b32 a70, v63
  v_accvgpr_write_b32 a71, v63
  v_accvgpr_write_b32 a72, v63
  v_accvgpr_write_b32 a73, v63
  v_accvgpr_write_b32 a74, v63
  v_accvgpr_write_b32 a75, v63
  v_accvgpr_write_b32 a76, v63
  v_accvgpr_write_b32 a77, v63
  v_accvgpr_write_b32 a78, v63
  v_accvgpr_write_b32 a79, v63
  s_mov_b32 s18, 29786112
  s_lshr_b32 s83, s56, 4
  s_mul_i32 s83, s83, 5
  s_add_u32 s83, s83, 0
  s_mul_i32 s98, s82, 20
  s_add_u32 s98, s98, s83
  s_mul_i32 s98, s98, 7168
  s_add_u32 s98, s98, 21397504
  s_lshl_b32 s99, s82, 5
  s_add_u32 s99, s99, s83
  s_lshl_b32 s99, s99, 7
  s_add_u32 s99, s99, 29163520
  s_waitcnt vmcnt(7)
  v_mov_b32 v254, s37
  v_lshlrev_b32 v253, 2, v1
  s_not_b64 exec, s[44:45]
  buffer_store_dword v254, v253, s[16:19], s99 offen sc1
  s_mov_b64 exec, -1
  s_mov_b32 s18, 29786112
  s_lshr_b32 s83, s56, 4
  s_mul_i32 s83, s83, 5
  s_add_u32 s83, s83, 1
  s_mul_i32 s98, s82, 20
  s_add_u32 s98, s98, s83
  s_mul_i32 s98, s98, 7168
  s_add_u32 s98, s98, 21397504
  s_lshl_b32 s99, s82, 5
  s_add_u32 s99, s99, s83
  s_lshl_b32 s99, s99, 7
  s_add_u32 s99, s99, 29163520
  s_waitcnt vmcnt(1)
  v_mov_b32 v254, s37
  v_lshlrev_b32 v253, 2, v1
  s_not_b64 exec, s[44:45]
  buffer_store_dword v254, v253, s[16:19], s99 offen sc1
  s_mov_b64 exec, -1
  s_lshl_b32 s48, s38, 11
  s_add_u32 s48, s48, 29327360
  v_and_b32 v9, 0x780, v8
  buffer_load_dword v240, v9, s[12:15], s48 offen
  s_cmp_lg_u32 s56, 63
  s_cbranch_scc1 Lep_27
  v_lshlrev_b32 v8, 7, v1
  v_add_u32 v9, 131072, v8
  s_mov_b32 s60, 200000
  s_nop 0
Lpl_28:
  buffer_load_dword v254, v9, s[12:15], s94 offen sc1
  s_sub_u32 s60, s60, 1
  s_cbranch_scc1 Lpd_29
  s_waitcnt vmcnt(0)
  v_subrev_u32 v253, s37, v254
  v_cmp_le_u32 vcc, 16, v253
  s_nop 3
  s_cbranch_vccz Lpd_29
  s_sleep 16
  s_branch Lpl_28
Lpd_29:
  s_waitcnt vmcnt(0)
  v_add_u32 v9, 139264, v8
  s_mov_b32 s60, 200000
  s_nop 0
Lpl_30:
  buffer_load_dword v254, v9, s[12:15], s94 offen sc1
  s_sub_u32 s60, s60, 1
  s_cbranch_scc1 Lpd_31
  s_waitcnt vmcnt(0)
  v_subrev_u32 v253, s37, v254
  v_cmp_le_u32 vcc, 16, v253
  s_nop 3
  s_cbranch_vccz Lpd_31
  s_sleep 16
  s_branch Lpl_30
Lpd_31:
  s_waitcnt vmcnt(0)
  v_add_u32 v9, 147456, v8
  s_mov_b32 s60, 200000
  s_nop 0
Lpl_32:
  buffer_load_dword v254, v9, s[12:15], s94 offen sc1
  s_sub_u32 s60, s60, 1
  s_cbranch_scc1 Lpd_33
  s_waitcnt vmcnt(0)
  v_subrev_u32 v253, s37, v254
  v_cmp_le_u32 vcc, 16, v253
  s_nop 3
  s_cbranch_vccz Lpd_33
  s_sleep 16
  s_branch Lpl_32
Lpd_33:
  s_waitcnt vmcnt(0)
  v_add_u32 v9, 155648, v8
  s_mov_b32 s60, 200000
  s_nop 0
Lpl_34:
  buffer_load_dword v254, v9, s[12:15], s94 offen sc1
  s_sub_u32 s60, s60, 1
  s_cbranch_scc1 Lpd_35
  s_waitcnt vmcnt(0)
  v_subrev_u32 v253, s37, v254
  v_cmp_le_u32 vcc, 16, v253
  s_nop 3
  s_cbranch_vccz Lpd_35
  s_sleep 16
  s_branch Lpl_34
Lpd_35:
  s_waitcnt vmcnt(0)
  s_mov_b32 s48, 29130752
  v_mov_b32 v254, s37
  v_lshlrev_b32 v253, 2, v1
  s_not_b64 exec, s[44:45]
  buffer_store_dword v254, v253, s[12:15], s48 offen sc1
  s_mov_b64 exec, -1
Lep_27:
  s_waitcnt vmcnt(0)
  s_mov_b32 s26, 0
  s_mov_b32 s100, 0
  s_mov_b32 s28, 0
  s_mov_b32 s79, 0
  s_mov_b32 s80, 0
  s_mov_b32 s82, 0
  s_mov_b32 s83, 0
  s_mov_b32 s84, 0
  v_mov_b32 v240, 0
  v_mov_b32 v241, 0
  v_mov_b32 v242, 0
  v_mov_b32 v243, 0
  v_mov_b32 v244, 0
  v_mov_b32 v245, 0
  v_mov_b32 v246, 0
  v_mov_b32 v247, 0
  v_mov_b32 v248, 0
  s_lshl_b32 s61, s38, 11
  s_add_u32 s61, s61, 29329280
  s_mov_b32 s60, 200000
Lpl_36:
  buffer_load_dword v60, v59, s[12:15], s94 offen sc1
  s_sub_u32 s60, s60, 1
  s_cbranch_scc1 Lpd_37
  s_waitcnt vmcnt(0)
  v_cmp_ne_u32 vcc, s37, v60
  s_nop 3
  s_cbranch_vccz Lpd_37
  s_sleep 8
  s_branch Lpl_36
Lpd_37:
  s_waitcnt vmcnt(0)
  s_barrier
  v_add_u32 v250, s90, v2
  global_load_dwordx4 a[156:159], v250, s[12:13] offset:-4096 sc1
  global_load_dwordx4 a[160:163], v250, s[12:13] offset:-3072 sc1
  global_load_dwordx4 a[164:167], v250, s[12:13] offset:-2048 sc1
  global_load_dwordx4 a[168:171], v250, s[12:13] offset:-1024 sc1
  global_load_dwordx4 a[172:175], v250, s[12:13] offset:0 sc1
  global_load_dwordx4 a[176:179], v250, s[12:13] offset:1024 sc1
  global_load_dwordx4 a[180:183], v250, s[12:13] offset:2048 sc1
  global_load_dwordx4 a[184:187], v250, s[12:13] offset:3072 sc1
  v_add_u32 v250, 8192, v250
  global_load_dwordx4 a[188:191], v250, s[12:13] offset:-4096 sc1
  global_load_dwordx4 a[192:195], v250, s[12:13] offset:-3072 sc1
  global_load_dwordx4 a[196:199], v250, s[12:13] offset:-2048 sc1
  global_load_dwordx4 a[200:203], v250, s[12:13] offset:-1024 sc1
  global_load_dwordx4 a[204:207], v250, s[12:13] offset:0 sc1
  global_load_dwordx4 a[208:211], v250, s[12:13] offset:1024 sc1
  global_load_dwordx4 a[212:215], v250, s[12:13] offset:2048 sc1
  global_load_dwordx4 a[216:219], v250, s[12:13] offset:3072 sc1
  v_add_u32 v250, 8192, v250
  global_load_dwordx4 a[220:223], v250, s[12:13] offset:-4096 sc1
  global_load_dwordx4 a[224:227], v250, s[12:13] offset:-3072 sc1
  global_load_dwordx4 a[228:231], v250, s[12:13] offset:-2048 sc1
  global_load_dwordx4 a[232:235], v250, s[12:13] offset:-1024 sc1
  global_load_dwordx4 a[236:239], v250, s[12:13] offset:0 sc1
  s_branch Lp1_join
Lfs_45:
  s_nop 15
  s_mov_b32 s60, 200000
Lpl_47:
  buffer_load_dword v6, v5, s[12:15], s94 offen sc1
  s_sub_u32 s60, s60, 1
  s_cbranch_scc1 Lpd_48
  s_waitcnt vmcnt(0)
  v_subrev_u32 v253, s37, v6
  v_cmp_le_u32 vcc, 16, v253
  s_nop 3
  s_cbranch_vccz Lpd_48
  s_sleep 4
  s_branch Lpl_47
Lpd_48:
  s_waitcnt vmcnt(0)
  s_branch Lfb_46
Lfs_49:
  s_nop 15
  s_mov_b32 s60, 200000
Lpl_51:
  buffer_load_dword v6, v5, s[12:15], s94 offen sc1
  s_sub_u32 s60, s60, 1
  s_cbranch_scc1 Lpd_52
  s_waitcnt vmcnt(0)
  v_subrev_u32 v253, s37, v6
  v_cmp_le_u32 vcc, 16, v253
  s_nop 3
  s_cbranch_vccz Lpd_52
  s_sleep 4
  s_branch Lpl_51
Lpd_52:
  s_waitcnt vmcnt(0)
  s_branch Lfb_50
Lfs_53:
  s_nop 15
  s_mov_b32 s60, 200000
Lpl_55:
  buffer_load_dword v6, v5, s[12:15], s94 offen sc1
  s_sub_u32 s60, s60, 1
  s_cbranch_scc1 Lpd_56
  s_waitcnt vmcnt(0)
  v_subrev_u32 v253, s37, v6
  v_cmp_le_u32 vcc, 16, v253
  s_nop 3
  s_cbranch_vccz Lpd_56
  s_sleep 4
  s_branch Lpl_55
Lpd_56:
  s_waitcnt vmcnt(0)
  s_branch Lfb_54
Lfs_57:
  s_nop 15
  s_mov_b32 s60, 200000
Lpl_59:
  buffer_load_dword v6, v5, s[12:15], s94 offen sc1
  s_sub_u32 s60, s60, 1
  s_cbranch_scc1 Lpd_60
  s_waitcnt vmcnt(0)
  v_subrev_u32 v253, s37, v6
  v_cmp_le_u32 vcc, 16, v253
  s_nop 3
  s_cbranch_vccz Lpd_60
  s_sleep 4
  s_branch Lpl_59
Lpd_60:
  s_waitcnt vmcnt(0)
  s_branch Lfb_58
Lfar_61:
  buffer_store_dwordx4 v[16:19], v12, s[12:15], s53 offen offset:0 sc1
  buffer_store_dwordx4 v[20:23], v12, s[12:15], s53 offen offset:1024 sc1
  s_not_b64 exec, s[44:45]
  buffer_store_dwordx4 v[24:27], v2, s[12:15], s53 offen offset:2048 sc1
  s_nop 0
  s_branch Lnear_62
Lattn_slow:
  s_waitcnt vmcnt(0) lgkmcnt(0)
  v_mov_b32 v16, 0xff800000
  v_mov_b32 v17, 0xff800000
  s_cmp_ge_u32 s40, 4
  s_cselect_b32 s60, 0x3f803f80, 0
  v_mov_b32 v18, s60
  v_cndmask_b32 v72, v72, v18, s[44:45]
  v_cndmask_b32 v73, v73, v18, s[44:45]
  v_cndmask_b32 v74, v74, v18, s[44:45]
  v_cndmask_b32 v75, v75, v18, s[44:45]
  s_nop 0
  s_cbranch_scc0 Lsl_63
  v_mfma_f32_32x32x16_bf16 v[146:161], v[64:67], v[124:127], v[178:193]
  v_mfma_f32_32x32x16_bf16 v[146:161], v[72:75], v[138:141], v[146:161]
  s_nop 11
  v_max3_f32 v16, v146, v147, v16
  v_max3_f32 v16, v148, v149, v16
  v_max3_f32 v16, v150, v151, v16
  v_max3_f32 v16, v152, v153, v16
  v_max3_f32 v16, v154, v155, v16
  v_max3_f32 v16, v156, v157, v16
  v_max3_f32 v16, v158, v159, v16
  v_max3_f32 v16, v160, v161, v16
  v_mfma_f32_32x32x16_bf16 v[146:161], v[68:71], v[124:127], 0
  v_mfma_f32_32x32x16_bf16 v[146:161], v[72:75], v[136:139], v[146:161]
  s_nop 11
  v_max3_f32 v16, v146, v147, v16
  v_max3_f32 v16, v148, v149, v16
  v_max3_f32 v16, v150, v151, v16
  v_max3_f32 v16, v152, v153, v16
  v_max3_f32 v16, v154, v155, v16
  v_max3_f32 v16, v156, v157, v16
  v_max3_f32 v16, v158, v159, v16
  v_max3_f32 v16, v160, v161, v16
  v_mfma_f32_32x32x16_bf16 v[146:161], v[68:71], v[128:131], v[178:193]
  v_mfma_f32_32x32x16_bf16 v[146:161], v[72:75], v[140:143], v[146:161]
  s_nop 11
  v_max3_f32 v17, v146, v147, v17
  v_max3_f32 v17, v148, v149, v17
  v_max3_f32 v17, v150, v151, v17
  v_max3_f32 v17, v152, v153, v17
  v_max3_f32 v17, v154, v155, v17
  v_max3_f32 v17, v156, v157, v17
  v_max3_f32 v17, v158, v159, v17
  v_max3_f32 v17, v160, v161, v17
  s_nop 1
Lsl_63:
  s_cmp_ge_u32 s40, 3
  s_cselect_b32 s60, 0x3f803f80, 0
  v_mov_b32 v18, s60
  v_cndmask_b32 v84, v84, v18, s[44:45]
  v_cndmask_b32 v85, v85, v18, s[44:45]
  v_cndmask_b32 v86, v86, v18, s[44:45]
  v_cndmask_b32 v87, v87, v18, s[44:45]
  s_nop 0
  s_cbranch_scc0 Lsl_64
  v_mfma_f32_32x32x16_bf16 v[146:161], v[76:79], v[124:127], 0
  v_mfma_f32_32x32x16_bf16 v[146:161], v[84:87], v[138:141], v[146:161]
  s_nop 11
  v_max3_f32 v16, v146, v147, v16
  v_max3_f32 v16, v148, v149, v16
  v_max3_f32 v16, v150, v151, v16
  v_max3_f32 v16, v152, v153, v16
  v_max3_f32 v16, v154, v155, v16
  v_max3_f32 v16, v156, v157, v16
  v_max3_f32 v16, v158, v159, v16
  v_max3_f32 v16, v160, v161, v16
  v_mfma_f32_32x32x16_bf16 v[146:161], v[76:79], v[128:131], 0
  v_mfma_f32_32x32x16_bf16 v[146:161], v[84:87], v[142:145], v[146:161]
  s_nop 11
  v_max3_f32 v17, v146, v147, v17
  v_max3_f32 v17, v148, v149, v17
  v_max3_f32 v17, v150, v151, v17
  v_max3_f32 v17, v152, v153, v17
  v_max3_f32 v17, v154, v155, v17
  v_max3_f32 v17, v156, v157, v17
  v_max3_f32 v17, v158, v159, v17
  v_max3_f32 v17, v160, v161, v17
  v_mfma_f32_32x32x16_bf16 v[146:161], v[80:83], v[124:127], 0
  v_mfma_f32_32x32x16_bf16 v[146:161], v[84:87], v[136:139], v[146:161]
  s_nop 11
  v_max3_f32 v16, v146, v147, v16
  v_max3_f32 v16, v148, v149, v16
  v_max3_f32 v16, v150, v151, v16
  v_max3_f32 v16, v152, v153, v16
  v_max3_f32 v16, v154, v155, v16
  v_max3_f32 v16, v156, v157, v16
  v_max3_f32 v16, v158, v159, v16
  v_max3_f32 v16, v160, v161, v16
  v_mfma_f32_32x32x16_bf16 v[146:161], v[80:83], v[128:131], 0
  v_mfma_f32_32x32x16_bf16 v[146:161], v[84:87], v[140:143], v[146:161]
  s_nop 11
  v_max3_f32 v17, v146, v147, v17
  v_max3_f32 v17, v148, v149, v17
  v_max3_f32 v17, v150, v151, v17
  v_max3_f32 v17, v152, v153, v17
  v_max3_f32 v17, v154, v155, v17
  v_max3_f32 v17, v156, v157, v17
  v_max3_f32 v17, v158, v159, v17
  v_max3_f32 v17, v160, v161, v17
  s_nop 1
Lsl_64:
  s_cmp_ge_u32 s40, 2
  s_cselect_b32 s60, 0x3f803f80, 0
  v_mov_b32 v18, s60
  v_cndmask_b32 v96, v96, v18, s[44:45]
  v_cndmask_b32 v97, v97, v18, s[44:45]
  v_cndmask_b32 v98, v98, v18, s[44:45]
  v_cndmask_b32 v99, v99, v18, s[44:45]
  s_nop 0
  s_cbranch_scc0 Lsl_65
  v_mfma_f32_32x32x16_bf16 v[146:161], v[88:91], v[124:127], 0
  v_mfma_f32_32x32x16_bf16 v[146:161], v[96:99], v[138:141], v[146:161]
  s_nop 11
  v_max3_f32 v16, v146, v147, v16
  v_max3_f32 v16, v148, v149, v16
  v_max3_f32 v16, v150, v151, v16
  v_max3_f32 v16, v152, v153, v16
  v_max3_f32 v16, v154, v155, v16
  v_max3_f32 v16, v156, v157, v16
  v_max3_f32 v16, v158, v159, v16
  v_max3_f32 v16, v160, v161, v16
  v_mfma_f32_32x32x16_bf16 v[146:161], v[88:91], v[128:131], 0
  v_mfma_f32_32x32x16_bf16 v[146:161], v[96:99], v[142:145], v[146:161]
  s_nop 11
  v_max3_f32 v17, v146, v147, v17
  v_max3_f32 v17, v148, v149, v17
  v_max3_f32 v17, v150, v151, v17
  v_max3_f32 v17, v152, v153, v17
  v_max3_f32 v17, v154, v155, v17
  v_max3_f32 v17, v156, v157, v17
  v_max3_f32 v17, v158, v159, v17
  v_max3_f32 v17, v160, v161, v17
  v_mfma_f32_32x32x16_bf16 v[146:161], v[92:95], v[124:127], 0
  v_mfma_f32_32x32x16_bf16 v[146:161], v[96:99], v[136:139], v[146:161]
  s_nop 11
  v_max3_f32 v16, v146, v147, v16
  v_max3_f32 v16, v148, v149, v16
  v_max3_f32 v16, v150, v151, v16
  v_max3_f32 v16, v152, v153, v16
  v_max3_f32 v16, v154, v155, v16
  v_max3_f32 v16, v156, v157, v16
  v_max3_f32 v16, v158, v159, v16
  v_max3_f32 v16, v160, v161, v16
  v_mfma_f32_32x32x16_bf16 v[146:161], v[92:95], v[128:131], 0
  v_mfma_f32_32x32x16_bf16 v[146:161], v[96:99], v[140:143], v[146:161]
  s_nop 11
  v_max3_f32 v17, v146, v147, v17
  v_max3_f32 v17, v148, v149, v17
  v_max3_f32 v17, v150, v151, v17
  v_max3_f32 v17, v152, v153, v17
  v_max3_f32 v17, v154, v155, v17
  v_max3_f32 v17, v156, v157, v17
  v_max3_f32 v17, v158, v159, v17
  v_max3_f32 v17, v160, v161, v17
  s_nop 1
Lsl_65:
  s_cmp_ge_u32 s40, 1
  s_cselect_b32 s60, 0x3f803f80, 0
  v_mov_b32 v18, s60
  v_cndmask_b32 v108, v108, v18, s[44:45]
  v_cndmask_b32 v109, v109, v18, s[44:45]
  v_cndmask_b32 v110, v110, v18, s[44:45]
  v_cndmask_b32 v111, v111, v18, s[44:45]
  s_nop 0
  s_cbranch_scc0 Lsl_66
  v_mfma_f32_32x32x16_bf16 v[146:161], v[100:103], v[124:127], 0
  v_mfma_f32_32x32x16_bf16 v[146:161], v[108:111], v[138:141], v[146:161]
  s_nop 11
  v_max3_f32 v16, v146, v147, v16
  v_max3_f32 v16, v148, v149, v16
  v_max3_f32 v16, v150, v151, v16
  v_max3_f32 v16, v152, v153, v16
  v_max3_f32 v16, v154, v155, v16
  v_max3_f32 v16, v156, v157, v16
  v_max3_f32 v16, v158, v159, v16
  v_max3_f32 v16, v160, v161, v16
  v_mfma_f32_32x32x16_bf16 v[146:161], v[100:103], v[128:131], 0
  v_mfma_f32_32x32x16_bf16 v[146:161], v[108:111], v[142:145], v[146:161]
  s_nop 11
  v_max3_f32 v17, v146, v147, v17
  v_max3_f32 v17, v148, v149, v17
  v_max3_f32 v17, v150, v151, v17
  v_max3_f32 v17, v152, v153, v17
  v_max3_f32 v17, v154, v155, v17
  v_max3_f32 v17, v156, v157, v17
  v_max3_f32 v17, v158, v159, v17
  v_max3_f32 v17, v160, v161, v17
  v_mfma_f32_32x32x16_bf16 v[146:161], v[104:107], v[124:127], 0
  v_mfma_f32_32x32x16_bf16 v[146:161], v[108:111], v[136:139], v[146:161]
  s_nop 11
  v_max3_f32 v16, v146, v147, v16
  v_max3_f32 v16, v148, v149, v16
  v_max3_f32 v16, v150, v151, v16
  v_max3_f32 v16, v152, v153, v16
  v_max3_f32 v16, v154, v155, v16
  v_max3_f32 v16, v156, v157, v16
  v_max3_f32 v16, v158, v159, v16
  v_max3_f32 v16, v160, v161, v16
  v_mfma_f32_32x32x16_bf16 v[146:161], v[104:107], v[128:131], 0
  v_mfma_f32_32x32x16_bf16 v[146:161], v[108:111], v[140:143], v[146:161]
  s_nop 11
  v_max3_f32 v17, v146, v147, v17
  v_max3_f32 v17, v148, v149, v17
  v_max3_f32 v17, v150, v151, v17
  v_max3_f32 v17, v152, v153, v17
  v_max3_f32 v17, v154, v155, v17
  v_max3_f32 v17, v156, v157, v17
  v_max3_f32 v17, v158, v159, v17
  v_max3_f32 v17, v160, v161, v17
  s_nop 1
Lsl_66:
  s_cmp_ge_u32 s40, 0
  s_cselect_b32 s60, 0x3f803f80, 0
  v_mov_b32 v18, s60
  v_cndmask_b32 v120, v120, v18, s[44:45]
  v_cndmask_b32 v121, v121, v18, s[44:45]
  v_cndmask_b32 v122, v122, v18, s[44:45]
  v_cndmask_b32 v123, v123, v18, s[44:45]
  s_nop 0
  s_cbranch_scc0 Lsl_67
  v_mfma_f32_32x32x16_bf16 v[146:161], v[112:115], v[124:127], v[194:209]
  v_mfma_f32_32x32x16_bf16 v[146:161], v[120:123], v[138:141], v[146:161]
  s_nop 11
  v_max3_f32 v16, v146, v147, v16
  v_max3_f32 v16, v148, v149, v16
  v_max3_f32 v16, v150, v151, v16
  v_max3_f32 v16, v152, v153, v16
  v_max3_f32 v16, v154, v155, v16
  v_max3_f32 v16, v156, v157, v16
  v_max3_f32 v16, v158, v159, v16
  v_max3_f32 v16, v160, v161, v16
  v_mfma_f32_32x32x16_bf16 v[146:161], v[112:115], v[128:131], 0
  v_mfma_f32_32x32x16_bf16 v[146:161], v[120:123], v[142:145], v[146:161]
  s_nop 11
  v_max3_f32 v17, v146, v147, v17
  v_max3_f32 v17, v148, v149, v17
  v_max3_f32 v17, v150, v151, v17
  v_max3_f32 v17, v152, v153, v17
  v_max3_f32 v17, v154, v155, v17
  v_max3_f32 v17, v156, v157, v17
  v_max3_f32 v17, v158, v159, v17
  v_max3_f32 v17, v160, v161, v17
  v_mfma_f32_32x32x16_bf16 v[146:161], v[116:119], v[128:131], v[194:209]
  v_mfma_f32_32x32x16_bf16 v[146:161], v[120:123], v[140:143], v[146:161]
  s_nop 11
  v_max3_f32 v17, v146, v147, v17
  v_max3_f32 v17, v148, v149, v17
  v_max3_f32 v17, v150, v151, v17
  v_max3_f32 v17, v152, v153, v17
  v_max3_f32 v17, v154, v155, v17
  v_max3_f32 v17, v156, v157, v17
  v_max3_f32 v17, v158, v159, v17
  v_max3_f32 v17, v160, v161, v17
  s_nop 1
Lsl_67:
  v_mov_b32 v18, v16
  s_nop 1
  v_permlane32_swap_b32 v18, v16
  v_max_f32 v18, v18, v16
  v_xor_b32 v18, 0x80000000, v18
  v_and_b32 v19, s46, v18
  v_sub_f32 v18, v18, v19
  v_and_b32 v20, s46, v18
  v_sub_f32 v18, v18, v20
  v_lshrrev_b32 v19, 16, v19
  v_or_b32 v19, v19, v20
  v_lshrrev_b32 v18, 16, v18
  v_cndmask_b32 v138, v138, v19, s[44:45]
  v_cndmask_b32 v139, v139, v18, s[44:45]
  v_mov_b32 v18, v17
  s_nop 1
  v_permlane32_swap_b32 v18, v17
  v_max_f32 v18, v18, v17
  v_xor_b32 v18, 0x80000000, v18
  v_and_b32 v19, s46, v18
  v_sub_f32 v18, v18, v19
  v_and_b32 v20, s46, v18
  v_sub_f32 v18, v18, v20
  v_lshrrev_b32 v19, 16, v19
  v_or_b32 v19, v19, v20
  v_lshrrev_b32 v18, 16, v18
  v_cndmask_b32 v142, v142, v19, s[44:45]
  v_cndmask_b32 v143, v143, v18, s[44:45]
  v_mfma_f32_32x32x16_bf16 v[146:161], v[64:67], v[124:127], v[178:193]
  v_mfma_f32_32x32x16_bf16 v[146:161], v[72:75], v[138:141], v[146:161]
  s_nop 11
  v_exp_f32 v146, v146
  v_exp_f32 v147, v147
  v_exp_f32 v148, v148
  v_exp_f32 v149, v149
  v_mfma_f32_32x32x16_bf16 v[162:177], v[68:71], v[124:127], 0
  v_exp_f32 v150, v150
  v_exp_f32 v151, v151
  v_exp_f32 v152, v152
  v_exp_f32 v153, v153
  v_cvt_pk_bf16_f32 v210, v146, v147
  v_cvt_pk_bf16_f32 v211, v148, v149
  v_mfma_f32_32x32x16_bf16 v[162:177], v[72:75], v[136:139], v[162:177]
  v_exp_f32 v154, v154
  v_exp_f32 v155, v155
  v_exp_f32 v156, v156
  v_exp_f32 v157, v157
  v_cvt_pk_bf16_f32 v212, v150, v151
  v_cvt_pk_bf16_f32 v213, v152, v153
  v_exp_f32 v158, v158
  v_exp_f32 v159, v159
  v_exp_f32 v160, v160
  v_exp_f32 v161, v161
  v_cvt_pk_bf16_f32 v214, v154, v155
  v_cvt_pk_bf16_f32 v215, v156, v157
  v_mfma_f32_32x32x16_bf16 v[32:47], a[0:3], v[210:213], 0
  v_cvt_pk_bf16_f32 v216, v158, v159
  v_cvt_pk_bf16_f32 v217, v160, v161
  v_exp_f32 v162, v162
  v_exp_f32 v163, v163
  v_exp_f32 v164, v164
  v_exp_f32 v165, v165
  v_mfma_f32_32x32x16_bf16 v[146:161], v[68:71], v[128:131], v[178:193]
  v_exp_f32 v166, v166
  v_exp_f32 v167, v167
  v_exp_f32 v168, v168
  v_exp_f32 v169, v169
  v_cvt_pk_bf16_f32 v218, v162, v163
  v_cvt_pk_bf16_f32 v219, v164, v165
  v_mfma_f32_32x32x16_bf16 v[146:161], v[72:75], v[140:143], v[146:161]
  v_exp_f32 v170, v170
  v_exp_f32 v171, v171
  v_exp_f32 v172, v172
  v_exp_f32 v173, v173
  v_cvt_pk_bf16_f32 v220, v166, v167
  v_cvt_pk_bf16_f32 v221, v168, v169
  v_mfma_f32_32x32x16_bf16 v[32:47], a[4:7], v[214:217], v[32:47]
  v_exp_f32 v174, v174
  v_exp_f32 v175, v175
  v_exp_f32 v176, v176
  v_exp_f32 v177, v177
  v_cvt_pk_bf16_f32 v222, v170, v171
  v_cvt_pk_bf16_f32 v223, v172, v173
  v_mfma_f32_32x32x16_bf16 v[32:47], a[8:11], v[218:221], v[32:47]
  v_cvt_pk_bf16_f32 v224, v174, v175
  v_cvt_pk_bf16_f32 v225, v176, v177
  v_exp_f32 v146, v146
  v_exp_f32 v147, v147
  v_exp_f32 v148, v148
  v_exp_f32 v149, v149
  v_mfma_f32_32x32x16_bf16 v[162:177], v[76:79], v[124:127], 0
  v_exp_f32 v150, v150
  v_exp_f32 v151, v151
  v_exp_f32 v152, v152
  v_exp_f32 v153, v153
  v_cvt_pk_bf16_f32 v210, v146, v147
  v_cvt_pk_bf16_f32 v211, v148, v149
  v_mfma_f32_32x32x16_bf16 v[162:177], v[84:87], v[138:141], v[162:177]
  v_exp_f32 v154, v154
  v_exp_f32 v155, v155
  v_exp_f32 v156, v156
  v_exp_f32 v157, v157
  v_cvt_pk_bf16_f32 v212, v150, v151
  v_cvt_pk_bf16_f32 v213, v152, v153
  v_mfma_f32_32x32x16_bf16 v[32:47], a[12:15], v[222:225], v[32:47]
  v_exp_f32 v158, v158
  v_exp_f32 v159, v159
  v_exp_f32 v160, v160
  v_exp_f32 v161, v161
  v_cvt_pk_bf16_f32 v214, v154, v155
  v_cvt_pk_bf16_f32 v215, v156, v157
  v_mfma_f32_32x32x16_bf16 v[48:63], a[8:11], v[210:213], 0
  v_cvt_pk_bf16_f32 v216, v158, v159
  v_cvt_pk_bf16_f32 v217, v160, v161
  v_exp_f32 v162, v162
  v_exp_f32 v163, v163
  v_exp_f32 v164, v164
  v_exp_f32 v165, v165
  v_mfma_f32_32x32x16_bf16 v[146:161], v[76:79], v[128:131], 0
  v_exp_f32 v166, v166
  v_exp_f32 v167, v167
  v_exp_f32 v168, v168
  v_exp_f32 v169, v169
  v_cvt_pk_bf16_f32 v218, v162, v163
  v_cvt_pk_bf16_f32 v219, v164, v165
  v_mfma_f32_32x32x16_bf16 v[146:161], v[84:87], v[142:145], v[146:161]
  v_exp_f32 v170, v170
  v_exp_f32 v171, v171
  v_exp_f32 v172, v172
  v_exp_f32 v173, v173
  v_cvt_pk_bf16_f32 v220, v166, v167
  v_cvt_pk_bf16_f32 v221, v168, v169
  v_mfma_f32_32x32x16_bf16 v[48:63], a[12:15], v[214:217], v[48:63]
  v_exp_f32 v174, v174
  v_exp_f32 v175, v175
  v_exp_f32 v176, v176
  v_exp_f32 v177, v177
  v_cvt_pk_bf16_f32 v222, v170, v171
  v_cvt_pk_bf16_f32 v223, v172, v173
  v_mfma_f32_32x32x16_bf16 v[32:47], a[16:19], v[218:221], v[32:47]
  v_cvt_pk_bf16_f32 v224, v174, v175
  v_cvt_pk_bf16_f32 v225, v176, v177
  v_exp_f32 v146, v146
  v_exp_f32 v147, v147
  v_exp_f32 v148, v148
  v_exp_f32 v149, v149
  v_mfma_f32_32x32x16_bf16 v[162:177], v[80:83], v[124:127], 0
  v_exp_f32 v150, v150
  v_exp_f32 v151, v151
  v_exp_f32 v152, v152
  v_exp_f32 v153, v153
  v_cvt_pk_bf16_f32 v210, v146, v147
  v_cvt_pk_bf16_f32 v211, v148, v149
  v_mfma_f32_32x32x16_bf16 v[162:177], v[84:87], v[136:139], v[162:177]
  v_exp_f32 v154, v154
  v_exp_f32 v155, v155
  v_exp_f32 v156, v156
  v_exp_f32 v157, v157
  v_cvt_pk_bf16_f32 v212, v150, v151
  v_cvt_pk_bf16_f32 v213, v152, v153
  v_mfma_f32_32x32x16_bf16 v[32:47], a[20:23], v[222:225], v[32:47]
  v_exp_f32 v158, v158
  v_exp_f32 v159, v159
  v_exp_f32 v160, v160
  v_exp_f32 v161, v161
  v_cvt_pk_bf16_f32 v214, v154, v155
  v_cvt_pk_bf16_f32 v215, v156, v157
  v_mfma_f32_32x32x16_bf16 v[48:63], a[16:19], v[210:213], v[48:63]
  v_cvt_pk_bf16_f32 v216, v158, v159
  v_cvt_pk_bf16_f32 v217, v160, v161
  v_exp_f32 v162, v162
  v_exp_f32 v163, v163
  v_exp_f32 v164, v164
  v_exp_f32 v165, v165
  v_mfma_f32_32x32x16_bf16 v[146:161], v[80:83], v[128:131], 0
  v_exp_f32 v166, v166
  v_exp_f32 v167, v167
  v_exp_f32 v168, v168
  v_exp_f32 v169, v169
  v_cvt_pk_bf16_f32 v218, v162, v163
  v_cvt_pk_bf16_f32 v219, v164, v165
  v_mfma_f32_32x32x16_bf16 v[146:161], v[84:87], v[140:143], v[146:161]
  v_exp_f32 v170, v170
  v_exp_f32 v171, v171
  v_exp_f32 v172, v172
  v_exp_f32 v173, v173
  v_cvt_pk_bf16_f32 v220, v166, v167
  v_cvt_pk_bf16_f32 v221, v168, v169
  v_mfma_f32_32x32x16_bf16 v[48:63], a[20:23], v[214:217], v[48:63]
  v_exp_f32 v174, v174
  v_exp_f32 v175, v175
  v_exp_f32 v176, v176
  v_exp_f32 v177, v177
  v_cvt_pk_bf16_f32 v222, v170, v171
  v_cvt_pk_bf16_f32 v223, v172, v173
  v_mfma_f32_32x32x16_bf16 v[32:47], a[24:27], v[218:221], v[32:47]
  v_cvt_pk_bf16_f32 v224, v174, v175
  v_cvt_pk_bf16_f32 v225, v176, v177
  v_exp_f32 v146, v146
  v_exp_f32 v147, v147
  v_exp_f32 v148, v148
  v_exp_f32 v149, v149
  v_mfma_f32_32x32x16_bf16 v[162:177], v[88:91], v[124:127], 0
  v_exp_f32 v150, v150
  v_exp_f32 v151, v151
  v_exp_f32 v152, v152
  v_exp_f32 v153, v153
  v_cvt_pk_bf16_f32 v210, v146, v147
  v_cvt_pk_bf16_f32 v211, v148, v149
  v_mfma_f32_32x32x16_bf16 v[162:177], v[96:99], v[138:141], v[162:177]
  v_exp_f32 v154, v154
  v_exp_f32 v155, v155
  v_exp_f32 v156, v156
  v_exp_f32 v157, v157
  v_cvt_pk_bf16_f32 v212, v150, v151
  v_cvt_pk_bf16_f32 v213, v152, v153
  v_mfma_f32_32x32x16_bf16 v[32:47], a[28:31], v[222:225], v[32:47]
  v_exp_f32 v158, v158
  v_exp_f32 v159, v159
  v_exp_f32 v160, v160
  v_exp_f32 v161, v161
  v_cvt_pk_bf16_f32 v214, v154, v155
  v_cvt_pk_bf16_f32 v215, v156, v157
  v_mfma_f32_32x32x16_bf16 v[48:63], a[24:27], v[210:213], v[48:63]
  v_cvt_pk_bf16_f32 v216, v158, v159
  v_cvt_pk_bf16_f32 v217, v160, v161
  v_exp_f32 v162, v162
  v_exp_f32 v163, v163
  v_exp_f32 v164, v164
  v_exp_f32 v165, v165
  v_mfma_f32_32x32x16_bf16 v[146:161], v[88:91], v[128:131], 0
  v_exp_f32 v166, v166
  v_exp_f32 v167, v167
  v_exp_f32 v168, v168
  v_exp_f32 v169, v169
  v_cvt_pk_bf16_f32 v218, v162, v163
  v_cvt_pk_bf16_f32 v219, v164, v165
  v_mfma_f32_32x32x16_bf16 v[146:161], v[96:99], v[142:145], v[146:161]
  v_exp_f32 v170, v170
  v_exp_f32 v171, v171
  v_exp_f32 v172, v172
  v_exp_f32 v173, v173
  v_cvt_pk_bf16_f32 v220, v166, v167
  v_cvt_pk_bf16_f32 v221, v168, v169
  v_mfma_f32_32x32x16_bf16 v[48:63], a[28:31], v[214:217], v[48:63]
  v_exp_f32 v174, v174
  v_exp_f32 v175, v175
  v_exp_f32 v176, v176
  v_exp_f32 v177, v177
  v_cvt_pk_bf16_f32 v222, v170, v171
  v_cvt_pk_bf16_f32 v223, v172, v173
  v_mfma_f32_32x32x16_bf16 v[32:47], a[32:35], v[218:221], v[32:47]
  v_cvt_pk_bf16_f32 v224, v174, v175
  v_cvt_pk_bf16_f32 v225, v176, v177
  v_exp_f32 v146, v146
  v_exp_f32 v147, v147
  v_exp_f32 v148, v148
  v_exp_f32 v149, v149
  v_mfma_f32_32x32x16_bf16 v[162:177], v[92:95], v[124:127], 0
  v_exp_f32 v150, v150
  v_exp_f32 v151, v151
  v_exp_f32 v152, v152
  v_exp_f32 v153, v153
  v_cvt_pk_bf16_f32 v210, v146, v147
  v_cvt_pk_bf16_f32 v211, v148, v149
  v_mfma_f32_32x32x16_bf16 v[162:177], v[96:99], v[136:139], v[162:177]
  v_exp_f32 v154, v154
  v_exp_f32 v155, v155
  v_exp_f32 v156, v156
  v_exp_f32 v157, v157
  v_cvt_pk_bf16_f32 v212, v150, v151
  v_cvt_pk_bf16_f32 v213, v152, v153
  v_mfma_f32_32x32x16_bf16 v[32:47], a[36:39], v[222:225], v[32:47]
  v_exp_f32 v158, v158
  v_exp_f32 v159, v159
  v_exp_f32 v160, v160
  v_exp_f32 v161, v161
  v_cvt_pk_bf16_f32 v214, v154, v155
  v_cvt_pk_bf16_f32 v215, v156, v157
  v_mfma_f32_32x32x16_bf16 v[48:63], a[32:35], v[210:213], v[48:63]
  v_cvt_pk_bf16_f32 v216, v158, v159
  v_cvt_pk_bf16_f32 v217, v160, v161
  v_exp_f32 v162, v162
  v_exp_f32 v163, v163
  v_exp_f32 v164, v164
  v_exp_f32 v165, v165
  v_mfma_f32_32x32x16_bf16 v[146:161], v[92:95], v[128:131], 0
  v_exp_f32 v166, v166
  v_exp_f32 v167, v167
  v_exp_f32 v168, v168
  v_exp_f32 v169, v169
  v_cvt_pk_bf16_f32 v218, v162, v163
  v_cvt_pk_bf16_f32 v219, v164, v165
  v_mfma_f32_32x32x16_bf16 v[146:161], v[96:99], v[140:143], v[146:161]
  v_exp_f32 v170, v170
  v_exp_f32 v171, v171
  v_exp_f32 v172, v172
  v_exp_f32 v173, v173
  v_cvt_pk_bf16_f32 v220, v166, v167
  v_cvt_pk_bf16_f32 v221, v168, v169
  v_mfma_f32_32x32x16_bf16 v[48:63], a[36:39], v[214:217], v[48:63]
  v_exp_f32 v174, v174
  v_exp_f32 v175, v175
  v_exp_f32 v176, v176
  v_exp_f32 v177, v177
  v_cvt_pk_bf16_f32 v222, v170, v171
  v_cvt_pk_bf16_f32 v223, v172, v173
  v_mfma_f32_32x32x16_bf16 v[32:47], a[40:43], v[218:221], v[32:47]
  v_cvt_pk_bf16_f32 v224, v174, v175
  v_cvt_pk_bf16_f32 v225, v176, v177
  v_exp_f32 v146, v146
  v_exp_f32 v147, v147
  v_exp_f32 v148, v148
  v_exp_f32 v149, v149
  v_mfma_f32_32x32x16_bf16 v[162:177], v[100:103], v[124:127], 0
  v_exp_f32 v150, v150
  v_exp_f32 v151, v151
  v_exp_f32 v152, v152
  v_exp_f32 v153, v153
  v_cvt_pk_bf16_f32 v210, v146, v147
  v_cvt_pk_bf16_f32 v211, v148, v149
  v_mfma_f32_32x32x16_bf16 v[162:177], v[108:111], v[138:141], v[162:177]
  v_exp_f32 v154, v154
  v_exp_f32 v155, v155
  v_exp_f32 v156, v156
  v_exp_f32 v157, v157
  v_cvt_pk_bf16_f32 v212, v150, v151
  v_cvt_pk_bf16_f32 v213, v152, v153
  v_mfma_f32_32x32x16_bf16 v[32:47], a[44:47], v[222:225], v[32:47]
  v_exp_f32 v158, v158
  v_exp_f32 v159, v159
  v_exp_f32 v160, v160
  v_exp_f32 v161, v161
  v_cvt_pk_bf16_f32 v214, v154, v155
  v_cvt_pk_bf16_f32 v215, v156, v157
  v_mfma_f32_32x32x16_bf16 v[48:63], a[40:43], v[210:213], v[48:63]
  v_cvt_pk_bf16_f32 v216, v158, v159
  v_cvt_pk_bf16_f32 v217, v160, v161
  v_exp_f32 v162, v162
  v_exp_f32 v163, v163
  v_exp_f32 v164, v164
  v_exp_f32 v165, v165
  v_mfma_f32_32x32x16_bf16 v[146:161], v[100:103], v[128:131], 0
  v_exp_f32 v166, v166
  v_exp_f32 v167, v167
  v_exp_f32 v168, v168
  v_exp_f32 v169, v169
  v_cvt_pk_bf16_f32 v218, v162, v163
  v_cvt_pk_bf16_f32 v219, v164, v165
  v_mfma_f32_32x32x16_bf16 v[146:161], v[108:111], v[142:145], v[146:161]
  v_exp_f32 v170, v170
  v_exp_f32 v171, v171
  v_exp_f32 v172, v172
  v_exp_f32 v173, v173
  v_cvt_pk_bf16_f32 v220, v166, v167
  v_cvt_pk_bf16_f32 v221, v168, v169
  v_mfma_f32_32x32x16_bf16 v[48:63], a[44:47], v[214:217], v[48:63]
  v_exp_f32 v174, v174
  v_exp_f32 v175, v175
  v_exp_f32 v176, v176
  v_exp_f32 v177, v177
  v_cvt_pk_bf16_f32 v222, v170, v171
  v_cvt_pk_bf16_f32 v223, v172, v173
  v_mfma_f32_32x32x16_bf16 v[32:47], a[48:51], v[218:221], v[32:47]
  v_cvt_pk_bf16_f32 v224, v174, v175
  v_cvt_pk_bf16_f32 v225, v176, v177
  v_exp_f32 v146, v146
  v_exp_f32 v147, v147
  v_exp_f32 v148, v148
  v_exp_f32 v149, v149
  v_mfma_f32_32x32x16_bf16 v[162:177], v[104:107], v[124:127], 0
  v_exp_f32 v150, v150
  v_exp_f32 v151, v151
  v_exp_f32 v152, v152
  v_exp_f32 v153, v153
  v_cvt_pk_bf16_f32 v210, v146, v147
  v_cvt_pk_bf16_f32 v211, v148, v149
  v_mfma_f32_32x32x16_bf16 v[162:177], v[108:111], v[136:139], v[162:177]
  v_exp_f32 v154, v154
  v_exp_f32 v155, v155
  v_exp_f32 v156, v156
  v_exp_f32 v157, v157
  v_cvt_pk_bf16_f32 v212, v150, v151
  v_cvt_pk_bf16_f32 v213, v152, v153
  v_mfma_f32_32x32x16_bf16 v[32:47], a[52:55], v[222:225], v[32:47]
  v_exp_f32 v158, v158
  v_exp_f32 v159, v159
  v_exp_f32 v160, v160
  v_exp_f32 v161, v161
  v_cvt_pk_bf16_f32 v214, v154, v155
  v_cvt_pk_bf16_f32 v215, v156, v157
  v_mfma_f32_32x32x16_bf16 v[48:63], a[48:51], v[210:213], v[48:63]
  v_cvt_pk_bf16_f32 v216, v158, v159
  v_cvt_pk_bf16_f32 v217, v160, v161
  v_exp_f32 v162, v162
  v_exp_f32 v163, v163
  v_exp_f32 v164, v164
  v_exp_f32 v165, v165
  v_mfma_f32_32x32x16_bf16 v[146:161], v[104:107], v[128:131], 0
  v_exp_f32 v166, v166
  v_exp_f32 v167, v167
  v_exp_f32 v168, v168
  v_exp_f32 v169, v169
  v_cvt_pk_bf16_f32 v218, v162, v163
  v_cvt_pk_bf16_f32 v219, v164, v165
  v_mfma_f32_32x32x16_bf16 v[146:161], v[108:111], v[140:143], v[146:161]
  v_exp_f32 v170, v170
  v_exp_f32 v171, v171
  v_exp_f32 v172, v172
  v_exp_f32 v173, v173
  v_cvt_pk_bf16_f32 v220, v166, v167
  v_cvt_pk_bf16_f32 v221, v168, v169
  v_mfma_f32_32x32x16_bf16 v[48:63], a[52:55], v[214:217], v[48:63]
  v_exp_f32 v174, v174
  v_exp_f32 v175, v175
  v_exp_f32 v176, v176
  v_exp_f32 v177, v177
  v_cvt_pk_bf16_f32 v222, v170, v171
  v_cvt_pk_bf16_f32 v223, v172, v173
  v_mfma_f32_32x32x16_bf16 v[32:47], a[56:59], v[218:221], v[32:47]
  v_cvt_pk_bf16_f32 v224, v174, v175
  v_cvt_pk_bf16_f32 v225, v176, v177
  v_exp_f32 v146, v146
  v_exp_f32 v147, v147
  v_exp_f32 v148, v148
  v_exp_f32 v149, v149
  v_mfma_f32_32x32x16_bf16 v[162:177], v[112:115], v[124:127], v[194:209]
  v_exp_f32 v150, v150
  v_exp_f32 v151, v151
  v_exp_f32 v152, v152
  v_exp_f32 v153, v153
  v_cvt_pk_bf16_f32 v210, v146, v147
  v_cvt_pk_bf16_f32 v211, v148, v149
  v_mfma_f32_32x32x16_bf16 v[162:177], v[120:123], v[138:141], v[162:177]
  v_exp_f32 v154, v154
  v_exp_f32 v155, v155
  v_exp_f32 v156, v156
  v_exp_f32 v157, v157
  v_cvt_pk_bf16_f32 v212, v150, v151
  v_cvt_pk_bf16_f32 v213, v152, v153
  v_mfma_f32_32x32x16_bf16 v[32:47], a[60:63], v[222:225], v[32:47]
  v_exp_f32 v158, v158
  v_exp_f32 v159, v159
  v_exp_f32 v160, v160
  v_exp_f32 v161, v161
  v_cvt_pk_bf16_f32 v214, v154, v155
  v_cvt_pk_bf16_f32 v215, v156, v157
  v_mfma_f32_32x32x16_bf16 v[48:63], a[56:59], v[210:213], v[48:63]
  v_cvt_pk_bf16_f32 v216, v158, v159
  v_cvt_pk_bf16_f32 v217, v160, v161
  v_exp_f32 v162, v162
  v_exp_f32 v163, v163
  v_exp_f32 v164, v164
  v_exp_f32 v165, v165
  v_mfma_f32_32x32x16_bf16 v[146:161], v[112:115], v[128:131], 0
  v_exp_f32 v166, v166
  v_exp_f32 v167, v167
  v_exp_f32 v168, v168
  v_exp_f32 v169, v169
  v_cvt_pk_bf16_f32 v218, v162, v163
  v_cvt_pk_bf16_f32 v219, v164, v165
  v_mfma_f32_32x32x16_bf16 v[146:161], v[120:123], v[142:145], v[146:161]
  v_exp_f32 v170, v170
  v_exp_f32 v171, v171
  v_exp_f32 v172, v172
  v_exp_f32 v173, v173
  v_cvt_pk_bf16_f32 v220, v166, v167
  v_cvt_pk_bf16_f32 v221, v168, v169
  v_mfma_f32_32x32x16_bf16 v[48:63], a[60:63], v[214:217], v[48:63]
  v_exp_f32 v174, v174
  v_exp_f32 v175, v175
  v_exp_f32 v176, v176
  v_exp_f32 v177, v177
  v_cvt_pk_bf16_f32 v222, v170, v171
  v_cvt_pk_bf16_f32 v223, v172, v173
  v_mfma_f32_32x32x16_bf16 v[32:47], a[64:67], v[218:221], v[32:47]
  v_cvt_pk_bf16_f32 v224, v174, v175
  v_cvt_pk_bf16_f32 v225, v176, v177
  v_exp_f32 v146, v146
  v_exp_f32 v147, v147
  v_exp_f32 v148, v148
  v_exp_f32 v149, v149
  v_mfma_f32_32x32x16_bf16 v[162:177], v[116:119], v[128:131], v[194:209]
  v_exp_f32 v150, v150
  v_exp_f32 v151, v151
  v_exp_f32 v152, v152
  v_exp_f32 v153, v153
  v_cvt_pk_bf16_f32 v210, v146, v147
  v_cvt_pk_bf16_f32 v211, v148, v149
  v_mfma_f32_32x32x16_bf16 v[162:177], v[120:123], v[140:143], v[162:177]
  v_exp_f32 v154, v154
  v_exp_f32 v155, v155
  v_exp_f32 v156, v156
  v_exp_f32 v157, v157
  v_cvt_pk_bf16_f32 v212, v150, v151
  v_cvt_pk_bf16_f32 v213, v152, v153
  v_mfma_f32_32x32x16_bf16 v[32:47], a[68:71], v[222:225], v[32:47]
  v_exp_f32 v158, v158
  v_exp_f32 v159, v159
  v_exp_f32 v160, v160
  v_exp_f32 v161, v161
  v_cvt_pk_bf16_f32 v214, v154, v155
  v_cvt_pk_bf16_f32 v215, v156, v157
  v_mfma_f32_32x32x16_bf16 v[48:63], a[64:67], v[210:213], v[48:63]
  v_cvt_pk_bf16_f32 v216, v158, v159
  v_cvt_pk_bf16_f32 v217, v160, v161
  v_exp_f32 v162, v162
  v_exp_f32 v163, v163
  v_exp_f32 v164, v164
  v_exp_f32 v165, v165
  v_exp_f32 v166, v166
  v_exp_f32 v167, v167
  v_exp_f32 v168, v168
  v_exp_f32 v169, v169
  v_cvt_pk_bf16_f32 v218, v162, v163
  v_cvt_pk_bf16_f32 v219, v164, v165
  v_exp_f32 v170, v170
  v_exp_f32 v171, v171
  v_exp_f32 v172, v172
  v_exp_f32 v173, v173
  v_cvt_pk_bf16_f32 v220, v166, v167
  v_cvt_pk_bf16_f32 v221, v168, v169
  v_mfma_f32_32x32x16_bf16 v[48:63], a[68:71], v[214:217], v[48:63]
  v_exp_f32 v174, v174
  v_exp_f32 v175, v175
  v_exp_f32 v176, v176
  v_exp_f32 v177, v177
  v_cvt_pk_bf16_f32 v222, v170, v171
  v_cvt_pk_bf16_f32 v223, v172, v173
  v_mfma_f32_32x32x16_bf16 v[48:63], a[72:75], v[218:221], v[48:63]
  v_cvt_pk_bf16_f32 v224, v174, v175
  v_cvt_pk_bf16_f32 v225, v176, v177
  s_nop 1
  v_mfma_f32_32x32x16_bf16 v[48:63], a[76:79], v[222:225], v[48:63]
  s_nop 10
  s_branch Lattn_fin
Lfar_68:
  buffer_store_dword v254, off, s[12:15], s61 sc1
  s_branch Lnear_69
Lfar_76:
  buffer_store_dword v254, off, s[12:15], s61 sc1
  s_branch Lnear_77
Lss_80:
  s_nop 15
  s_mov_b32 s60, 200000
Lsl_82:
  buffer_load_dwordx4 v[224:227], v2, s[12:15], s52 offen offset:0 sc1
  buffer_load_dwordx4 v[228:231], v2, s[12:15], s52 offen offset:1024 sc1
  buffer_load_dwordx2 v[232:233], v28, s[12:15], s52 offen offset:2048 sc1
  s_waitcnt vmcnt(0)
  s_sub_u32 s60, s60, 1
  s_cbranch_scc1 Lsb_81
  v_max_u32 v29, v232, v233
  v_max3_u32 v29, v224, v225, v29
  v_max3_u32 v29, v226, v227, v29
  v_max3_u32 v29, v228, v229, v29
  v_max3_u32 v29, v230, v231, v29
  v_cmp_eq_u32 vcc, -1, v29
  s_nop 3
  s_cbranch_vccz Lsb_81
  s_branch Lsl_82
Lend:
  s_endpgm
Lcode_end:
.section .rodata,"a"
.p2align 6
.amdhsa_kernel sequential_preLN__sliding_block__dense_activation_silu__prompt_kernel
  .amdhsa_next_free_vgpr 512
  .amdhsa_next_free_sgpr 102
  .amdhsa_accum_offset 256
  .amdhsa_group_segment_fixed_size 0
  .amdhsa_kernarg_size 72
  .amdhsa_user_sgpr_count 2
  .amdhsa_user_sgpr_kernarg_segment_ptr 1
  .amdhsa_system_sgpr_workgroup_id_x 1
.end_amdhsa_kernel
```
